```python
import torch

def _softmax(x, axis=-1):
    return torch.softmax(x, dim=axis)
def _gelu(x):
    return torch.nn.functional.gelu(x, approximate="tanh")
def _silu(x):
    return torch.nn.functional.silu(x)
def _sigmoid(x):
    return torch.sigmoid(x)
def _layernorm(x, axis=-1, eps=1e-5):
    m = x.mean(dim=axis, keepdim=True)
    v = x.var(dim=axis, keepdim=True, unbiased=False)
    return (x - m) / torch.sqrt(v + eps)
def _scatter_add(tgt, idx, src, axis=0):
    return tgt.clone().index_add_(axis, idx, src)
def _segment_sum(src, seg, n):
    out = torch.zeros((n,) + src.shape[1:], dtype=src.dtype)
    return out.index_add_(0, seg, src)
def _pad(x, pw):
    flat = tuple(v for pair in reversed(pw) for v in pair)
    return torch.nn.functional.pad(x, flat)

kernel_name = 'sequential_preLN__ssm_conv_h3__dense_activation_squared_relu__prompt'

def setup_inputs():

    _w = (lambda a: (lambda t: t.to(torch.bfloat16) if t.is_floating_point() else t)(torch.as_tensor(a)))
    def _A_setup():
        B, S, D = 1, 2048, 1024
        ks = 4
        return {
            "q": _w((lambda *s: torch.randn(*s, dtype=torch.bfloat16) * 0.05)(B, S, D)),
            "k": _w((lambda *s: torch.randn(*s, dtype=torch.bfloat16) * 0.4)(B, S, D)),
            "v": _w((lambda *s: torch.randn(*s, dtype=torch.bfloat16) * 0.4)(B, S, D)),
            "shift_k": _w((lambda *s: torch.randn(*s, dtype=torch.bfloat16) * 0.4)(D, ks) * 0.5),
            "ssm_k": _w((lambda *s: torch.randn(*s, dtype=torch.bfloat16) * 0.4)(D, S) * (1.0 / S ** 0.5)),
            "ssm_D": _w((lambda *s: torch.randn(*s, dtype=torch.bfloat16) * 0.4)(D)),
        }
    _A_in = _A_setup()

    def _B_setup():
        B, S, D, F = 1, 2048, 1024, 3584
        return {
            "x": _w((lambda *s: torch.randn(*s, dtype=torch.bfloat16) * 0.05)(B, S, D)),
            "w1": _w((lambda *s: torch.randn(*s, dtype=torch.bfloat16) * 0.05)(D, F)),
            "b1": _w((lambda *s: torch.randn(*s, dtype=torch.bfloat16) * 0.4)(F)),
            "w2": _w((lambda *s: torch.randn(*s, dtype=torch.bfloat16) * 0.05)(F, D)),
            "b2": _w((lambda *s: torch.randn(*s, dtype=torch.bfloat16) * 3.2)(D)),
        }
    _B_in = _B_setup()

    return {
        "A_q": _A_in["q"],
        "A_k": _A_in["k"],
        "A_v": _A_in["v"],
        "A_shift_k": _A_in["shift_k"],
        "A_ssm_k": _A_in["ssm_k"],
        "A_ssm_D": _A_in["ssm_D"],
        "B_x": _B_in["x"],
        "B_w1": _B_in["w1"],
        "B_b1": _B_in["b1"],
        "B_w2": _B_in["w2"],
        "B_b2": _B_in["b2"],
    }

def reference(A_q, A_k, A_v, A_shift_k, A_ssm_k, A_ssm_D, B_x, B_w1, B_b1, B_w2, B_b2):
    def _A_ref(q, k, v, shift_k, ssm_k, ssm_D):
        B, S, D = q.shape
        ks = shift_k.shape[-1]
        k_pad = _pad(k, ((0, 0), (ks - 1, 0), (0, 0)))
        k_shift = torch.zeros_like(k)
        for t in range(ks):
            k_shift = k_shift + k_pad[:, t:t + S, :] * shift_k[:, ks - 1 - t][None, None, :]
        kv = k_shift * v
        L = 2 * S
        kv_pad = _pad(kv, ((0, 0), (0, S), (0, 0)))
        kf_pad = _pad(ssm_k, ((0, 0), (0, S)))
        kv_f = (lambda x, axes=(-2,-1): torch.fft.rfft2(x.float(), dim=axes))(kv_pad[:, None, :, :], axes=(1, 2))
        kf_f = (lambda x, axes=(-2,-1): torch.fft.rfft2(x.float(), dim=axes))(kf_pad[:, None, :], axes=(1, 2))
        kf_f = (lambda x, *d: x.permute(*d))(kf_f, 1, 2, 0)
        y_f = kv_f * kf_f[None, :, :, :]
        y = (lambda x, s, axes=(-2,-1): torch.fft.irfft2(x, s=s, dim=axes).to(torch.bfloat16))(y_f, (1, L), axes=(1, 2))[:, 0, :S, :]
        y = y + kv * ssm_D[None, None, :]
        return q * y

    def _B_ref(x, w1, b1, w2, b2):
        h = torch.einsum("bsd,df->bsf", x, w1) + b1
        zero = torch.zeros_like(h)
        r = torch.where(h > zero, h, zero)
        h = r * r
        out = torch.einsum("bsf,fd->bsd", h, w2) + b2
        return out

    x = A_q
    h = x + _A_ref(_layernorm(x, axis=-1), A_k, A_v, A_shift_k, A_ssm_k, A_ssm_D)
    h2 = h + _B_ref(_layernorm(h, axis=-1), B_w1, B_b1, B_w2, B_b2)
    return h2
```

```asm
; @launch kernel=sequential_preLN__ssm_conv_h3__dense_activation_squared_relu__prompt_kernel grid=(256,1,1) block=(512,1,1) lds=152976
.amdgcn_target "amdgcn-amd-amdhsa--gfx950"
.text
.globl sequential_preLN__ssm_conv_h3__dense_activation_squared_relu__prompt_kernel
.p2align 8
.type sequential_preLN__ssm_conv_h3__dense_activation_squared_relu__prompt_kernel,@function
sequential_preLN__ssm_conv_h3__dense_activation_squared_relu__prompt_kernel:
    s_cmp_ge_u32 s2, 256
    s_cbranch_scc1 sequential_preLN__ssm_conv_h3__dense_activation_squared_relu__prompt_kernel_end
    s_nop 0
    s_load_dwordx4 s[4:7], s[0:1], 0
    s_load_dwordx4 s[8:11], s[0:1], 16
    s_load_dwordx4 s[40:43], s[0:1], 32
    s_load_dwordx4 s[28:31], s[0:1], 96
    v_lshrrev_b32 v2, 6, v0
    v_and_b32 v1, 63, v0
    v_readfirstlane_b32 s14, v2
    s_and_b32 s15, s2, 7
    s_lshr_b32 s16, s2, 3
    v_and_b32 v3, 15, v1
    v_lshrrev_b32 v4, 4, v1
    v_lshlrev_b32 v5, 4, v1
    s_and_b32 s18, s14, 3
    s_lshl_b32 s52, s16, 17
    s_lshl_b32 s53, s18, 15
    s_add_u32 s52, s52, s53
    s_lshl_b32 s53, s15, 8
    s_add_u32 s52, s52, s53
    v_lshlrev_b32_e64 v7, 13, v4
    v_lshl_add_u32 v7, v3, 4, v7
    v_add_u32_e64 v7, s52, v7
    s_mov_b32 s44, 4096
    s_mov_b32 s22, 0x400000
    s_mov_b32 s23, 0x20000
    s_lshl_b32 s17, s15, 7
    s_lshl_b32 s19, s16, 2
    s_add_u32 s17, s17, s19
    s_add_u32 s17, s17, s18
    s_lshl_b32 s19, s17, 12
    s_cmp_ge_u32 s14, 4
    s_cbranch_scc1 sequential_preLN__ssm_conv_h3__dense_activation_squared_relu__prompt_kernel_xw
    s_nop 0
    v_subrev_u32 v11, 6144, v7
    v_subrev_u32 v12, 2048, v7
    v_lshlrev_b32 v13, 6, v3
    s_lshl_b32 s53, s15, 10
    s_mov_b32 s26, 0x400000
    s_mov_b32 s27, 0x20000
    s_mov_b32 s34, 8192
    s_mov_b32 s35, 0x20000
    s_waitcnt lgkmcnt(0)
    s_mov_b32 s20, s6
    s_mov_b32 s21, s7
    s_nop 0
    buffer_load_dwordx4 v[16:19], v11, s[20:23], 0 offen
    buffer_load_dwordx4 v[20:23], v11, s[20:23], 0 offen offset:2048
    buffer_load_dwordx4 v[24:27], v12, s[20:23], 0 offen
    buffer_load_dwordx4 v[28:31], v7, s[20:23], 0 offen offset:0
    buffer_load_dwordx4 v[32:35], v7, s[20:23], 0 offen offset:2048
    buffer_load_dwordx4 v[36:39], v7, s[20:23], s44 offen offset:0
    buffer_load_dwordx4 v[40:43], v7, s[20:23], s44 offen offset:2048
    s_mov_b32 s32, s10
    s_mov_b32 s33, s11
    buffer_load_dwordx4 v[60:63], v13, s[32:35], s53 offen offset:0
    buffer_load_dwordx4 v[64:67], v13, s[32:35], s53 offen offset:16
    buffer_load_dwordx4 v[68:71], v13, s[32:35], s53 offen offset:32
    buffer_load_dwordx4 v[72:75], v13, s[32:35], s53 offen offset:48
    s_mov_b32 s24, s8
    s_mov_b32 s25, s9
    buffer_load_dwordx4 v[44:47], v7, s[24:27], 0 offen offset:0
    buffer_load_dwordx4 v[48:51], v7, s[24:27], 0 offen offset:2048
    buffer_load_dwordx4 v[52:55], v7, s[24:27], s44 offen offset:0
    buffer_load_dwordx4 v[56:59], v7, s[24:27], s44 offen offset:2048
    s_mov_b32 s20, s40
    s_mov_b32 s21, s41
    s_mov_b32 s12, s30
    s_mov_b32 s13, s31
    s_lshr_b32 s53, s17, 1
    s_lshl_b32 s53, s53, 2
    s_load_dword s45, s[42:43], s53
    s_lshl_b32 s53, s18, 1
    v_lshrrev_b32 v9, 1, v4
    v_add_u32 v9, s53, v9
    v_and_b32 v10, 7, v3
    v_xor_b32 v9, v9, v10
    v_lshlrev_b32 v8, 10, v3
    v_lshl_add_u32 v8, v9, 4, v8
    v_and_b32 v9, 1, v4
    v_xor_b32 v9, 1, v9
    v_lshl_add_u32 v8, v9, 3, v8
    v_add_u32 v8, 84992, v8
    s_waitcnt vmcnt(14)
    v_lshlrev_b32 v108, 16, v16
    v_and_b32 v109, 0xffff0000, v16
    v_lshlrev_b32_e64 v110, 16, v17
    v_and_b32 v111, 0xffff0000, v17
    v_lshlrev_b32_e64 v112, 16, v18
    v_and_b32 v113, 0xffff0000, v18
    v_lshlrev_b32_e64 v114, 16, v19
    v_and_b32 v115, 0xffff0000, v19
    s_waitcnt vmcnt(13)
    v_lshlrev_b32 v116, 16, v20
    v_and_b32 v117, 0xffff0000, v20
    v_lshlrev_b32_e64 v118, 16, v21
    v_and_b32 v119, 0xffff0000, v21
    v_lshlrev_b32_e64 v120, 16, v22
    v_and_b32 v121, 0xffff0000, v22
    v_lshlrev_b32_e64 v122, 16, v23
    v_and_b32 v123, 0xffff0000, v23
    s_waitcnt vmcnt(12)
    v_lshlrev_b32 v124, 16, v24
    v_and_b32 v125, 0xffff0000, v24
    v_lshlrev_b32_e64 v126, 16, v25
    v_and_b32 v127, 0xffff0000, v25
    v_lshlrev_b32_e64 v128, 16, v26
    v_and_b32 v129, 0xffff0000, v26
    v_lshlrev_b32_e64 v130, 16, v27
    v_and_b32 v131, 0xffff0000, v27
    s_waitcnt vmcnt(11)
    v_lshlrev_b32 v132, 16, v28
    v_and_b32 v133, 0xffff0000, v28
    v_lshlrev_b32_e64 v134, 16, v29
    v_and_b32 v135, 0xffff0000, v29
    v_lshlrev_b32_e64 v136, 16, v30
    v_and_b32 v137, 0xffff0000, v30
    v_lshlrev_b32_e64 v138, 16, v31
    v_and_b32 v139, 0xffff0000, v31
    s_waitcnt vmcnt(10)
    v_lshlrev_b32 v140, 16, v32
    v_and_b32 v141, 0xffff0000, v32
    v_lshlrev_b32_e64 v142, 16, v33
    v_and_b32 v143, 0xffff0000, v33
    v_lshlrev_b32_e64 v144, 16, v34
    v_and_b32 v145, 0xffff0000, v34
    v_lshlrev_b32_e64 v146, 16, v35
    v_and_b32 v147, 0xffff0000, v35
    s_waitcnt vmcnt(9)
    v_lshlrev_b32 v148, 16, v36
    v_and_b32 v149, 0xffff0000, v36
    v_lshlrev_b32_e64 v150, 16, v37
    v_and_b32 v151, 0xffff0000, v37
    v_lshlrev_b32_e64 v152, 16, v38
    v_and_b32 v153, 0xffff0000, v38
    v_lshlrev_b32_e64 v154, 16, v39
    v_and_b32 v155, 0xffff0000, v39
    s_waitcnt vmcnt(8)
    v_lshlrev_b32 v156, 16, v40
    v_and_b32 v157, 0xffff0000, v40
    v_lshlrev_b32_e64 v158, 16, v41
    v_and_b32 v159, 0xffff0000, v41
    v_lshlrev_b32_e64 v160, 16, v42
    v_and_b32 v161, 0xffff0000, v42
    v_lshlrev_b32_e64 v162, 16, v43
    v_and_b32 v163, 0xffff0000, v43
    s_waitcnt vmcnt(4)
    v_lshlrev_b32 v76, 16, v60
    v_lshlrev_b32 v77, 16, v62
    v_lshlrev_b32 v78, 16, v64
    v_lshlrev_b32 v79, 16, v66
    v_lshlrev_b32 v80, 16, v68
    v_lshlrev_b32 v81, 16, v70
    v_lshlrev_b32 v82, 16, v72
    v_lshlrev_b32_e64 v83, 16, v74
    v_and_b32 v84, 0xffff0000, v60
    v_and_b32 v85, 0xffff0000, v62
    v_and_b32 v86, 0xffff0000, v64
    v_and_b32 v87, 0xffff0000, v66
    v_and_b32 v88, 0xffff0000, v68
    v_and_b32 v89, 0xffff0000, v70
    v_and_b32 v90, 0xffff0000, v72
    v_and_b32 v91, 0xffff0000, v74
    v_lshlrev_b32 v92, 16, v61
    v_lshlrev_b32 v93, 16, v63
    v_lshlrev_b32 v94, 16, v65
    v_lshlrev_b32 v95, 16, v67
    v_lshlrev_b32 v96, 16, v69
    v_lshlrev_b32 v97, 16, v71
    v_lshlrev_b32 v98, 16, v73
    v_lshlrev_b32 v99, 16, v75
    v_and_b32 v100, 0xffff0000, v61
    v_and_b32 v101, 0xffff0000, v63
    v_and_b32 v102, 0xffff0000, v65
    v_and_b32 v103, 0xffff0000, v67
    v_and_b32 v104, 0xffff0000, v69
    v_and_b32 v105, 0xffff0000, v71
    v_and_b32 v106, 0xffff0000, v73
    v_and_b32 v107, 0xffff0000, v75
    v_pk_mul_f32 v[164:165], v[132:133], v[76:77]
    v_pk_mul_f32 v[166:167], v[134:135], v[78:79]
    v_pk_mul_f32 v[168:169], v[136:137], v[80:81]
    v_pk_mul_f32 v[170:171], v[138:139], v[82:83]
    v_pk_fma_f32 v[164:165], v[124:125], v[84:85], v[164:165]
    v_pk_fma_f32 v[166:167], v[126:127], v[86:87], v[166:167]
    v_pk_fma_f32 v[168:169], v[128:129], v[88:89], v[168:169]
    v_pk_fma_f32 v[170:171], v[130:131], v[90:91], v[170:171]
    v_pk_fma_f32 v[164:165], v[116:117], v[92:93], v[164:165]
    v_pk_fma_f32 v[166:167], v[118:119], v[94:95], v[166:167]
    v_pk_fma_f32 v[168:169], v[120:121], v[96:97], v[168:169]
    v_pk_fma_f32 v[170:171], v[122:123], v[98:99], v[170:171]
    v_pk_fma_f32 v[164:165], v[108:109], v[100:101], v[164:165]
    v_pk_fma_f32 v[166:167], v[110:111], v[102:103], v[166:167]
    v_pk_fma_f32 v[168:169], v[112:113], v[104:105], v[168:169]
    v_pk_fma_f32 v[170:171], v[114:115], v[106:107], v[170:171]
    v_pk_mul_f32 v[172:173], v[140:141], v[76:77]
    v_pk_mul_f32 v[174:175], v[142:143], v[78:79]
    v_pk_mul_f32 v[176:177], v[144:145], v[80:81]
    v_pk_mul_f32 v[178:179], v[146:147], v[82:83]
    v_pk_fma_f32 v[172:173], v[132:133], v[84:85], v[172:173]
    v_pk_fma_f32 v[174:175], v[134:135], v[86:87], v[174:175]
    v_pk_fma_f32 v[176:177], v[136:137], v[88:89], v[176:177]
    v_pk_fma_f32 v[178:179], v[138:139], v[90:91], v[178:179]
    v_pk_fma_f32 v[172:173], v[124:125], v[92:93], v[172:173]
    v_pk_fma_f32 v[174:175], v[126:127], v[94:95], v[174:175]
    v_pk_fma_f32 v[176:177], v[128:129], v[96:97], v[176:177]
    v_pk_fma_f32 v[178:179], v[130:131], v[98:99], v[178:179]
    v_pk_fma_f32 v[172:173], v[116:117], v[100:101], v[172:173]
    v_pk_fma_f32 v[174:175], v[118:119], v[102:103], v[174:175]
    v_pk_fma_f32 v[176:177], v[120:121], v[104:105], v[176:177]
    v_pk_fma_f32 v[178:179], v[122:123], v[106:107], v[178:179]
    v_pk_mul_f32 v[180:181], v[148:149], v[76:77]
    v_pk_mul_f32 v[182:183], v[150:151], v[78:79]
    v_pk_mul_f32 v[184:185], v[152:153], v[80:81]
    v_pk_mul_f32 v[186:187], v[154:155], v[82:83]
    v_pk_fma_f32 v[180:181], v[140:141], v[84:85], v[180:181]
    v_pk_fma_f32 v[182:183], v[142:143], v[86:87], v[182:183]
    v_pk_fma_f32 v[184:185], v[144:145], v[88:89], v[184:185]
    v_pk_fma_f32 v[186:187], v[146:147], v[90:91], v[186:187]
    v_pk_fma_f32 v[180:181], v[132:133], v[92:93], v[180:181]
    v_pk_fma_f32 v[182:183], v[134:135], v[94:95], v[182:183]
    v_pk_fma_f32 v[184:185], v[136:137], v[96:97], v[184:185]
    v_pk_fma_f32 v[186:187], v[138:139], v[98:99], v[186:187]
    v_pk_fma_f32 v[180:181], v[124:125], v[100:101], v[180:181]
    v_pk_fma_f32 v[182:183], v[126:127], v[102:103], v[182:183]
    v_pk_fma_f32 v[184:185], v[128:129], v[104:105], v[184:185]
    v_pk_fma_f32 v[186:187], v[130:131], v[106:107], v[186:187]
    v_pk_mul_f32 v[188:189], v[156:157], v[76:77]
    v_pk_mul_f32 v[190:191], v[158:159], v[78:79]
    v_pk_mul_f32 v[192:193], v[160:161], v[80:81]
    v_pk_mul_f32 v[194:195], v[162:163], v[82:83]
    v_pk_fma_f32 v[188:189], v[148:149], v[84:85], v[188:189]
    v_pk_fma_f32 v[190:191], v[150:151], v[86:87], v[190:191]
    v_pk_fma_f32 v[192:193], v[152:153], v[88:89], v[192:193]
    v_pk_fma_f32 v[194:195], v[154:155], v[90:91], v[194:195]
    v_pk_fma_f32 v[188:189], v[140:141], v[92:93], v[188:189]
    v_pk_fma_f32 v[190:191], v[142:143], v[94:95], v[190:191]
    v_pk_fma_f32 v[192:193], v[144:145], v[96:97], v[192:193]
    v_pk_fma_f32 v[194:195], v[146:147], v[98:99], v[194:195]
    v_pk_fma_f32 v[188:189], v[132:133], v[100:101], v[188:189]
    v_pk_fma_f32 v[190:191], v[134:135], v[102:103], v[190:191]
    v_pk_fma_f32 v[192:193], v[136:137], v[104:105], v[192:193]
    v_pk_fma_f32 v[194:195], v[138:139], v[106:107], v[194:195]
    s_waitcnt vmcnt(3)
    v_lshlrev_b32 v196, 16, v44
    v_and_b32 v197, 0xffff0000, v44
    v_lshlrev_b32_e64 v198, 16, v45
    v_and_b32 v199, 0xffff0000, v45
    v_lshlrev_b32_e64 v200, 16, v46
    v_and_b32 v201, 0xffff0000, v46
    v_lshlrev_b32_e64 v202, 16, v47
    v_and_b32 v203, 0xffff0000, v47
    v_pk_mul_f32 v[164:165], v[164:165], v[196:197]
    v_pk_mul_f32 v[166:167], v[166:167], v[198:199]
    v_pk_mul_f32 v[168:169], v[168:169], v[200:201]
    v_pk_mul_f32 v[170:171], v[170:171], v[202:203]
    s_waitcnt vmcnt(2)
    v_lshlrev_b32 v196, 16, v48
    v_and_b32 v197, 0xffff0000, v48
    v_lshlrev_b32_e64 v198, 16, v49
    v_and_b32 v199, 0xffff0000, v49
    v_lshlrev_b32_e64 v200, 16, v50
    v_and_b32 v201, 0xffff0000, v50
    v_lshlrev_b32_e64 v202, 16, v51
    v_and_b32 v203, 0xffff0000, v51
    v_pk_mul_f32 v[172:173], v[172:173], v[196:197]
    v_pk_mul_f32 v[174:175], v[174:175], v[198:199]
    v_pk_mul_f32 v[176:177], v[176:177], v[200:201]
    v_pk_mul_f32 v[178:179], v[178:179], v[202:203]
    s_waitcnt vmcnt(1)
    v_lshlrev_b32 v196, 16, v52
    v_and_b32 v197, 0xffff0000, v52
    v_lshlrev_b32_e64 v198, 16, v53
    v_and_b32 v199, 0xffff0000, v53
    v_lshlrev_b32_e64 v200, 16, v54
    v_and_b32 v201, 0xffff0000, v54
    v_lshlrev_b32_e64 v202, 16, v55
    v_and_b32 v203, 0xffff0000, v55
    v_pk_mul_f32 v[180:181], v[180:181], v[196:197]
    v_pk_mul_f32 v[182:183], v[182:183], v[198:199]
    v_pk_mul_f32 v[184:185], v[184:185], v[200:201]
    v_pk_mul_f32 v[186:187], v[186:187], v[202:203]
    s_waitcnt vmcnt(0)
    v_lshlrev_b32 v196, 16, v56
    v_and_b32 v197, 0xffff0000, v56
    v_lshlrev_b32_e64 v198, 16, v57
    v_and_b32 v199, 0xffff0000, v57
    v_lshlrev_b32_e64 v200, 16, v58
    v_and_b32 v201, 0xffff0000, v58
    v_lshlrev_b32_e64 v202, 16, v59
    v_and_b32 v203, 0xffff0000, v59
    v_pk_mul_f32 v[188:189], v[188:189], v[196:197]
    v_pk_mul_f32 v[190:191], v[190:191], v[198:199]
    v_pk_mul_f32 v[192:193], v[192:193], v[200:201]
    v_pk_mul_f32 v[194:195], v[194:195], v[202:203]
    v_cvt_pk_bf16_f32 v16, v188, v180
    v_cvt_pk_bf16_f32 v17, v172, v164
    ds_write_b64 v8, v[16:17] offset:0
    v_cvt_pk_bf16_f32 v18, v189, v181
    v_cvt_pk_bf16_f32 v19, v173, v165
    ds_write_b64 v8, v[18:19] offset:128
    v_cvt_pk_bf16_f32 v20, v190, v182
    v_cvt_pk_bf16_f32 v21, v174, v166
    ds_write_b64 v8, v[20:21] offset:256
    v_cvt_pk_bf16_f32 v22, v191, v183
    v_cvt_pk_bf16_f32 v23, v175, v167
    ds_write_b64 v8, v[22:23] offset:384
    v_cvt_pk_bf16_f32 v24, v192, v184
    v_cvt_pk_bf16_f32 v25, v176, v168
    ds_write_b64 v8, v[24:25] offset:512
    v_cvt_pk_bf16_f32 v26, v193, v185
    v_cvt_pk_bf16_f32 v27, v177, v169
    ds_write_b64 v8, v[26:27] offset:640
    v_cvt_pk_bf16_f32 v28, v194, v186
    v_cvt_pk_bf16_f32 v29, v178, v170
    ds_write_b64 v8, v[28:29] offset:768
    v_cvt_pk_bf16_f32 v30, v195, v187
    v_cvt_pk_bf16_f32 v31, v179, v171
    ds_write_b64 v8, v[30:31] offset:896
    s_branch sequential_preLN__ssm_conv_h3__dense_activation_squared_relu__prompt_kernel_join
sequential_preLN__ssm_conv_h3__dense_activation_squared_relu__prompt_kernel_xw:
    s_nop 0
    s_memrealtime s[46:47]
    s_lshl_b32 s55, s2, 3
    s_lshl_b32 s54, s18, 1
    s_add_u32 s54, s54, s55
    s_lshl_b32 s55, s54, 11
    v_mov_b32 v124, 0
    s_waitcnt lgkmcnt(0)
    s_mov_b32 s24, s28
    s_mov_b32 s25, s29
    s_mov_b32 s26, 256
    s_mov_b32 s27, 0x20000
    s_mov_b32 s20, s4
    s_mov_b32 s21, s5
    s_cmp_lg_u32 s54, 0
    s_cbranch_scc1 sequential_preLN__ssm_conv_h3__dense_activation_squared_relu__prompt_kernel_non
    s_lshl_b32 s46, s46, 8
    s_or_b32 s46, s46, 1
    v_mov_b32 v122, s46
    s_mov_b64 exec, 1
    buffer_store_dword v122, v124, s[24:27], 0 offen sc1
    s_mov_b64 exec, -1
sequential_preLN__ssm_conv_h3__dense_activation_squared_relu__prompt_kernel_non:
    s_nop 0
    buffer_load_dwordx4 v[16:19], v7, s[20:23], 0 offen offset:0
    buffer_load_dwordx4 v[20:23], v7, s[20:23], 0 offen offset:2048
    buffer_load_dwordx4 v[24:27], v7, s[20:23], s44 offen offset:0
    buffer_load_dwordx4 v[28:31], v7, s[20:23], s44 offen offset:2048
    buffer_load_dword v122, v124, s[24:27], 0 offen sc1
    s_mov_b32 s4, s55
    s_nop 0
    buffer_load_dwordx4 v[144:147], v5, s[20:23], s4 offen offset:0
    buffer_load_dwordx4 v[148:151], v5, s[20:23], s4 offen offset:1024
    buffer_load_dwordx4 v[152:155], v5, s[20:23], s4 offen offset:2048
    buffer_load_dwordx4 v[156:159], v5, s[20:23], s4 offen offset:3072
    s_mov_b32 s12, s30
    s_mov_b32 s13, s31
    s_load_dwordx2 s[8:9], s[0:1], 56
    s_load_dwordx2 s[10:11], s[0:1], 72
    s_getpc_b64 s[56:57]
sequential_preLN__ssm_conv_h3__dense_activation_squared_relu__prompt_kernel_pc:
    s_nop 0
    s_add_u32 s56, s56, sequential_preLN__ssm_conv_h3__dense_activation_squared_relu__prompt_kernel_join-sequential_preLN__ssm_conv_h3__dense_activation_squared_relu__prompt_kernel_pc
    s_addc_u32 s57, s57, 0
    s_lshl_b32 s58, s16, 2
    s_add_u32 s58, s58, s18
    s_and_b32 s58, s58, 15
    s_lshl_b32 s58, s58, 12
    v_lshlrev_b32 v12, 6, v1
    v_add_u32_e64 v12, s58, v12
    v_min_u32 v12, code_end_lbl-sequential_preLN__ssm_conv_h3__dense_activation_squared_relu__prompt_kernel_join-4, v12
    global_load_dword v125, v12, s[56:57]
    s_mov_b32 s58, 0x05040100
    s_mov_b32 s59, 0x07060302
    s_lshl_b32 s53, s18, 1
    v_lshrrev_b32 v9, 1, v4
    v_add_u32 v9, s53, v9
    v_and_b32 v10, 7, v3
    v_xor_b32 v9, v9, v10
    v_lshlrev_b32 v8, 10, v3
    v_lshl_add_u32 v8, v9, 4, v8
    v_and_b32_e64 v9, 1, v4
    v_lshl_add_u32 v8, v9, 3, v8
    v_add_u32 v8, 101376, v8
    s_mov_b32 s5, s54
    s_waitcnt vmcnt(6)
    v_perm_b32 v128, v20, v16, s58
    v_perm_b32 v129, v28, v24, s58
    ds_write_b64 v8, v[128:129] offset:0
    v_perm_b32 v130, v20, v16, s59
    v_perm_b32 v131, v28, v24, s59
    ds_write_b64 v8, v[130:131] offset:128
    v_perm_b32 v132, v21, v17, s58
    v_perm_b32 v133, v29, v25, s58
    ds_write_b64 v8, v[132:133] offset:256
    v_perm_b32 v134, v21, v17, s59
    v_perm_b32 v135, v29, v25, s59
    ds_write_b64 v8, v[134:135] offset:384
    v_perm_b32 v136, v22, v18, s58
    v_perm_b32 v137, v30, v26, s58
    ds_write_b64 v8, v[136:137] offset:512
    v_perm_b32 v138, v22, v18, s59
    v_perm_b32 v139, v30, v26, s59
    ds_write_b64 v8, v[138:139] offset:640
    v_perm_b32 v140, v23, v19, s58
    v_perm_b32 v141, v31, v27, s58
    ds_write_b64 v8, v[140:141] offset:768
    v_perm_b32 v142, v23, v19, s59
    v_perm_b32 v143, v31, v27, s59
    ds_write_b64 v8, v[142:143] offset:896
    s_lshl_b32 s53, s18, 2
    s_nop 0
    s_add_u32 s53, s53, 150528
    v_mov_b32 v120, s53
    s_mov_b64 exec, 1
    ds_write_b32 v120, v124
    ds_write_b32 v120, v124 offset:32
    ds_write_b32 v120, v124 offset:48
    ds_write_b32 v120, v124 offset:64
    s_mov_b64 exec, -1
    s_cmp_lg_u32 s14, 4
    s_cbranch_scc1 sequential_preLN__ssm_conv_h3__dense_activation_squared_relu__prompt_kernel_join
    s_mov_b32 s61, 0
    s_waitcnt vmcnt(5)
sequential_preLN__ssm_conv_h3__dense_activation_squared_relu__prompt_kernel_nc:
    v_readfirstlane_b32 s47, v122
    s_nop 0
    s_cmp_lg_u32 s47, 0
    s_cbranch_scc1 sequential_preLN__ssm_conv_h3__dense_activation_squared_relu__prompt_kernel_nok
    s_nop 0
    buffer_load_dword v122, v124, s[24:27], 0 offen sc1
    s_add_u32 s61, s61, 1
    s_nop 0
    s_cmp_lt_u32 s61, 0x20000
    s_waitcnt vmcnt(0)
    s_cbranch_scc1 sequential_preLN__ssm_conv_h3__dense_activation_squared_relu__prompt_kernel_nc
sequential_preLN__ssm_conv_h3__dense_activation_squared_relu__prompt_kernel_nok:
    v_mov_b32 v120, 150544
    s_mov_b64 exec, 1
    s_nop 0
    ds_write_b32 v120, v122
    s_mov_b64 exec, -1
sequential_preLN__ssm_conv_h3__dense_activation_squared_relu__prompt_kernel_join:
    s_mov_b32 s36, s12
    s_mov_b32 s37, s13
    s_nop 0
    s_mov_b32 s38, 8388608
    s_mov_b32 s39, 0x20000
    s_lshl_b32 s53, s14, 12
    s_nop 0
    s_add_u32 s53, s53, 84992
    v_add_u32 v9, s53, v5
    s_lshr_b32 s53, s14, 2
    s_lshl_b32 s53, s53, 22
    s_lshl_b32 s54, s18, 5
    s_lshl_b32 s55, s15, 7
    s_add_u32 s54, s54, s55
    s_lshl_b32 s54, s54, 12
    s_add_u32 s53, s53, s54
    s_lshl_b32 s54, s16, 7
    s_add_u32 s53, s53, s54
    v_lshrrev_b32 v10, 3, v1
    v_lshlrev_b32 v10, 12, v10
    v_and_b32_e64 v11, 7, v1
    v_lshl_add_u32 v10, v11, 4, v10
    s_and_b32 s54, s18, 1
    s_lshl_b32 s54, s54, 6
    v_xor_b32_e64 v10, s54, v10
    v_mov_b32 v6, 150544
    s_add_u32 s54, s53, 32768
    s_add_u32 s55, s53, 65536
    s_add_u32 s56, s53, 98304
    s_waitcnt lgkmcnt(0)
    s_barrier
    ds_read_b128 v[16:19], v9 offset:0
    ds_read_b128 v[20:23], v9 offset:1024
    ds_read_b128 v[24:27], v9 offset:2048
    ds_read_b128 v[28:31], v9 offset:3072
    ds_read_b32 v14, v6
    v_xor_b32 v11, 16, v10
    v_xor_b32 v12, 32, v10
    v_xor_b32 v13, 48, v10
    s_waitcnt lgkmcnt(4)
    buffer_store_dwordx4 v[16:19], v10, s[36:39], s53 offen sc1
    s_waitcnt lgkmcnt(3)
    s_nop 0
    buffer_store_dwordx4 v[20:23], v11, s[36:39], s54 offen sc1
    s_waitcnt lgkmcnt(2)
    s_nop 0
    buffer_store_dwordx4 v[24:27], v12, s[36:39], s55 offen sc1
    s_waitcnt lgkmcnt(1)
    s_nop 0
    buffer_store_dwordx4 v[28:31], v13, s[36:39], s56 offen sc1
    s_getreg_b32 s60, hwreg(HW_REG_XCC_ID, 0, 4)
    s_lshl_b32 s60, s60, 4
    s_waitcnt lgkmcnt(0)
    v_or_b32 v14, s60, v14
    s_nop 0
    v_readfirstlane_b32 s47, v14
    s_nop 0
    s_mov_b32 s3, s47
    s_add_u32 s48, s12, 33554432
    s_addc_u32 s49, s13, 0
    s_nop 0
    s_mov_b32 s50, 65536
    s_mov_b32 s51, 0x20000
    s_lshl_b32 s58, s2, 8
    s_cmp_ge_u32 s14, 4
    s_cbranch_scc1 sequential_preLN__ssm_conv_h3__dense_activation_squared_relu__prompt_kernel_sp
    s_nop 0
    buffer_load_dwordx4 v[208:211], v5, s[20:23], s19 offen offset:0
    buffer_load_dwordx4 v[212:215], v5, s[20:23], s19 offen offset:1024
    buffer_load_dwordx4 v[216:219], v5, s[20:23], s19 offen offset:2048
    buffer_load_dwordx4 v[220:223], v5, s[20:23], s19 offen offset:3072
    s_mul_i32 s57, s14, 21248
    v_mov_b32 v34, 0
    v_mov_b32 v35, 0
    v_lshlrev_b32_e64 v33, 3, v1
    s_add_u32 s44, s57, 16640
    v_add_u32_e64 v33, s44, v33
    ds_write_b64 v33, v[34:35]
    v_bfe_u32 v33, v1, 3, 2
    v_mul_u32_u24 v33, 4160, v33
    v_and_b32_e64 v32, 7, v1
    v_lshl_add_u32 v33, v32, 2, v33
    v_add_u32_e64 v33, s57, v33
    ds_write_b32 v33, v34
    v_mov_b32 v176, 0
    v_mov_b32 v177, 0
    s_add_u32 s44, s57, 32
    v_add_u32 v15, s44, v5
    v_and_b32_e64 v8, 31, v1
    v_lshl_add_u32 v8, v8, 3, s15
    v_lshlrev_b32_e64 v8, 8, v8
    s_add_u32 s24, s12, s19
    s_addc_u32 s25, s13, 0
    s_mov_b32 s26, 4096
    s_mov_b32 s27, 0x20000
    s_add_u32 m0, s57, 17152
    s_waitcnt vmcnt(4)
    v_mov_b32 v40, 1
    s_mov_b64 exec, 1
    s_nop 0
    ds_add_rtn_u32 v41, v6, v40 offset:16
    s_mov_b64 exec, -1
    s_mov_b32 s61, 0
    s_waitcnt lgkmcnt(0)
    v_readfirstlane_b32 s62, v41
    s_nop 0
    s_mov_b32 s63, s62
    s_cmp_lg_u32 s62, 3
    s_cbranch_scc1 sequential_preLN__ssm_conv_h3__dense_activation_squared_relu__prompt_kernel_a1_n
    v_lshlrev_b32 v41, 2, v1
    s_mov_b32 exec_hi, 0
    buffer_store_dword v14, v41, s[48:51], s58 offen offset:0 sc1
    s_mov_b64 exec, -1
sequential_preLN__ssm_conv_h3__dense_activation_squared_relu__prompt_kernel_a1_n:
    s_waitcnt vmcnt(3)
    ds_write_b128 v15, v[208:211] offset:0
    v_mov_b32_dpp v176, v210 wave_shr:1 row_mask:0xf bank_mask:0xf
    v_mov_b32_dpp v177, v211 wave_shr:1 row_mask:0xf bank_mask:0xf
    v_alignbit_b32 v49, v209, v208, 16
    v_alignbit_b32 v50, v210, v209, 16
    v_alignbit_b32 v51, v211, v210, 16
    v_alignbit_b32 v48, v208, v177, 16
    ds_write_b128 v15, v[48:51] offset:4160
    v_mov_b32 v65, v208
    v_mov_b32 v66, v209
    v_mov_b32 v67, v210
    v_mov_b32 v64, v177
    ds_write_b128 v15, v[64:67] offset:8320
    v_alignbit_b32 v80, v177, v176, 16
    v_mov_b32 v81, v48
    v_mov_b32 v82, v49
    v_mov_b32_e64 v83, v50
    ds_write_b128 v15, v[80:83] offset:12480
    s_waitcnt vmcnt(2)
    s_nop 0
    ds_write_b128 v15, v[212:215] offset:1024
    v_mov_b32_dpp v178, v210 wave_ror:1 row_mask:0xf bank_mask:0xf
    v_mov_b32_dpp v179, v211 wave_ror:1 row_mask:0xf bank_mask:0xf
    s_nop 0
    s_nop 0
    v_mov_b32_dpp v178, v214 wave_shr:1 row_mask:0xf bank_mask:0xf
    v_mov_b32_dpp v179, v215 wave_shr:1 row_mask:0xf bank_mask:0xf
    v_alignbit_b32 v53, v213, v212, 16
    v_alignbit_b32 v54, v214, v213, 16
    v_alignbit_b32 v55, v215, v214, 16
    v_alignbit_b32 v52, v212, v179, 16
    ds_write_b128 v15, v[52:55] offset:5184
    v_mov_b32 v69, v212
    v_mov_b32 v70, v213
    v_mov_b32 v71, v214
    v_mov_b32 v68, v179
    ds_write_b128 v15, v[68:71] offset:9344
    v_alignbit_b32 v84, v179, v178, 16
    v_mov_b32 v85, v52
    v_mov_b32 v86, v53
    v_mov_b32_e64 v87, v54
    ds_write_b128 v15, v[84:87] offset:13504
    s_waitcnt vmcnt(1)
    s_nop 0
    ds_write_b128 v15, v[216:219] offset:2048
    v_mov_b32_dpp v180, v214 wave_ror:1 row_mask:0xf bank_mask:0xf
    v_mov_b32_dpp v181, v215 wave_ror:1 row_mask:0xf bank_mask:0xf
    s_nop 0
    s_nop 0
    v_mov_b32_dpp v180, v218 wave_shr:1 row_mask:0xf bank_mask:0xf
    v_mov_b32_dpp v181, v219 wave_shr:1 row_mask:0xf bank_mask:0xf
    v_alignbit_b32 v57, v217, v216, 16
    v_alignbit_b32 v58, v218, v217, 16
    v_alignbit_b32 v59, v219, v218, 16
    v_alignbit_b32 v56, v216, v181, 16
    ds_write_b128 v15, v[56:59] offset:6208
    v_mov_b32 v73, v216
    v_mov_b32 v74, v217
    v_mov_b32 v75, v218
    v_mov_b32 v72, v181
    ds_write_b128 v15, v[72:75] offset:10368
    v_alignbit_b32 v88, v181, v180, 16
    v_mov_b32 v89, v56
    v_mov_b32 v90, v57
    v_mov_b32_e64 v91, v58
    ds_write_b128 v15, v[88:91] offset:14528
    s_waitcnt vmcnt(0)
    s_nop 0
    ds_write_b128 v15, v[220:223] offset:3072
    v_mov_b32_dpp v182, v218 wave_ror:1 row_mask:0xf bank_mask:0xf
    v_mov_b32_dpp v183, v219 wave_ror:1 row_mask:0xf bank_mask:0xf
    s_nop 0
    s_nop 0
    v_mov_b32_dpp v182, v222 wave_shr:1 row_mask:0xf bank_mask:0xf
    v_mov_b32_dpp v183, v223 wave_shr:1 row_mask:0xf bank_mask:0xf
    v_alignbit_b32 v61, v221, v220, 16
    v_alignbit_b32 v62, v222, v221, 16
    v_alignbit_b32 v63, v223, v222, 16
    v_alignbit_b32 v60, v220, v183, 16
    ds_write_b128 v15, v[60:63] offset:7232
    v_mov_b32 v77, v220
    v_mov_b32 v78, v221
    v_mov_b32 v79, v222
    v_mov_b32 v76, v183
    ds_write_b128 v15, v[76:79] offset:11392
    v_alignbit_b32 v92, v183, v182, 16
    v_mov_b32 v93, v60
    v_mov_b32 v94, v61
    v_mov_b32_e64 v95, v62
    ds_write_b128 v15, v[92:95] offset:15552
    s_add_u32 s44, s19, 16777216
    s_add_u32 s32, s12, s44
    s_addc_u32 s33, s13, 0
    s_mov_b32 s34, 4096
    s_mov_b32 s35, 0x20000
    v_and_b32 v9, 3, v3
    v_sub_u32 v9, 3, v9
    v_mul_u32_u24 v13, 4160, v9
    v_lshrrev_b32_e64 v9, 2, v3
    v_lshl_add_u32 v13, v9, 3, v13
    v_lshlrev_b32 v9, 4, v4
    v_sub_u32 v13, v13, v9
    s_add_u32 s44, s57, 56
    v_add_u32 v13, s44, v13
    v_lshlrev_b32 v14, 5, v3
    v_add_u32 v14, v14, v9
    s_add_u32 s44, s57, 17120
    v_add_u32 v14, s44, v14
    v_mov_b32 v16, 0
    v_mov_b32 v17, 0
    v_mov_b32 v18, 0
    v_mov_b32 v19, 0
    v_mov_b32 v20, 0
    v_mov_b32 v21, 0
    v_mov_b32 v22, 0
    v_mov_b32 v23, 0
    v_mov_b32 v24, 0
    v_mov_b32 v25, 0
    v_mov_b32 v26, 0
    v_mov_b32 v27, 0
    v_mov_b32 v28, 0
    v_mov_b32 v29, 0
    v_mov_b32 v30, 0
    v_mov_b32 v31, 0
    v_mov_b32 v32, 0
    v_mov_b32 v33, 0
    v_mov_b32 v34, 0
    v_mov_b32 v35, 0
    v_mov_b32 v36, 0
    v_mov_b32 v37, 0
    v_mov_b32 v38, 0
    v_mov_b32 v39, 0
    v_mov_b32 v40, 0
    v_mov_b32 v41, 0
    v_mov_b32 v42, 0
    v_mov_b32 v43, 0
    v_mov_b32 v44, 0
    v_mov_b32 v45, 0
    v_mov_b32 v46, 0
    v_mov_b32 v47, 0
    s_waitcnt lgkmcnt(0)
    ds_read_b64 v[48:49], v13 offset:0
    ds_read_b64 v[50:51], v13 offset:8
    ds_read_b64 v[52:53], v13 offset:512
    ds_read_b64 v[54:55], v13 offset:520
    ds_read_b64 v[56:57], v13 offset:1024
    ds_read_b64 v[58:59], v13 offset:1032
    ds_read_b64 v[60:61], v13 offset:1536
    ds_read_b64 v[62:63], v13 offset:1544
    ds_read_b64 v[64:65], v13 offset:2048
    ds_read_b64 v[66:67], v13 offset:2056
    ds_read_b64 v[68:69], v13 offset:2560
    ds_read_b64 v[70:71], v13 offset:2568
    ds_read_b64 v[72:73], v13 offset:3072
    ds_read_b64 v[74:75], v13 offset:3080
    ds_read_b64 v[76:77], v13 offset:3584
    ds_read_b64 v[78:79], v13 offset:3592
    s_lshl_b32 s44, s14, 2
    v_add_u32 v6, s44, v6
    s_mov_b32 s61, 0
sequential_preLN__ssm_conv_h3__dense_activation_squared_relu__prompt_kernel_ul:
    s_nop 0
    ds_read_b32 v41, v6 offset:48
    s_add_u32 s61, s61, 1
    s_waitcnt lgkmcnt(0)
    v_readfirstlane_b32 s62, v41
    s_nop 0
    s_cmp_gt_u32 s61, 0x400000
    s_cbranch_scc1 sequential_preLN__ssm_conv_h3__dense_activation_squared_relu__prompt_kernel_ulx
    s_cmp_lt_u32 s62, 1
    s_cbranch_scc1 sequential_preLN__ssm_conv_h3__dense_activation_squared_relu__prompt_kernel_ul
sequential_preLN__ssm_conv_h3__dense_activation_squared_relu__prompt_kernel_ulx:
    s_nop 0
    v_mov_b32 v6, 150544
    ds_read_b128 v[80:83], v14 offset:0
    ds_read_b128 v[84:87], v14 offset:512
    ds_read_b128 v[88:91], v14 offset:1024
    ds_read_b128 v[92:95], v14 offset:1536
    ds_read_b128 v[96:99], v14 offset:2048
    ds_read_b128 v[100:103], v14 offset:2560
    ds_read_b128 v[104:107], v14 offset:3072
    ds_read_b128 v[108:111], v14 offset:3584
    s_mov_b32 s61, 0
sequential_preLN__ssm_conv_h3__dense_activation_squared_relu__prompt_kernel_loop:
    v_add_u32 v13, 64, v13
    v_subrev_u32 v14, 64, v14
    s_waitcnt lgkmcnt(0)
    v_mfma_f32_16x16x32_bf16 v[16:19], v[48:51], v[80:83], v[16:19]
    ds_read_b128 v[144:147], v14 offset:0
    v_mfma_f32_16x16x32_bf16 v[20:23], v[48:51], v[84:87], v[20:23]
    ds_read_b64 v[112:113], v13 offset:0
    v_mfma_f32_16x16x32_bf16 v[20:23], v[52:55], v[80:83], v[20:23]
    ds_read_b64 v[114:115], v13 offset:8
    v_mfma_f32_16x16x32_bf16 v[24:27], v[52:55], v[84:87], v[24:27]
    ds_read_b128 v[148:151], v14 offset:512
    v_mfma_f32_16x16x32_bf16 v[24:27], v[48:51], v[88:91], v[24:27]
    ds_read_b64 v[116:117], v13 offset:512
    v_mfma_f32_16x16x32_bf16 v[24:27], v[56:59], v[80:83], v[24:27]
    ds_read_b64 v[118:119], v13 offset:520
    v_mfma_f32_16x16x32_bf16 v[28:31], v[52:55], v[88:91], v[28:31]
    ds_read_b128 v[152:155], v14 offset:1024
    v_mfma_f32_16x16x32_bf16 v[28:31], v[56:59], v[84:87], v[28:31]
    ds_read_b64 v[120:121], v13 offset:1024
    v_mfma_f32_16x16x32_bf16 v[32:35], v[56:59], v[88:91], v[32:35]
    ds_read_b64 v[122:123], v13 offset:1032
    v_mfma_f32_16x16x32_bf16 v[28:31], v[48:51], v[92:95], v[28:31]
    ds_read_b128 v[156:159], v14 offset:1536
    v_mfma_f32_16x16x32_bf16 v[28:31], v[60:63], v[80:83], v[28:31]
    ds_read_b64 v[124:125], v13 offset:1536
    v_mfma_f32_16x16x32_bf16 v[32:35], v[52:55], v[92:95], v[32:35]
    ds_read_b64 v[126:127], v13 offset:1544
    v_mfma_f32_16x16x32_bf16 v[32:35], v[60:63], v[84:87], v[32:35]
    ds_read_b128 v[160:163], v14 offset:2048
    v_mfma_f32_16x16x32_bf16 v[36:39], v[56:59], v[92:95], v[36:39]
    ds_read_b64 v[128:129], v13 offset:2048
    v_mfma_f32_16x16x32_bf16 v[36:39], v[60:63], v[88:91], v[36:39]
    ds_read_b64 v[130:131], v13 offset:2056
    v_mfma_f32_16x16x32_bf16 v[40:43], v[60:63], v[92:95], v[40:43]
    ds_read_b128 v[164:167], v14 offset:2560
    v_mfma_f32_16x16x32_bf16 v[32:35], v[48:51], v[96:99], v[32:35]
    ds_read_b64 v[132:133], v13 offset:2560
    v_mfma_f32_16x16x32_bf16 v[32:35], v[64:67], v[80:83], v[32:35]
    ds_read_b64 v[134:135], v13 offset:2568
    v_mfma_f32_16x16x32_bf16 v[36:39], v[52:55], v[96:99], v[36:39]
    ds_read_b128 v[168:171], v14 offset:3072
    v_mfma_f32_16x16x32_bf16 v[36:39], v[64:67], v[84:87], v[36:39]
    ds_read_b64 v[136:137], v13 offset:3072
    v_mfma_f32_16x16x32_bf16 v[40:43], v[56:59], v[96:99], v[40:43]
    ds_read_b64 v[138:139], v13 offset:3080
    v_mfma_f32_16x16x32_bf16 v[40:43], v[64:67], v[88:91], v[40:43]
    ds_read_b128 v[172:175], v14 offset:3584
    v_mfma_f32_16x16x32_bf16 v[44:47], v[60:63], v[96:99], v[44:47]
    ds_read_b64 v[140:141], v13 offset:3584
    v_mfma_f32_16x16x32_bf16 v[44:47], v[64:67], v[92:95], v[44:47]
    ds_read_b64 v[142:143], v13 offset:3592
    v_mfma_f32_16x16x32_bf16 v[36:39], v[48:51], v[100:103], v[36:39]
    v_mfma_f32_16x16x32_bf16 v[36:39], v[68:71], v[80:83], v[36:39]
    v_mfma_f32_16x16x32_bf16 v[40:43], v[52:55], v[100:103], v[40:43]
    v_mfma_f32_16x16x32_bf16 v[40:43], v[68:71], v[84:87], v[40:43]
    v_mfma_f32_16x16x32_bf16 v[44:47], v[56:59], v[100:103], v[44:47]
    v_mfma_f32_16x16x32_bf16 v[44:47], v[68:71], v[88:91], v[44:47]
    v_mfma_f32_16x16x32_bf16 v[40:43], v[48:51], v[104:107], v[40:43]
    v_mfma_f32_16x16x32_bf16 v[40:43], v[72:75], v[80:83], v[40:43]
    v_mfma_f32_16x16x32_bf16 v[44:47], v[52:55], v[104:107], v[44:47]
    v_mfma_f32_16x16x32_bf16 v[44:47], v[72:75], v[84:87], v[44:47]
    v_mfma_f32_16x16x32_bf16 v[44:47], v[48:51], v[108:111], v[44:47]
    v_mfma_f32_16x16x32_bf16 v[44:47], v[76:79], v[80:83], v[44:47]
    v_add_u32_e64 v13, 64, v13
    v_subrev_u32 v14, 64, v14
    s_waitcnt lgkmcnt(0)
    v_mfma_f32_16x16x32_bf16 v[16:19], v[112:115], v[144:147], v[16:19]
    ds_read_b128 v[80:83], v14 offset:0
    v_mfma_f32_16x16x32_bf16 v[20:23], v[112:115], v[148:151], v[20:23]
    ds_read_b64 v[48:49], v13 offset:0
    v_mfma_f32_16x16x32_bf16 v[20:23], v[116:119], v[144:147], v[20:23]
    ds_read_b64 v[50:51], v13 offset:8
    v_mfma_f32_16x16x32_bf16 v[24:27], v[116:119], v[148:151], v[24:27]
    ds_read_b128 v[84:87], v14 offset:512
    v_mfma_f32_16x16x32_bf16 v[24:27], v[112:115], v[152:155], v[24:27]
    ds_read_b64 v[52:53], v13 offset:512
    v_mfma_f32_16x16x32_bf16 v[24:27], v[120:123], v[144:147], v[24:27]
    ds_read_b64 v[54:55], v13 offset:520
    v_mfma_f32_16x16x32_bf16 v[28:31], v[116:119], v[152:155], v[28:31]
    ds_read_b128 v[88:91], v14 offset:1024
    v_mfma_f32_16x16x32_bf16 v[28:31], v[120:123], v[148:151], v[28:31]
    ds_read_b64 v[56:57], v13 offset:1024
    v_mfma_f32_16x16x32_bf16 v[32:35], v[120:123], v[152:155], v[32:35]
    ds_read_b64 v[58:59], v13 offset:1032
    v_mfma_f32_16x16x32_bf16 v[28:31], v[112:115], v[156:159], v[28:31]
    ds_read_b128 v[92:95], v14 offset:1536
    v_mfma_f32_16x16x32_bf16 v[28:31], v[124:127], v[144:147], v[28:31]
    ds_read_b64 v[60:61], v13 offset:1536
    v_mfma_f32_16x16x32_bf16 v[32:35], v[116:119], v[156:159], v[32:35]
    ds_read_b64 v[62:63], v13 offset:1544
    v_mfma_f32_16x16x32_bf16 v[32:35], v[124:127], v[148:151], v[32:35]
    ds_read_b128 v[96:99], v14 offset:2048
    v_mfma_f32_16x16x32_bf16 v[36:39], v[120:123], v[156:159], v[36:39]
    ds_read_b64 v[64:65], v13 offset:2048
    v_mfma_f32_16x16x32_bf16 v[36:39], v[124:127], v[152:155], v[36:39]
    ds_read_b64 v[66:67], v13 offset:2056
    v_mfma_f32_16x16x32_bf16 v[40:43], v[124:127], v[156:159], v[40:43]
    ds_read_b128 v[100:103], v14 offset:2560
    v_mfma_f32_16x16x32_bf16 v[32:35], v[112:115], v[160:163], v[32:35]
    ds_read_b64 v[68:69], v13 offset:2560
    v_mfma_f32_16x16x32_bf16 v[32:35], v[128:131], v[144:147], v[32:35]
    ds_read_b64 v[70:71], v13 offset:2568
    v_mfma_f32_16x16x32_bf16 v[36:39], v[116:119], v[160:163], v[36:39]
    ds_read_b128 v[104:107], v14 offset:3072
    v_mfma_f32_16x16x32_bf16 v[36:39], v[128:131], v[148:151], v[36:39]
    ds_read_b64 v[72:73], v13 offset:3072
    v_mfma_f32_16x16x32_bf16 v[40:43], v[120:123], v[160:163], v[40:43]
    ds_read_b64 v[74:75], v13 offset:3080
    v_mfma_f32_16x16x32_bf16 v[40:43], v[128:131], v[152:155], v[40:43]
    ds_read_b128 v[108:111], v14 offset:3584
    v_mfma_f32_16x16x32_bf16 v[44:47], v[124:127], v[160:163], v[44:47]
    ds_read_b64 v[76:77], v13 offset:3584
    v_mfma_f32_16x16x32_bf16 v[44:47], v[128:131], v[156:159], v[44:47]
    ds_read_b64 v[78:79], v13 offset:3592
    v_mfma_f32_16x16x32_bf16 v[36:39], v[112:115], v[164:167], v[36:39]
    v_mfma_f32_16x16x32_bf16 v[36:39], v[132:135], v[144:147], v[36:39]
    v_mfma_f32_16x16x32_bf16 v[40:43], v[116:119], v[164:167], v[40:43]
    v_mfma_f32_16x16x32_bf16 v[40:43], v[132:135], v[148:151], v[40:43]
    v_mfma_f32_16x16x32_bf16 v[44:47], v[120:123], v[164:167], v[44:47]
    v_mfma_f32_16x16x32_bf16 v[44:47], v[132:135], v[152:155], v[44:47]
    v_mfma_f32_16x16x32_bf16 v[40:43], v[112:115], v[168:171], v[40:43]
    v_mfma_f32_16x16x32_bf16 v[40:43], v[136:139], v[144:147], v[40:43]
    v_mfma_f32_16x16x32_bf16 v[44:47], v[116:119], v[168:171], v[44:47]
    v_mfma_f32_16x16x32_bf16 v[44:47], v[136:139], v[148:151], v[44:47]
    v_mfma_f32_16x16x32_bf16 v[44:47], v[112:115], v[172:175], v[44:47]
    v_mfma_f32_16x16x32_bf16 v[44:47], v[140:143], v[144:147], v[44:47]
    s_add_u32 s61, s61, 1
    s_cmp_lt_u32 s61, 3
    s_cbranch_scc1 sequential_preLN__ssm_conv_h3__dense_activation_squared_relu__prompt_kernel_loop
    s_and_b32 s44, s17, 1
    s_lshl_b32 s44, s44, 4
    s_lshr_b32 s45, s45, s44
    s_lshl_b32 s46, s45, 16
    s_mov_b32 s47, s46
    v_lshlrev_b32_e64 v9, 6, v3
    v_lshl_add_u32 v9, v4, 4, v9
    v_add_u32 v9, 101376, v9
    v_lshlrev_b32 v10, 5, v3
    v_lshrrev_b32 v11, 1, v4
    v_lshl_add_u32 v10, v11, 4, v10
    v_and_b32 v11, 1, v4
    v_lshlrev_b32 v11, 3, v11
    v_sub_u32_e64 v10, v10, v11
    s_add_u32 s44, s57, 17160
    v_add_u32 v10, s44, v10
    v_lshlrev_b32 v8, 5, v3
    v_lshl_add_u32 v8, v4, 3, v8
    s_lshl_b32 s44, s14, 12
    s_nop 0
    s_add_u32 s44, s44, 84992
    v_add_u32 v8, s44, v8
    v_lshlrev_b32 v11, 5, v3
    v_and_b32_e64 v12, 1, v4
    v_lshl_add_u32 v11, v12, 9, v11
    v_lshrrev_b32_e64 v12, 1, v4
    v_lshl_add_u32 v11, v12, 4, v11
    v_mov_b32 v7, 150528
    v_add_u32_e64 v13, 64, v13
    v_subrev_u32 v14, 64, v14
    s_waitcnt lgkmcnt(0)
    v_mfma_f32_16x16x32_bf16 v[16:19], v[48:51], v[80:83], v[16:19]
    ds_read_b128 v[144:147], v14 offset:0
    v_mfma_f32_16x16x32_bf16 v[20:23], v[48:51], v[84:87], v[20:23]
    ds_read_b64 v[112:113], v13 offset:0
    v_mfma_f32_16x16x32_bf16 v[20:23], v[52:55], v[80:83], v[20:23]
    ds_read_b64 v[114:115], v13 offset:8
    v_mfma_f32_16x16x32_bf16 v[24:27], v[52:55], v[84:87], v[24:27]
    ds_read_b128 v[148:151], v14 offset:512
    v_mfma_f32_16x16x32_bf16 v[24:27], v[48:51], v[88:91], v[24:27]
    ds_read_b64 v[116:117], v13 offset:512
    v_mfma_f32_16x16x32_bf16 v[24:27], v[56:59], v[80:83], v[24:27]
    ds_read_b64 v[118:119], v13 offset:520
    v_mfma_f32_16x16x32_bf16 v[28:31], v[52:55], v[88:91], v[28:31]
    ds_read_b128 v[152:155], v14 offset:1024
    v_mfma_f32_16x16x32_bf16 v[28:31], v[56:59], v[84:87], v[28:31]
    ds_read_b64 v[120:121], v13 offset:1024
    v_mfma_f32_16x16x32_bf16 v[32:35], v[56:59], v[88:91], v[32:35]
    ds_read_b64 v[122:123], v13 offset:1032
    v_mfma_f32_16x16x32_bf16 v[28:31], v[48:51], v[92:95], v[28:31]
    ds_read_b128 v[156:159], v14 offset:1536
    v_mfma_f32_16x16x32_bf16 v[28:31], v[60:63], v[80:83], v[28:31]
    ds_read_b64 v[124:125], v13 offset:1536
    v_mfma_f32_16x16x32_bf16 v[32:35], v[52:55], v[92:95], v[32:35]
    ds_read_b64 v[126:127], v13 offset:1544
    v_mfma_f32_16x16x32_bf16 v[32:35], v[60:63], v[84:87], v[32:35]
    ds_read_b128 v[160:163], v14 offset:2048
    v_mfma_f32_16x16x32_bf16 v[36:39], v[56:59], v[92:95], v[36:39]
    ds_read_b64 v[128:129], v13 offset:2048
    v_mfma_f32_16x16x32_bf16 v[36:39], v[60:63], v[88:91], v[36:39]
    ds_read_b64 v[130:131], v13 offset:2056
    v_mfma_f32_16x16x32_bf16 v[40:43], v[60:63], v[92:95], v[40:43]
    ds_read_b128 v[164:167], v14 offset:2560
    v_mfma_f32_16x16x32_bf16 v[32:35], v[48:51], v[96:99], v[32:35]
    ds_read_b64 v[132:133], v13 offset:2560
    v_mfma_f32_16x16x32_bf16 v[32:35], v[64:67], v[80:83], v[32:35]
    ds_read_b64 v[134:135], v13 offset:2568
    v_mfma_f32_16x16x32_bf16 v[36:39], v[52:55], v[96:99], v[36:39]
    ds_read_b128 v[168:171], v14 offset:3072
    v_mfma_f32_16x16x32_bf16 v[36:39], v[64:67], v[84:87], v[36:39]
    ds_read_b64 v[136:137], v13 offset:3072
    v_mfma_f32_16x16x32_bf16 v[40:43], v[56:59], v[96:99], v[40:43]
    ds_read_b64 v[138:139], v13 offset:3080
    v_mfma_f32_16x16x32_bf16 v[40:43], v[64:67], v[88:91], v[40:43]
    ds_read_b128 v[172:175], v14 offset:3584
    v_mfma_f32_16x16x32_bf16 v[44:47], v[60:63], v[96:99], v[44:47]
    ds_read_b64 v[140:141], v13 offset:3584
    v_mfma_f32_16x16x32_bf16 v[44:47], v[64:67], v[92:95], v[44:47]
    ds_read_b64 v[142:143], v13 offset:3592
    v_mfma_f32_16x16x32_bf16 v[36:39], v[48:51], v[100:103], v[36:39]
    ds_read_b128 v[208:211], v7
    v_mfma_f32_16x16x32_bf16 v[36:39], v[68:71], v[80:83], v[36:39]
    v_mfma_f32_16x16x32_bf16 v[40:43], v[52:55], v[100:103], v[40:43]
    v_mfma_f32_16x16x32_bf16 v[40:43], v[68:71], v[84:87], v[40:43]
    v_mfma_f32_16x16x32_bf16 v[44:47], v[56:59], v[100:103], v[44:47]
    v_mfma_f32_16x16x32_bf16 v[44:47], v[68:71], v[88:91], v[44:47]
    v_mfma_f32_16x16x32_bf16 v[40:43], v[48:51], v[104:107], v[40:43]
    v_mfma_f32_16x16x32_bf16 v[40:43], v[72:75], v[80:83], v[40:43]
    v_mfma_f32_16x16x32_bf16 v[44:47], v[52:55], v[104:107], v[44:47]
    v_mfma_f32_16x16x32_bf16 v[44:47], v[72:75], v[84:87], v[44:47]
    v_mfma_f32_16x16x32_bf16 v[44:47], v[48:51], v[108:111], v[44:47]
    v_mfma_f32_16x16x32_bf16 v[44:47], v[76:79], v[80:83], v[44:47]
    s_waitcnt lgkmcnt(0)
sequential_preLN__ssm_conv_h3__dense_activation_squared_relu__prompt_kernel_chk:
    v_and_b32 v208, v208, v209
    v_and_b32_e64 v210, v210, v211
    v_and_b32 v208, v208, v210
    s_nop 0
    v_readfirstlane_b32 s44, v208
    s_nop 0
    s_cmp_eq_u32 s44, 1
    s_cbranch_scc0 sequential_preLN__ssm_conv_h3__dense_activation_squared_relu__prompt_kernel_spin
sequential_preLN__ssm_conv_h3__dense_activation_squared_relu__prompt_kernel_go:
    v_mfma_f32_16x16x32_bf16 v[16:19], v[112:115], v[144:147], v[16:19]
    ds_read_b128 v[48:51], v9 offset:0
    v_mfma_f32_16x16x32_bf16 v[20:23], v[112:115], v[148:151], v[20:23]
    ds_read_b128 v[80:83], v9 offset:8192
    v_mfma_f32_16x16x32_bf16 v[20:23], v[116:119], v[144:147], v[20:23]
    ds_read_b64 v[176:177], v10 offset:0
    v_mfma_f32_16x16x32_bf16 v[24:27], v[112:115], v[152:155], v[24:27]
    ds_read_b64 v[192:193], v8 offset:0
    v_mfma_f32_16x16x32_bf16 v[24:27], v[116:119], v[148:151], v[24:27]
    ds_read_b128 v[52:55], v9 offset:1024
    v_mfma_f32_16x16x32_bf16 v[24:27], v[120:123], v[144:147], v[24:27]
    ds_read_b128 v[84:87], v9 offset:9216
    v_mfma_f32_16x16x32_bf16 v[28:31], v[112:115], v[156:159], v[28:31]
    ds_read_b64 v[178:179], v10 offset:512
    v_mfma_f32_16x16x32_bf16 v[28:31], v[116:119], v[152:155], v[28:31]
    ds_read_b64 v[194:195], v8 offset:512
    v_mfma_f32_16x16x32_bf16 v[28:31], v[120:123], v[148:151], v[28:31]
    ds_read_b128 v[56:59], v9 offset:2048
    v_mfma_f32_16x16x32_bf16 v[28:31], v[124:127], v[144:147], v[28:31]
    ds_read_b128 v[88:91], v9 offset:10240
    v_mfma_f32_16x16x32_bf16 v[32:35], v[112:115], v[160:163], v[32:35]
    ds_read_b64 v[180:181], v10 offset:1024
    v_mfma_f32_16x16x32_bf16 v[32:35], v[116:119], v[156:159], v[32:35]
    ds_read_b64 v[196:197], v8 offset:1024
    v_mfma_f32_16x16x32_bf16 v[32:35], v[120:123], v[152:155], v[32:35]
    ds_read_b128 v[60:63], v9 offset:3072
    v_mfma_f32_16x16x32_bf16 v[32:35], v[124:127], v[148:151], v[32:35]
    ds_read_b128 v[92:95], v9 offset:11264
    v_mfma_f32_16x16x32_bf16 v[32:35], v[128:131], v[144:147], v[32:35]
    ds_read_b64 v[182:183], v10 offset:1536
    v_mfma_f32_16x16x32_bf16 v[36:39], v[112:115], v[164:167], v[36:39]
    ds_read_b64 v[198:199], v8 offset:1536
    v_mfma_f32_16x16x32_bf16 v[36:39], v[116:119], v[160:163], v[36:39]
    ds_read_b128 v[64:67], v9 offset:4096
    v_mfma_f32_16x16x32_bf16 v[36:39], v[120:123], v[156:159], v[36:39]
    ds_read_b128 v[96:99], v9 offset:12288
    v_mfma_f32_16x16x32_bf16 v[36:39], v[124:127], v[152:155], v[36:39]
    ds_read_b64 v[184:185], v10 offset:2048
    v_mfma_f32_16x16x32_bf16 v[36:39], v[128:131], v[148:151], v[36:39]
    ds_read_b64 v[200:201], v8 offset:2048
    v_mfma_f32_16x16x32_bf16 v[36:39], v[132:135], v[144:147], v[36:39]
    ds_read_b128 v[68:71], v9 offset:5120
    v_mfma_f32_16x16x32_bf16 v[40:43], v[112:115], v[168:171], v[40:43]
    ds_read_b128 v[100:103], v9 offset:13312
    v_mfma_f32_16x16x32_bf16 v[40:43], v[116:119], v[164:167], v[40:43]
    ds_read_b64 v[186:187], v10 offset:2560
    v_mfma_f32_16x16x32_bf16 v[40:43], v[120:123], v[160:163], v[40:43]
    ds_read_b64 v[202:203], v8 offset:2560
    v_mfma_f32_16x16x32_bf16 v[40:43], v[124:127], v[156:159], v[40:43]
    ds_read_b128 v[72:75], v9 offset:6144
    v_mfma_f32_16x16x32_bf16 v[40:43], v[128:131], v[152:155], v[40:43]
    ds_read_b128 v[104:107], v9 offset:14336
    v_mfma_f32_16x16x32_bf16 v[40:43], v[132:135], v[148:151], v[40:43]
    ds_read_b64 v[188:189], v10 offset:3072
    v_mfma_f32_16x16x32_bf16 v[40:43], v[136:139], v[144:147], v[40:43]
    ds_read_b64 v[204:205], v8 offset:3072
    v_mfma_f32_16x16x32_bf16 v[44:47], v[112:115], v[172:175], v[44:47]
    ds_read_b128 v[76:79], v9 offset:7168
    v_mfma_f32_16x16x32_bf16 v[44:47], v[116:119], v[168:171], v[44:47]
    ds_read_b128 v[108:111], v9 offset:15360
    v_mfma_f32_16x16x32_bf16 v[44:47], v[120:123], v[164:167], v[44:47]
    ds_read_b64 v[190:191], v10 offset:3584
    v_mfma_f32_16x16x32_bf16 v[44:47], v[124:127], v[160:163], v[44:47]
    ds_read_b64 v[206:207], v8 offset:3584
    v_mfma_f32_16x16x32_bf16 v[44:47], v[128:131], v[156:159], v[44:47]
    v_mfma_f32_16x16x32_bf16 v[44:47], v[132:135], v[152:155], v[44:47]
    v_mfma_f32_16x16x32_bf16 v[44:47], v[136:139], v[148:151], v[44:47]
    v_mfma_f32_16x16x32_bf16 v[44:47], v[140:143], v[144:147], v[44:47]
    s_waitcnt lgkmcnt(0)
    s_nop 0
    v_and_b32 v208, 0xffff0000, v177
    v_lshlrev_b32_e64 v209, 16, v177
    v_and_b32 v210, 0xffff0000, v176
    v_lshlrev_b32 v211, 16, v176
    v_lshlrev_b32 v212, 16, v192
    v_and_b32 v213, 0xffff0000, v192
    v_lshlrev_b32_e64 v214, 16, v193
    v_and_b32 v215, 0xffff0000, v193
    v_pk_fma_f32 v[16:17], v[208:209], s[46:47], v[16:17]
    v_pk_add_f32 v[216:217], v[212:213], v[48:49] neg_lo:[0,1] neg_hi:[0,1]
    v_pk_fma_f32 v[18:19], v[210:211], s[46:47], v[18:19]
    v_pk_add_f32 v[218:219], v[214:215], v[50:51] neg_lo:[0,1] neg_hi:[0,1]
    v_pk_mul_f32 v[216:217], v[216:217], v[80:81]
    v_pk_mul_f32 v[218:219], v[218:219], v[82:83]
    v_pk_fma_f32 v[16:17], v[216:217], v[16:17], v[212:213]
    v_pk_fma_f32 v[18:19], v[218:219], v[18:19], v[214:215]
    v_cvt_pk_bf16_f32 v224, v16, v17
    v_cvt_pk_bf16_f32 v225, v18, v19
    v_and_b32 v208, 0xffff0000, v179
    v_lshlrev_b32_e64 v209, 16, v179
    v_and_b32 v210, 0xffff0000, v178
    v_lshlrev_b32 v211, 16, v178
    v_lshlrev_b32 v212, 16, v194
    v_and_b32 v213, 0xffff0000, v194
    v_lshlrev_b32_e64 v214, 16, v195
    v_and_b32 v215, 0xffff0000, v195
    v_pk_fma_f32 v[20:21], v[208:209], s[46:47], v[20:21]
    v_pk_add_f32 v[216:217], v[212:213], v[52:53] neg_lo:[0,1] neg_hi:[0,1]
    v_pk_fma_f32 v[22:23], v[210:211], s[46:47], v[22:23]
    v_pk_add_f32 v[218:219], v[214:215], v[54:55] neg_lo:[0,1] neg_hi:[0,1]
    v_pk_mul_f32 v[216:217], v[216:217], v[84:85]
    v_pk_mul_f32 v[218:219], v[218:219], v[86:87]
    v_pk_fma_f32 v[20:21], v[216:217], v[20:21], v[212:213]
    v_pk_fma_f32 v[22:23], v[218:219], v[22:23], v[214:215]
    v_cvt_pk_bf16_f32 v226, v20, v21
    v_cvt_pk_bf16_f32 v227, v22, v23
    s_nop 1
    s_nop 0
    v_permlane16_swap_b32 v224, v226
    v_permlane16_swap_b32 v225, v227
    buffer_store_dwordx4 v[224:227], v11, s[32:35], 0 offen offset:0 sc1
    v_and_b32 v208, 0xffff0000, v181
    v_lshlrev_b32_e64 v209, 16, v181
    v_and_b32 v210, 0xffff0000, v180
    v_lshlrev_b32 v211, 16, v180
    v_lshlrev_b32 v212, 16, v196
    v_and_b32 v213, 0xffff0000, v196
    v_lshlrev_b32_e64 v214, 16, v197
    v_and_b32 v215, 0xffff0000, v197
    v_pk_fma_f32 v[24:25], v[208:209], s[46:47], v[24:25]
    v_pk_add_f32 v[216:217], v[212:213], v[56:57] neg_lo:[0,1] neg_hi:[0,1]
    v_pk_fma_f32 v[26:27], v[210:211], s[46:47], v[26:27]
    v_pk_add_f32 v[218:219], v[214:215], v[58:59] neg_lo:[0,1] neg_hi:[0,1]
    v_pk_mul_f32 v[216:217], v[216:217], v[88:89]
    v_pk_mul_f32 v[218:219], v[218:219], v[90:91]
    v_pk_fma_f32 v[24:25], v[216:217], v[24:25], v[212:213]
    v_pk_fma_f32 v[26:27], v[218:219], v[26:27], v[214:215]
    v_cvt_pk_bf16_f32 v228, v24, v25
    v_cvt_pk_bf16_f32 v229, v26, v27
    v_and_b32 v208, 0xffff0000, v183
    v_lshlrev_b32_e64 v209, 16, v183
    v_and_b32 v210, 0xffff0000, v182
    v_lshlrev_b32 v211, 16, v182
    v_lshlrev_b32 v212, 16, v198
    v_and_b32 v213, 0xffff0000, v198
    v_lshlrev_b32_e64 v214, 16, v199
    v_and_b32 v215, 0xffff0000, v199
    v_pk_fma_f32 v[28:29], v[208:209], s[46:47], v[28:29]
    v_pk_add_f32 v[216:217], v[212:213], v[60:61] neg_lo:[0,1] neg_hi:[0,1]
    v_pk_fma_f32 v[30:31], v[210:211], s[46:47], v[30:31]
    v_pk_add_f32 v[218:219], v[214:215], v[62:63] neg_lo:[0,1] neg_hi:[0,1]
    v_pk_mul_f32 v[216:217], v[216:217], v[92:93]
    v_pk_mul_f32 v[218:219], v[218:219], v[94:95]
    v_pk_fma_f32 v[28:29], v[216:217], v[28:29], v[212:213]
    v_pk_fma_f32 v[30:31], v[218:219], v[30:31], v[214:215]
    v_cvt_pk_bf16_f32 v230, v28, v29
    v_cvt_pk_bf16_f32 v231, v30, v31
    s_nop 1
    s_nop 0
    v_permlane16_swap_b32 v228, v230
    v_permlane16_swap_b32 v229, v231
    buffer_store_dwordx4 v[228:231], v11, s[32:35], 0 offen offset:1024 sc1
    v_and_b32 v208, 0xffff0000, v185
    v_lshlrev_b32_e64 v209, 16, v185
    v_and_b32 v210, 0xffff0000, v184
    v_lshlrev_b32 v211, 16, v184
    v_lshlrev_b32 v212, 16, v200
    v_and_b32 v213, 0xffff0000, v200
    v_lshlrev_b32_e64 v214, 16, v201
    v_and_b32 v215, 0xffff0000, v201
    v_pk_fma_f32 v[32:33], v[208:209], s[46:47], v[32:33]
    v_pk_add_f32 v[216:217], v[212:213], v[64:65] neg_lo:[0,1] neg_hi:[0,1]
    v_pk_fma_f32 v[34:35], v[210:211], s[46:47], v[34:35]
    v_pk_add_f32 v[218:219], v[214:215], v[66:67] neg_lo:[0,1] neg_hi:[0,1]
    v_pk_mul_f32 v[216:217], v[216:217], v[96:97]
    v_pk_mul_f32 v[218:219], v[218:219], v[98:99]
    v_pk_fma_f32 v[32:33], v[216:217], v[32:33], v[212:213]
    v_pk_fma_f32 v[34:35], v[218:219], v[34:35], v[214:215]
    v_cvt_pk_bf16_f32 v224, v32, v33
    v_cvt_pk_bf16_f32 v225, v34, v35
    v_and_b32 v208, 0xffff0000, v187
    v_lshlrev_b32_e64 v209, 16, v187
    v_and_b32 v210, 0xffff0000, v186
    v_lshlrev_b32 v211, 16, v186
    v_lshlrev_b32 v212, 16, v202
    v_and_b32 v213, 0xffff0000, v202
    v_lshlrev_b32_e64 v214, 16, v203
    v_and_b32 v215, 0xffff0000, v203
    v_pk_fma_f32 v[36:37], v[208:209], s[46:47], v[36:37]
    v_pk_add_f32 v[216:217], v[212:213], v[68:69] neg_lo:[0,1] neg_hi:[0,1]
    v_pk_fma_f32 v[38:39], v[210:211], s[46:47], v[38:39]
    v_pk_add_f32 v[218:219], v[214:215], v[70:71] neg_lo:[0,1] neg_hi:[0,1]
    v_pk_mul_f32 v[216:217], v[216:217], v[100:101]
    v_pk_mul_f32 v[218:219], v[218:219], v[102:103]
    v_pk_fma_f32 v[36:37], v[216:217], v[36:37], v[212:213]
    v_pk_fma_f32 v[38:39], v[218:219], v[38:39], v[214:215]
    v_cvt_pk_bf16_f32 v226, v36, v37
    v_cvt_pk_bf16_f32 v227, v38, v39
    s_nop 1
    s_nop 0
    v_permlane16_swap_b32 v224, v226
    v_permlane16_swap_b32 v225, v227
    buffer_store_dwordx4 v[224:227], v11, s[32:35], 0 offen offset:2048 sc1
    v_and_b32 v208, 0xffff0000, v189
    v_lshlrev_b32_e64 v209, 16, v189
    v_and_b32 v210, 0xffff0000, v188
    v_lshlrev_b32 v211, 16, v188
    v_lshlrev_b32 v212, 16, v204
    v_and_b32 v213, 0xffff0000, v204
    v_lshlrev_b32_e64 v214, 16, v205
    v_and_b32 v215, 0xffff0000, v205
    v_pk_fma_f32 v[40:41], v[208:209], s[46:47], v[40:41]
    v_pk_add_f32 v[216:217], v[212:213], v[72:73] neg_lo:[0,1] neg_hi:[0,1]
    v_pk_fma_f32 v[42:43], v[210:211], s[46:47], v[42:43]
    v_pk_add_f32 v[218:219], v[214:215], v[74:75] neg_lo:[0,1] neg_hi:[0,1]
    v_pk_mul_f32 v[216:217], v[216:217], v[104:105]
    v_pk_mul_f32 v[218:219], v[218:219], v[106:107]
    v_pk_fma_f32 v[40:41], v[216:217], v[40:41], v[212:213]
    v_pk_fma_f32 v[42:43], v[218:219], v[42:43], v[214:215]
    v_cvt_pk_bf16_f32 v228, v40, v41
    v_cvt_pk_bf16_f32 v229, v42, v43
    v_and_b32 v208, 0xffff0000, v191
    v_lshlrev_b32_e64 v209, 16, v191
    v_and_b32 v210, 0xffff0000, v190
    v_lshlrev_b32 v211, 16, v190
    v_lshlrev_b32 v212, 16, v206
    v_and_b32 v213, 0xffff0000, v206
    v_lshlrev_b32_e64 v214, 16, v207
    v_and_b32 v215, 0xffff0000, v207
    v_pk_fma_f32 v[44:45], v[208:209], s[46:47], v[44:45]
    v_pk_add_f32 v[216:217], v[212:213], v[76:77] neg_lo:[0,1] neg_hi:[0,1]
    v_pk_fma_f32 v[46:47], v[210:211], s[46:47], v[46:47]
    v_pk_add_f32 v[218:219], v[214:215], v[78:79] neg_lo:[0,1] neg_hi:[0,1]
    v_pk_mul_f32 v[216:217], v[216:217], v[108:109]
    v_pk_mul_f32 v[218:219], v[218:219], v[110:111]
    v_pk_fma_f32 v[44:45], v[216:217], v[44:45], v[212:213]
    v_pk_fma_f32 v[46:47], v[218:219], v[46:47], v[214:215]
    v_cvt_pk_bf16_f32 v230, v44, v45
    v_cvt_pk_bf16_f32 v231, v46, v47
    s_nop 1
    s_nop 0
    v_permlane16_swap_b32 v228, v230
    v_permlane16_swap_b32 v229, v231
    buffer_store_dwordx4 v[228:231], v11, s[32:35], 0 offen offset:3072 sc1
    s_add_u32 s48, s12, 33685504
    s_addc_u32 s49, s13, 0
    s_nop 0
    s_mov_b32 s50, 65536
    s_mov_b32 s51, 0x20000
    v_mov_b32 v6, 150544
    v_mov_b32 v40, 1
    v_mov_b32 v14, s3
    s_lshl_b32 s58, s2, 8
    s_mov_b64 exec, 1
    ds_add_u32 v6, v40 offset:36
    s_waitcnt vmcnt(0)
    s_nop 0
    ds_add_rtn_u32 v41, v6, v40 offset:44
    s_mov_b64 exec, -1
    s_waitcnt lgkmcnt(0)
    v_readfirstlane_b32 s62, v41
    s_nop 0
    s_cmp_lg_u32 s62, 3
    s_cbranch_scc1 sequential_preLN__ssm_conv_h3__dense_activation_squared_relu__prompt_kernel_hn
    v_lshlrev_b32 v41, 2, v1
    s_mov_b32 exec_hi, 0
    buffer_store_dword v14, v41, s[48:51], s58 offen sc1
    s_mov_b64 exec, -1
sequential_preLN__ssm_conv_h3__dense_activation_squared_relu__prompt_kernel_hn:
    s_branch sequential_preLN__ssm_conv_h3__dense_activation_squared_relu__prompt_kernel_tr
sequential_preLN__ssm_conv_h3__dense_activation_squared_relu__prompt_kernel_spin:
    s_sleep 1
    s_add_u32 s61, s61, 1
    s_cmp_gt_u32 s61, 0x100000
    s_cbranch_scc1 sequential_preLN__ssm_conv_h3__dense_activation_squared_relu__prompt_kernel_go
    s_nop 0
    ds_read_b128 v[208:211], v7
    s_waitcnt lgkmcnt(0)
    s_branch sequential_preLN__ssm_conv_h3__dense_activation_squared_relu__prompt_kernel_chk
sequential_preLN__ssm_conv_h3__dense_activation_squared_relu__prompt_kernel_sp:
    s_add_u32 s24, s12, 31457280
    s_addc_u32 s25, s13, 0
    s_nop 0
    s_mov_b32 s26, 16384
    s_mov_b32 s27, 0x20000
    s_waitcnt vmcnt(5)
    v_lshlrev_b32 v64, 16, v144
    v_and_b32 v65, 0xffff0000, v144
    v_lshlrev_b32_e64 v66, 16, v145
    v_and_b32 v67, 0xffff0000, v145
    v_lshlrev_b32_e64 v68, 16, v146
    v_and_b32 v69, 0xffff0000, v146
    v_lshlrev_b32_e64 v70, 16, v147
    v_and_b32 v71, 0xffff0000, v147
    v_lshlrev_b32_e64 v72, 16, v148
    v_and_b32 v73, 0xffff0000, v148
    v_lshlrev_b32_e64 v74, 16, v149
    v_and_b32 v75, 0xffff0000, v149
    v_lshlrev_b32_e64 v76, 16, v150
    v_and_b32 v77, 0xffff0000, v150
    v_lshlrev_b32_e64 v78, 16, v151
    v_and_b32 v79, 0xffff0000, v151
    v_lshlrev_b32_e64 v80, 16, v152
    v_and_b32 v81, 0xffff0000, v152
    v_lshlrev_b32_e64 v82, 16, v153
    v_and_b32 v83, 0xffff0000, v153
    v_lshlrev_b32_e64 v84, 16, v154
    v_and_b32 v85, 0xffff0000, v154
    v_lshlrev_b32_e64 v86, 16, v155
    v_and_b32 v87, 0xffff0000, v155
    v_lshlrev_b32_e64 v88, 16, v156
    v_and_b32 v89, 0xffff0000, v156
    v_lshlrev_b32_e64 v90, 16, v157
    v_and_b32 v91, 0xffff0000, v157
    v_lshlrev_b32_e64 v92, 16, v158
    v_and_b32 v93, 0xffff0000, v158
    v_lshlrev_b32_e64 v94, 16, v159
    v_and_b32 v95, 0xffff0000, v159
    v_pk_add_f32 v[208:209], v[64:65], v[66:67]
    v_pk_add_f32 v[210:211], v[68:69], v[70:71]
    v_pk_add_f32 v[212:213], v[72:73], v[74:75]
    v_pk_add_f32 v[214:215], v[76:77], v[78:79]
    v_pk_add_f32 v[208:209], v[208:209], v[210:211]
    v_pk_add_f32 v[212:213], v[212:213], v[214:215]
    v_pk_add_f32 v[208:209], v[208:209], v[212:213]
    v_add_f32_e64 v100, v208, v209
    v_pk_add_f32 v[216:217], v[80:81], v[82:83]
    v_pk_add_f32 v[218:219], v[84:85], v[86:87]
    v_pk_add_f32 v[220:221], v[88:89], v[90:91]
    v_pk_add_f32 v[222:223], v[92:93], v[94:95]
    v_pk_add_f32 v[216:217], v[216:217], v[218:219]
    v_pk_add_f32 v[220:221], v[220:221], v[222:223]
    v_pk_add_f32 v[216:217], v[216:217], v[220:221]
    v_add_f32_e64 v101, v216, v217
    s_nop 0
    s_nop 0
    v_add_f32_dpp v100, v100, v100 row_shr:1 row_mask:0xf bank_mask:0xf bound_ctrl:0
    v_add_f32_dpp v101, v101, v101 row_shr:1 row_mask:0xf bank_mask:0xf bound_ctrl:0
    s_nop 0
    s_nop 0
    v_add_f32_dpp v100, v100, v100 row_shr:2 row_mask:0xf bank_mask:0xf bound_ctrl:0
    v_add_f32_dpp v101, v101, v101 row_shr:2 row_mask:0xf bank_mask:0xf bound_ctrl:0
    s_nop 0
    s_nop 0
    v_add_f32_dpp v100, v100, v100 row_shr:4 row_mask:0xf bank_mask:0xf bound_ctrl:0
    v_add_f32_dpp v101, v101, v101 row_shr:4 row_mask:0xf bank_mask:0xf bound_ctrl:0
    s_nop 0
    s_nop 0
    v_add_f32_dpp v100, v100, v100 row_shr:8 row_mask:0xf bank_mask:0xf bound_ctrl:0
    v_add_f32_dpp v101, v101, v101 row_shr:8 row_mask:0xf bank_mask:0xf bound_ctrl:0
    s_nop 0
    s_nop 0
    v_add_f32_dpp v100, v100, v100 row_bcast:15 row_mask:0xa bank_mask:0xf
    v_add_f32_dpp v101, v101, v101 row_bcast:15 row_mask:0xa bank_mask:0xf
    s_nop 0
    s_nop 0
    v_add_f32_dpp v100, v100, v100 row_bcast:31 row_mask:0xc bank_mask:0xf
    v_add_f32_dpp v101, v101, v101 row_bcast:31 row_mask:0xc bank_mask:0xf
    s_nop 0
    s_nop 0
    v_readlane_b32 s62, v100, 63
    v_readlane_b32 s63, v101, 63
    s_mov_b32 s60, 0x3a800000
    s_nop 0
    v_mov_b32 v100, s62
    v_mov_b32 v101, s63
    v_mul_f32 v102, s60, v100
    v_mul_f32_e64 v103, s60, v101
    v_pk_add_f32 v[64:65], v[64:65], v[102:103] op_sel:[0,0] op_sel_hi:[1,0] neg_lo:[0,1] neg_hi:[0,1]
    v_pk_add_f32 v[66:67], v[66:67], v[102:103] op_sel:[0,0] op_sel_hi:[1,0] neg_lo:[0,1] neg_hi:[0,1]
    v_pk_add_f32 v[68:69], v[68:69], v[102:103] op_sel:[0,0] op_sel_hi:[1,0] neg_lo:[0,1] neg_hi:[0,1]
    v_pk_add_f32 v[70:71], v[70:71], v[102:103] op_sel:[0,0] op_sel_hi:[1,0] neg_lo:[0,1] neg_hi:[0,1]
    v_pk_add_f32 v[72:73], v[72:73], v[102:103] op_sel:[0,0] op_sel_hi:[1,0] neg_lo:[0,1] neg_hi:[0,1]
    v_pk_add_f32 v[74:75], v[74:75], v[102:103] op_sel:[0,0] op_sel_hi:[1,0] neg_lo:[0,1] neg_hi:[0,1]
    v_pk_add_f32 v[76:77], v[76:77], v[102:103] op_sel:[0,0] op_sel_hi:[1,0] neg_lo:[0,1] neg_hi:[0,1]
    v_pk_add_f32 v[78:79], v[78:79], v[102:103] op_sel:[0,0] op_sel_hi:[1,0] neg_lo:[0,1] neg_hi:[0,1]
    v_pk_mul_f32 v[208:209], v[64:65], v[64:65]
    v_pk_mul_f32 v[210:211], v[66:67], v[66:67]
    v_pk_fma_f32 v[208:209], v[68:69], v[68:69], v[208:209]
    v_pk_fma_f32 v[210:211], v[70:71], v[70:71], v[210:211]
    v_pk_fma_f32 v[208:209], v[72:73], v[72:73], v[208:209]
    v_pk_fma_f32 v[210:211], v[74:75], v[74:75], v[210:211]
    v_pk_fma_f32 v[208:209], v[76:77], v[76:77], v[208:209]
    v_pk_fma_f32 v[210:211], v[78:79], v[78:79], v[210:211]
    v_pk_add_f32 v[208:209], v[208:209], v[210:211]
    v_add_f32_e64 v100, v208, v209
    v_pk_add_f32 v[80:81], v[80:81], v[102:103] op_sel:[0,1] op_sel_hi:[1,1] neg_lo:[0,1] neg_hi:[0,1]
    v_pk_add_f32 v[82:83], v[82:83], v[102:103] op_sel:[0,1] op_sel_hi:[1,1] neg_lo:[0,1] neg_hi:[0,1]
    v_pk_add_f32 v[84:85], v[84:85], v[102:103] op_sel:[0,1] op_sel_hi:[1,1] neg_lo:[0,1] neg_hi:[0,1]
    v_pk_add_f32 v[86:87], v[86:87], v[102:103] op_sel:[0,1] op_sel_hi:[1,1] neg_lo:[0,1] neg_hi:[0,1]
    v_pk_add_f32 v[88:89], v[88:89], v[102:103] op_sel:[0,1] op_sel_hi:[1,1] neg_lo:[0,1] neg_hi:[0,1]
    v_pk_add_f32 v[90:91], v[90:91], v[102:103] op_sel:[0,1] op_sel_hi:[1,1] neg_lo:[0,1] neg_hi:[0,1]
    v_pk_add_f32 v[92:93], v[92:93], v[102:103] op_sel:[0,1] op_sel_hi:[1,1] neg_lo:[0,1] neg_hi:[0,1]
    v_pk_add_f32 v[94:95], v[94:95], v[102:103] op_sel:[0,1] op_sel_hi:[1,1] neg_lo:[0,1] neg_hi:[0,1]
    v_pk_mul_f32 v[216:217], v[80:81], v[80:81]
    v_pk_mul_f32 v[218:219], v[82:83], v[82:83]
    v_pk_fma_f32 v[216:217], v[84:85], v[84:85], v[216:217]
    v_pk_fma_f32 v[218:219], v[86:87], v[86:87], v[218:219]
    v_pk_fma_f32 v[216:217], v[88:89], v[88:89], v[216:217]
    v_pk_fma_f32 v[218:219], v[90:91], v[90:91], v[218:219]
    v_pk_fma_f32 v[216:217], v[92:93], v[92:93], v[216:217]
    v_pk_fma_f32 v[218:219], v[94:95], v[94:95], v[218:219]
    v_pk_add_f32 v[216:217], v[216:217], v[218:219]
    v_add_f32 v101, v216, v217
    s_nop 0
    v_add_f32_dpp v100, v100, v100 row_shr:1 row_mask:0xf bank_mask:0xf bound_ctrl:0
    v_add_f32_dpp v101, v101, v101 row_shr:1 row_mask:0xf bank_mask:0xf bound_ctrl:0
    s_nop 0
    s_nop 0
    v_add_f32_dpp v100, v100, v100 row_shr:2 row_mask:0xf bank_mask:0xf bound_ctrl:0
    v_add_f32_dpp v101, v101, v101 row_shr:2 row_mask:0xf bank_mask:0xf bound_ctrl:0
    s_nop 0
    s_nop 0
    v_add_f32_dpp v100, v100, v100 row_shr:4 row_mask:0xf bank_mask:0xf bound_ctrl:0
    v_add_f32_dpp v101, v101, v101 row_shr:4 row_mask:0xf bank_mask:0xf bound_ctrl:0
    s_nop 0
    s_nop 0
    v_add_f32_dpp v100, v100, v100 row_shr:8 row_mask:0xf bank_mask:0xf bound_ctrl:0
    v_add_f32_dpp v101, v101, v101 row_shr:8 row_mask:0xf bank_mask:0xf bound_ctrl:0
    s_nop 0
    s_nop 0
    v_add_f32_dpp v100, v100, v100 row_bcast:15 row_mask:0xa bank_mask:0xf
    v_add_f32_dpp v101, v101, v101 row_bcast:15 row_mask:0xa bank_mask:0xf
    s_nop 0
    s_nop 0
    v_add_f32_dpp v100, v100, v100 row_bcast:31 row_mask:0xc bank_mask:0xf
    v_add_f32_dpp v101, v101, v101 row_bcast:31 row_mask:0xc bank_mask:0xf
    s_nop 0
    s_nop 0
    v_readlane_b32 s62, v100, 63
    v_readlane_b32 s63, v101, 63
    v_cmp_eq_u32 vcc, 1, v1
    s_nop 0
    v_mov_b32 v100, s62
    v_mov_b32 v101, s63
    v_cndmask_b32 v100, v100, v101, vcc
    v_cndmask_b32 v102, v102, v103, vcc
    v_mul_f32_e64 v100, s60, v100
    v_cvt_pk_bf16_f32 v104, v102, v100
    v_lshlrev_b32_e64 v105, 16, v104
    v_and_b32 v106, 0xffff0000, v104
    v_add_f32 v106, 0x3727c5ac, v106
    v_cvt_pk_bf16_f32 v106, v106, v106
    v_lshlrev_b32_e64 v106, 16, v106
    v_sqrt_f32 v106, v106
    s_nop 0
    v_cvt_pk_bf16_f32 v106, v106, v106
    v_lshlrev_b32 v106, 16, v106
    v_rcp_f32 v106, v106
    v_add_u32_e64 v107, s5, v1
    v_lshlrev_b32 v107, 2, v107
    s_mov_b64 exec, 3
    s_mov_b32 s61, 8192
    buffer_store_dword v105, v107, s[24:27], 0 offen sc1
    buffer_store_dword v106, v107, s[24:27], s61 offen sc1
    s_mov_b64 exec, -1
    s_sub_u32 s14, s14, 4
    s_lshl_b32 s17, s14, 12
    s_nop 0
    s_add_u32 s44, s19, 4194304
    s_mul_i32 s36, s2, 1171
    s_lshr_b32 s36, s36, 16
    s_mul_i32 s37, s36, 56
    s_sub_u32 s37, s2, s37
    s_lshl_b32 s18, s36, 8
    s_lshl_b32 s19, s14, 6
    s_add_u32 s18, s18, s19
    s_mul_i32 s18, s18, 7168
    s_lshl_b32 s38, s37, 7
    s_add_u32 s18, s18, s38
    v_lshrrev_b32_e64 v9, 3, v1
    v_mul_u32_u24 v7, 7168, v9
    v_and_b32 v9, 6, v9
    v_and_b32 v8, 7, v1
    v_xor_b32_e64 v8, v8, v9
    v_lshl_add_u32 v7, v8, 4, v7
    v_add_u32 v7, s18, v7
    s_lshl_b32 s57, s14, 13
    s_add_u32 s57, s57, 117760
    s_mov_b32 s18, 0
    s_add_u32 s20, s12, s44
    s_addc_u32 s21, s13, 0
    s_nop 0
    s_mov_b32 s22, 4096
    s_add_u32 s24, s12, 31457280
    s_addc_u32 s25, s13, 0
    s_nop 0
    s_mov_b32 s26, 16384
    s_mov_b32 s27, 0x20000
    s_add_u32 s28, s12, 20971520
    s_addc_u32 s29, s13, 0
    s_nop 0
    s_mov_b32 s30, 7340032
    s_mov_b32 s31, 0x20000
    s_add_u32 s52, s12, 31522816
    s_addc_u32 s53, s13, 0
    s_nop 0
    s_mov_b32 s54, 229376
    s_mov_b32 s55, 0x20000
    v_lshrrev_b32 v9, 2, v1
    v_lshlrev_b32 v8, 7, v9
    v_and_b32_e64 v9, 6, v9
    v_lshl_add_u32 v8, v9, 4, v8
    v_and_b32_e64 v9, 3, v1
    v_lshl_add_u32 v8, v9, 3, v8
    v_add_u32 v8, s57, v8
    v_xor_b32 v9, 32, v8
    v_xor_b32_e64 v10, 64, v8
    v_xor_b32 v11, 96, v8
    v_mov_b32 v12, 0x3f803f80
    s_lshl_b32 s59, s36, 3
    s_lshl_b32 s38, s14, 1
    s_add_u32 s59, s59, s38
    s_nop 0
    s_mul_i32 s59, s59, 14336
    s_lshl_b32 s38, s37, 2
    s_add_u32 s38, s38, 0
    s_mul_i32 s39, s38, 4682
    s_lshr_b32 s39, s39, 16
    s_mul_i32 s44, s39, 14
    s_sub_u32 s38, s38, s44
    s_nop 0
    s_mul_i32 s39, s39, 458752
    s_lshl_b32 s38, s38, 10
    s_add_u32 s38, s38, s39
    s_add_u32 s40, s38, s59
    s_lshl_b32 s38, s37, 2
    s_add_u32 s38, s38, 1
    s_nop 0
    s_mul_i32 s39, s38, 4682
    s_lshr_b32 s39, s39, 16
    s_mul_i32 s44, s39, 14
    s_sub_u32 s38, s38, s44
    s_nop 0
    s_mul_i32 s39, s39, 458752
    s_lshl_b32 s38, s38, 10
    s_add_u32 s38, s38, s39
    s_add_u32 s41, s38, s59
    s_lshl_b32 s38, s37, 2
    s_add_u32 s38, s38, 2
    s_nop 0
    s_mul_i32 s39, s38, 4682
    s_lshr_b32 s39, s39, 16
    s_mul_i32 s44, s39, 14
    s_sub_u32 s38, s38, s44
    s_nop 0
    s_mul_i32 s39, s39, 458752
    s_lshl_b32 s38, s38, 10
    s_add_u32 s38, s38, s39
    s_add_u32 s42, s38, s59
    s_lshl_b32 s38, s37, 2
    s_add_u32 s38, s38, 3
    s_nop 0
    s_mul_i32 s39, s38, 4682
    s_lshr_b32 s39, s39, 16
    s_mul_i32 s44, s39, 14
    s_sub_u32 s38, s38, s44
    s_nop 0
    s_mul_i32 s39, s39, 458752
    s_lshl_b32 s38, s38, 10
    s_add_u32 s38, s38, s39
    s_add_u32 s43, s38, s59
    s_nop 0
    v_add_u32 v13, 14336, v5
    v_mov_b32 v48, 0
    v_mov_b32 v49, 0
    v_mov_b32 v50, 0
    v_mov_b32 v51, 0
    s_lshl_b32 s38, s36, 2
    s_add_u32 s38, s38, s14
    s_mul_i32 s39, s38, 14336
    s_lshl_b32 s38, s37, 8
    s_add_u32 s39, s39, s38
    v_lshlrev_b32_e64 v60, 8, v1
    s_mov_b32 s44, 16384
    s_mov_b32 s45, 32768
    s_mov_b32 s46, 49152
    s_lshl_b32 s19, s14, 2
    s_nop 0
    s_add_u32 s19, s19, 150528
    v_mov_b32_e64 v62, s19
    v_mov_b32 v63, 1
    s_waitcnt vmcnt(0)
    v_mov_b32 v40, 1
    s_mov_b64 exec, 1
    ds_add_rtn_u32 v41, v6, v40 offset:24
    s_mov_b64 exec, -1
    s_mov_b32 s61, 0
    s_waitcnt lgkmcnt(0)
    v_readfirstlane_b32 s62, v41
    s_nop 0
    s_mov_b32 s63, s62
    s_cmp_lg_u32 s62, 3
    s_cbranch_scc1 sequential_preLN__ssm_conv_h3__dense_activation_squared_relu__prompt_kernel_a2_n
    v_lshlrev_b32 v41, 2, v1
    s_mov_b32 exec_hi, 0
    buffer_store_dword v14, v41, s[48:51], s58 offen offset:128 sc1
    s_mov_b64 exec, -1
sequential_preLN__ssm_conv_h3__dense_activation_squared_relu__prompt_kernel_a2_n:
sequential_preLN__ssm_conv_h3__dense_activation_squared_relu__prompt_kernel_sg:
    s_nop 0
    ds_read_b32 v41, v6 offset:16
    s_add_u32 s61, s61, 1
    s_waitcnt lgkmcnt(0)
    v_readfirstlane_b32 s62, v41
    s_nop 0
    s_cmp_gt_u32 s61, 0x400000
    s_cbranch_scc1 sequential_preLN__ssm_conv_h3__dense_activation_squared_relu__prompt_kernel_sgx
    s_cmp_lt_u32 s62, 4
    s_cbranch_scc1 sequential_preLN__ssm_conv_h3__dense_activation_squared_relu__prompt_kernel_sg
sequential_preLN__ssm_conv_h3__dense_activation_squared_relu__prompt_kernel_sgx:
    s_cmp_lg_u32 s14, 0
    s_cbranch_scc1 sequential_preLN__ssm_conv_h3__dense_activation_squared_relu__prompt_kernel_uw
    v_and_b32 v9, 31, v1
    v_lshl_add_u32 v9, v9, 3, s15
    v_lshlrev_b32 v9, 8, v9
    s_mov_b32 s61, 0
sequential_preLN__ssm_conv_h3__dense_activation_squared_relu__prompt_kernel_up:
    buffer_load_dword v42, v9, s[48:51], 0 offen sc1
    s_add_u32 s61, s61, 1
    s_waitcnt vmcnt(0)
    v_xor_b32_e64 v42, s47, v42
    v_and_b32 v42, 0xffffff0f, v42
    v_cmp_ne_u32_e64 vcc, 0, v42
    s_cmp_gt_u32 s61, 0x20000
    s_cbranch_scc1 sequential_preLN__ssm_conv_h3__dense_activation_squared_relu__prompt_kernel_ug
    s_cbranch_vccz sequential_preLN__ssm_conv_h3__dense_activation_squared_relu__prompt_kernel_ug
    s_sleep 2
    s_branch sequential_preLN__ssm_conv_h3__dense_activation_squared_relu__prompt_kernel_up
sequential_preLN__ssm_conv_h3__dense_activation_squared_relu__prompt_kernel_ug:
    v_mov_b32 v40, 1
    s_mov_b64 exec, 1
    ds_write_b32 v6, v40 offset:20
    s_mov_b64 exec, -1
sequential_preLN__ssm_conv_h3__dense_activation_squared_relu__prompt_kernel_uw:
sequential_preLN__ssm_conv_h3__dense_activation_squared_relu__prompt_kernel_sx:
    s_nop 0
    ds_read_b32 v41, v6 offset:20
    s_add_u32 s61, s61, 1
    s_waitcnt lgkmcnt(0)
    v_readfirstlane_b32 s62, v41
    s_nop 0
    s_cmp_gt_u32 s61, 0x400000
    s_cbranch_scc1 sequential_preLN__ssm_conv_h3__dense_activation_squared_relu__prompt_kernel_sxx
    s_cmp_lt_u32 s62, 1
    s_cbranch_scc1 sequential_preLN__ssm_conv_h3__dense_activation_squared_relu__prompt_kernel_sx
sequential_preLN__ssm_conv_h3__dense_activation_squared_relu__prompt_kernel_sxx:
    s_nop 0
    s_sub_u32 s32, s20, 4194304
    s_subb_u32 s33, s21, 0
    s_nop 0
    s_mov_b32 s34, 4096
    s_mov_b32 s35, 0x20000
    s_mul_i32 s62, s14, 21248
    s_add_u32 m0, s62, 17152
    s_lshl_b32 s62, s14, 2
    v_add_u32 v9, s62, v6
    buffer_load_dwordx4 v5, s[32:35], 0 offen offset:0 sc1 lds
    buffer_load_dwordx4 v5, s[32:35], 0 offen offset:1024 sc1 lds
    buffer_load_dwordx4 v5, s[32:35], 0 offen offset:2048 sc1 lds
    buffer_load_dwordx4 v5, s[32:35], 0 offen offset:3072 sc1 lds
    v_mov_b32 v40, 1
    v_add_u32 v9, s62, v6
    s_waitcnt vmcnt(0)
    s_mov_b64 exec, 1
    ds_write_b32 v9, v40 offset:48
    s_mov_b64 exec, -1
    s_mov_b32 s32, s8
    s_mov_b32 s33, s9
    s_nop 0
    s_mov_b32 s34, 7340032
    s_mov_b32 s35, 0x20000
    v_lshrrev_b32 v9, 3, v1
    v_and_b32 v9, 6, v9
    v_lshlrev_b32 v9, 4, v9
    v_xor_b32 v7, v7, v9
    buffer_load_dwordx4 v[160:163], v7, s[32:35], s18 offen
    s_add_u32 s18, s18, 57344
    buffer_load_dwordx4 v[164:167], v7, s[32:35], s18 offen
    s_add_u32 s18, s18, 57344
    buffer_load_dwordx4 v[168:171], v7, s[32:35], s18 offen
    s_add_u32 s18, s18, 57344
    buffer_load_dwordx4 v[172:175], v7, s[32:35], s18 offen
    s_add_u32 s18, s18, 57344
    buffer_load_dwordx4 v[176:179], v7, s[32:35], s18 offen
    s_add_u32 s18, s18, 57344
    buffer_load_dwordx4 v[180:183], v7, s[32:35], s18 offen
    s_add_u32 s18, s18, 57344
    buffer_load_dwordx4 v[184:187], v7, s[32:35], s18 offen
    s_add_u32 s18, s18, 57344
    buffer_load_dwordx4 v[188:191], v7, s[32:35], s18 offen
    s_add_u32 s32, s12, 32505856
    s_addc_u32 s33, s13, 0
    s_nop 0
    s_mov_b32 s34, 262144
    s_mov_b32 s35, 0x20000
    s_add_u32 s40, s12, 50331648
    s_addc_u32 s41, s13, 0
    s_nop 0
    s_mov_b32 s42, 131072
    s_mov_b32 s43, 0x20000
    s_and_b32 s56, s2, 3
    s_lshl_b32 s56, s56, 2
    s_bfe_u32 s57, s2, 0x20003
    s_add_u32 s56, s56, s57
    s_lshl_b32 s56, s56, 4
    s_bfe_u32 s57, s2, 0x10002
    s_lshl_b32 s57, s57, 3
    s_add_u32 s56, s56, s57
    s_lshr_b32 s57, s2, 5
    s_add_u32 s56, s56, s57
    s_lshl_b32 s56, s56, 10
    s_lshl_b32 s57, s14, 8
    s_add_u32 s56, s56, s57
    v_lshlrev_b32 v9, 2, v1
    v_mov_b32 v10, -1
    s_lshl_b32 s57, s2, 2
    s_add_u32 s57, s57, s14
    s_lshl_b32 s57, s57, 7
    v_and_b32 v11, 96, v9
    buffer_store_dword v10, v9, s[32:35], s56 offen sc1
    v_cmp_eq_u32 vcc, 32, v11
    v_mov_b32 v12, s3
    s_nop 0
    v_cndmask_b32 v12, v10, v12, vcc
    buffer_store_dword v12, v11, s[40:43], s57 offen sc1
    s_cmp_lg_u32 s63, 3
    s_cbranch_scc1 sequential_preLN__ssm_conv_h3__dense_activation_squared_relu__prompt_kernel_a2_w
sequential_preLN__ssm_conv_h3__dense_activation_squared_relu__prompt_kernel_a2_p:
    buffer_load_dword v42, v60, s[48:51], 0 offen offset:128 sc1
    buffer_load_dword v43, v60, s[48:51], s44 offen offset:128 sc1
    buffer_load_dword v44, v60, s[48:51], s45 offen offset:128 sc1
    buffer_load_dword v45, v60, s[48:51], s46 offen offset:128 sc1
sequential_preLN__ssm_conv_h3__dense_activation_squared_relu__prompt_kernel_a2_c:
    s_add_u32 s61, s61, 1
    s_waitcnt vmcnt(0)
    v_xor_b32 v42, s47, v42
    v_xor_b32 v43, s47, v43
    v_xor_b32 v44, s47, v44
    v_xor_b32 v45, s47, v45
    v_or3_b32 v42, v42, v43, v44
    v_or_b32_e64 v42, v42, v45
    v_and_b32 v43, 0xffffff0f, v42
    v_cmp_ne_u32_e64 vcc, 0, v43
    s_cmp_gt_u32 s61, 0x20000
    s_cbranch_scc1 sequential_preLN__ssm_conv_h3__dense_activation_squared_relu__prompt_kernel_a2_g
    s_cbranch_vccz sequential_preLN__ssm_conv_h3__dense_activation_squared_relu__prompt_kernel_a2_g
    s_sleep 4
    s_branch sequential_preLN__ssm_conv_h3__dense_activation_squared_relu__prompt_kernel_a2_p
sequential_preLN__ssm_conv_h3__dense_activation_squared_relu__prompt_kernel_a2_g:
    v_mov_b32 v40, 1
    s_mov_b64 exec, 1
    ds_write_b32 v6, v40 offset:28
    s_mov_b64 exec, -1
    s_branch sequential_preLN__ssm_conv_h3__dense_activation_squared_relu__prompt_kernel_a2_x
sequential_preLN__ssm_conv_h3__dense_activation_squared_relu__prompt_kernel_a2_w:
    s_sleep 4
    s_nop 0
    ds_read_b32 v41, v6 offset:28
    s_add_u32 s61, s61, 1
    s_waitcnt lgkmcnt(0)
    v_readfirstlane_b32 s62, v41
    s_nop 0
    s_cmp_gt_u32 s61, 0x400000
    s_cbranch_scc1 sequential_preLN__ssm_conv_h3__dense_activation_squared_relu__prompt_kernel_a2_x
    s_cmp_eq_u32 s62, 0
    s_cbranch_scc1 sequential_preLN__ssm_conv_h3__dense_activation_squared_relu__prompt_kernel_a2_w
sequential_preLN__ssm_conv_h3__dense_activation_squared_relu__prompt_kernel_a2_x:
    s_nop 0
    s_add_u32 m0, s17, 84992
    s_nop 0
    s_nop 0
    buffer_load_dwordx4 v5, s[20:23], 0 offen offset:0 sc1 lds
    buffer_load_dwordx4 v5, s[20:23], 0 offen offset:1024 sc1 lds
    buffer_load_dwordx4 v5, s[20:23], 0 offen offset:2048 sc1 lds
    buffer_load_dwordx4 v5, s[20:23], 0 offen offset:3072 sc1 lds
    s_add_u32 m0, s17, 101376
    s_nop 0
    s_nop 0
    buffer_load_dwordx4 v5, s[24:27], s17 offen offset:0 sc1 lds
    buffer_load_dwordx4 v5, s[24:27], s17 offen offset:1024 sc1 lds
    buffer_load_dwordx4 v5, s[24:27], s17 offen offset:2048 sc1 lds
    buffer_load_dwordx4 v5, s[24:27], s17 offen offset:3072 sc1 lds
    s_waitcnt vmcnt(0)
    s_mov_b64 exec, 1
    ds_write_b32 v62, v63
    s_mov_b64 exec, -1
    s_waitcnt vmcnt(0)
    s_cmp_ge_u32 s2, 224
    s_cbranch_scc1 sequential_preLN__ssm_conv_h3__dense_activation_squared_relu__prompt_kernel_now1
    v_lshlrev_b32 v16, 16, v160
    v_and_b32 v17, 0xffff0000, v160
    v_lshlrev_b32_e64 v18, 16, v161
    v_and_b32 v19, 0xffff0000, v161
    v_lshlrev_b32_e64 v20, 16, v162
    v_and_b32 v21, 0xffff0000, v162
    v_lshlrev_b32_e64 v22, 16, v163
    v_and_b32 v23, 0xffff0000, v163
    v_lshlrev_b32_e64 v24, 16, v164
    v_and_b32 v25, 0xffff0000, v164
    v_lshlrev_b32_e64 v26, 16, v165
    v_and_b32 v27, 0xffff0000, v165
    v_lshlrev_b32_e64 v28, 16, v166
    v_and_b32 v29, 0xffff0000, v166
    v_lshlrev_b32_e64 v30, 16, v167
    v_and_b32 v31, 0xffff0000, v167
    v_pk_add_f32 v[16:17], v[16:17], v[24:25]
    v_pk_add_f32 v[18:19], v[18:19], v[26:27]
    v_pk_add_f32 v[20:21], v[20:21], v[28:29]
    v_pk_add_f32 v[22:23], v[22:23], v[30:31]
    v_lshlrev_b32_e64 v24, 16, v168
    v_and_b32 v25, 0xffff0000, v168
    v_lshlrev_b32_e64 v26, 16, v169
    v_and_b32 v27, 0xffff0000, v169
    v_lshlrev_b32_e64 v28, 16, v170
    v_and_b32 v29, 0xffff0000, v170
    v_lshlrev_b32_e64 v30, 16, v171
    v_and_b32 v31, 0xffff0000, v171
    v_pk_add_f32 v[16:17], v[16:17], v[24:25]
    v_pk_add_f32 v[18:19], v[18:19], v[26:27]
    v_pk_add_f32 v[20:21], v[20:21], v[28:29]
    v_pk_add_f32 v[22:23], v[22:23], v[30:31]
    v_lshlrev_b32_e64 v24, 16, v172
    v_and_b32 v25, 0xffff0000, v172
    v_lshlrev_b32_e64 v26, 16, v173
    v_and_b32 v27, 0xffff0000, v173
    v_lshlrev_b32_e64 v28, 16, v174
    v_and_b32 v29, 0xffff0000, v174
    v_lshlrev_b32_e64 v30, 16, v175
    v_and_b32 v31, 0xffff0000, v175
    v_pk_add_f32 v[16:17], v[16:17], v[24:25]
    v_pk_add_f32 v[18:19], v[18:19], v[26:27]
    v_pk_add_f32 v[20:21], v[20:21], v[28:29]
    v_pk_add_f32 v[22:23], v[22:23], v[30:31]
    v_lshlrev_b32_e64 v24, 16, v176
    v_and_b32 v25, 0xffff0000, v176
    v_lshlrev_b32_e64 v26, 16, v177
    v_and_b32 v27, 0xffff0000, v177
    v_lshlrev_b32_e64 v28, 16, v178
    v_and_b32 v29, 0xffff0000, v178
    v_lshlrev_b32_e64 v30, 16, v179
    v_and_b32 v31, 0xffff0000, v179
    v_pk_add_f32 v[16:17], v[16:17], v[24:25]
    v_pk_add_f32 v[18:19], v[18:19], v[26:27]
    v_pk_add_f32 v[20:21], v[20:21], v[28:29]
    v_pk_add_f32 v[22:23], v[22:23], v[30:31]
    v_lshlrev_b32_e64 v24, 16, v180
    v_and_b32 v25, 0xffff0000, v180
    v_lshlrev_b32_e64 v26, 16, v181
    v_and_b32 v27, 0xffff0000, v181
    v_lshlrev_b32_e64 v28, 16, v182
    v_and_b32 v29, 0xffff0000, v182
    v_lshlrev_b32_e64 v30, 16, v183
    v_and_b32 v31, 0xffff0000, v183
    v_pk_add_f32 v[16:17], v[16:17], v[24:25]
    v_pk_add_f32 v[18:19], v[18:19], v[26:27]
    v_pk_add_f32 v[20:21], v[20:21], v[28:29]
    v_pk_add_f32 v[22:23], v[22:23], v[30:31]
    v_lshlrev_b32_e64 v24, 16, v184
    v_and_b32 v25, 0xffff0000, v184
    v_lshlrev_b32_e64 v26, 16, v185
    v_and_b32 v27, 0xffff0000, v185
    v_lshlrev_b32_e64 v28, 16, v186
    v_and_b32 v29, 0xffff0000, v186
    v_lshlrev_b32_e64 v30, 16, v187
    v_and_b32 v31, 0xffff0000, v187
    v_pk_add_f32 v[16:17], v[16:17], v[24:25]
    v_pk_add_f32 v[18:19], v[18:19], v[26:27]
    v_pk_add_f32 v[20:21], v[20:21], v[28:29]
    v_pk_add_f32 v[22:23], v[22:23], v[30:31]
    v_lshlrev_b32_e64 v24, 16, v188
    v_and_b32 v25, 0xffff0000, v188
    v_lshlrev_b32_e64 v26, 16, v189
    v_and_b32 v27, 0xffff0000, v189
    v_lshlrev_b32_e64 v28, 16, v190
    v_and_b32 v29, 0xffff0000, v190
    v_lshlrev_b32_e64 v30, 16, v191
    v_and_b32 v31, 0xffff0000, v191
    v_pk_add_f32 v[16:17], v[16:17], v[24:25]
    v_pk_add_f32 v[18:19], v[18:19], v[26:27]
    v_pk_add_f32 v[20:21], v[20:21], v[28:29]
    v_pk_add_f32 v[22:23], v[22:23], v[30:31]
    s_nop 1
    s_nop 0
    v_add_f32_dpp v16, v16, v16 row_ror:8 row_mask:0xf bank_mask:0xf
    v_add_f32_dpp v17, v17, v17 row_ror:8 row_mask:0xf bank_mask:0xf
    v_add_f32_dpp v18, v18, v18 row_ror:8 row_mask:0xf bank_mask:0xf
    v_add_f32_dpp v19, v19, v19 row_ror:8 row_mask:0xf bank_mask:0xf
    v_add_f32_dpp v20, v20, v20 row_ror:8 row_mask:0xf bank_mask:0xf
    v_add_f32_dpp v21, v21, v21 row_ror:8 row_mask:0xf bank_mask:0xf
    v_add_f32_dpp v22, v22, v22 row_ror:8 row_mask:0xf bank_mask:0xf
    v_add_f32_dpp v23, v23, v23 row_ror:8 row_mask:0xf bank_mask:0xf
    v_mov_b32 v24, v16
    v_mov_b32 v25, v17
    v_mov_b32 v26, v18
    v_mov_b32 v27, v19
    v_mov_b32 v28, v20
    v_mov_b32 v29, v21
    v_mov_b32_e64 v30, v22
    v_mov_b32 v31, v23
    s_nop 1
    v_permlane16_swap_b32 v16, v24
    v_permlane16_swap_b32 v17, v25
    v_permlane16_swap_b32 v18, v26
    v_permlane16_swap_b32 v19, v27
    v_permlane16_swap_b32 v20, v28
    v_permlane16_swap_b32 v21, v29
    v_permlane16_swap_b32 v22, v30
    v_permlane16_swap_b32 v23, v31
    v_add_f32 v16, v16, v24
    v_add_f32 v17, v17, v25
    v_add_f32 v18, v18, v26
    v_add_f32 v19, v19, v27
    v_add_f32 v20, v20, v28
    v_add_f32 v21, v21, v29
    v_add_f32 v22, v22, v30
    v_add_f32 v23, v23, v31
    v_mov_b32 v24, v16
    v_mov_b32 v25, v17
    v_mov_b32 v26, v18
    v_mov_b32 v27, v19
    v_mov_b32 v28, v20
    v_mov_b32 v29, v21
    v_mov_b32_e64 v30, v22
    v_mov_b32 v31, v23
    s_nop 1
    v_permlane32_swap_b32 v16, v24
    v_permlane32_swap_b32 v17, v25
    v_permlane32_swap_b32 v18, v26
    v_permlane32_swap_b32 v19, v27
    v_permlane32_swap_b32 v20, v28
    v_permlane32_swap_b32 v21, v29
    v_permlane32_swap_b32 v22, v30
    v_permlane32_swap_b32 v23, v31
    v_add_f32 v16, v16, v24
    v_add_f32 v17, v17, v25
    v_add_f32 v18, v18, v26
    v_add_f32 v19, v19, v27
    v_add_f32 v20, v20, v28
    v_add_f32 v21, v21, v29
    v_add_f32 v22, v22, v30
    v_add_f32 v23, v23, v31
    v_lshlrev_b32_e64 v7, 5, v1
    s_mov_b64 exec, 0xff
    buffer_store_dwordx4 v[16:19], v7, s[52:55], s39 offen sc1
    buffer_store_dwordx4 v[20:23], v7, s[52:55], s39 offen offset:16 sc1
    s_mov_b64 exec, -1
    s_setprio 0
sequential_preLN__ssm_conv_h3__dense_activation_squared_relu__prompt_kernel_now1:
    s_waitcnt lgkmcnt(0)
    s_add_u32 s14, s14, 4
sequential_preLN__ssm_conv_h3__dense_activation_squared_relu__prompt_kernel_tr:
    s_add_u32 s48, s12, 33619968
    s_addc_u32 s49, s13, 0
    s_nop 0
    s_mov_b32 s50, 65536
    s_mov_b32 s51, 0x20000
    v_mov_b32 v6, 150544
    v_mov_b32_e64 v40, 1
    v_mov_b32 v14, s3
    s_lshl_b32 s58, s2, 8
    s_waitcnt vmcnt(0) lgkmcnt(0)
    s_mov_b64 exec, 1
    ds_add_rtn_u32 v41, v6, v40 offset:32
    s_mov_b64 exec, -1
    s_waitcnt lgkmcnt(0)
    v_readfirstlane_b32 s62, v41
    s_nop 0
    s_cmp_lg_u32 s62, 7
    s_cbranch_scc1 sequential_preLN__ssm_conv_h3__dense_activation_squared_relu__prompt_kernel_tn
    v_lshlrev_b32 v41, 2, v1
    s_mov_b32 exec_hi, 0
    buffer_store_dword v14, v41, s[48:51], s58 offen sc1
    s_mov_b64 exec, -1
sequential_preLN__ssm_conv_h3__dense_activation_squared_relu__prompt_kernel_tn:
    s_nop 0
    s_load_dwordx2 s[12:13], s[0:1], 104
    s_load_dwordx4 s[8:11], s[0:1], 64
    s_load_dwordx2 s[6:7], s[0:1], 56
    v_lshrrev_b32 v2, 6, v0
    v_and_b32 v1, 63, v0
    v_readfirstlane_b32 s14, v2
    v_and_b32 v3, 15, v1
    v_lshrrev_b32_e64 v4, 4, v1
    v_lshlrev_b32 v5, 4, v1
    s_and_b32 s15, s2, 3
    s_lshl_b32 s15, s15, 2
    s_lshr_b32 s17, s2, 3
    s_and_b32 s18, s17, 3
    s_add_u32 s15, s15, s18
    s_lshr_b32 s16, s2, 2
    s_and_b32 s16, s16, 1
    s_lshl_b32 s16, s16, 3
    s_lshr_b32 s17, s17, 2
    s_add_u32 s16, s16, s17
    s_cmp_lt_u32 s14, 4
    s_cbranch_scc1 sequential_preLN__ssm_conv_h3__dense_activation_squared_relu__prompt_kernel_g_cons
    s_sub_u32 s14, s14, 4
    s_mul_i32 s17, s16, 458752
    s_add_u32 s17, s17, 20971520
    s_lshl_b32 s18, s14, 2
    s_mul_i32 s19, s14, 3
    s_add_u32 s19, s19, 2
    s_min_u32 s18, s18, s19
    s_lshl_b32 s18, s18, 10
    v_add_u32 v8, s18, v5
    s_lshl_b32 s19, s14, 11
    s_nop 0
    s_add_u32 s19, s19, 14336
    s_lshl_b32 s20, s14, 15
    s_lshl_b32 s23, s15, 8
    s_add_u32 s20, s20, s23
    v_lshlrev_b32 v9, 12, v4
    v_lshlrev_b32 v11, 1, v4
    v_xor_b32 v11, v11, v3
    v_lshl_add_u32 v9, v11, 4, v9
    v_add_u32_e64 v9, s20, v9
    v_xor_b32 v10, 128, v9
    v_add_u32 v10, 15360, v10
    s_mov_b32 s32, 0
    s_nop 0
    s_mul_i32 s33, s16, 28672
    s_lshl_b32 s34, s16, 18
    s_waitcnt lgkmcnt(0)
    s_mov_b32 s24, s6
    s_mov_b32 s25, s7
    s_mov_b32 s26, 7340032
    s_mov_b32 s27, 0x20000
    s_lshr_b32 s20, s18, 4
    s_nop 0
    s_mul_i32 s23, s16, 448
    s_mov_b32 s33, 9363
    v_add_u32 v16, s20, v1
    v_add_u32 v16, 0, v16
    v_mul_u32_u24 v17, s33, v16
    v_lshrrev_b32 v17, 18, v17
    v_mul_u32_u24 v18, 28, v17
    v_sub_u32 v16, v16, v18
    v_lshrrev_b32 v18, 1, v17
    v_and_b32 v18, 2, v18
    v_xor_b32_e64 v16, v16, v18
    v_mul_u32_u24 v17, 7168, v17
    v_lshl_add_u32 v16, v16, 4, v17
    v_add_u32 v16, s23, v16
    v_subrev_u32 v116, 0, v16
    v_add_u32 v16, s20, v1
    v_add_u32 v16, 64, v16
    v_mul_u32_u24 v17, s33, v16
    v_lshrrev_b32 v17, 18, v17
    v_mul_u32_u24 v18, 28, v17
    v_sub_u32 v16, v16, v18
    v_lshrrev_b32 v18, 1, v17
    v_and_b32 v18, 2, v18
    v_xor_b32_e64 v16, v16, v18
    v_mul_u32_u24 v17, 7168, v17
    v_lshl_add_u32 v16, v16, 4, v17
    v_add_u32_e64 v16, s23, v16
    v_subrev_u32 v117, 1024, v16
    v_add_u32_e64 v16, s20, v1
    v_add_u32 v16, 128, v16
    v_mul_u32_u24 v17, s33, v16
    v_lshrrev_b32 v17, 18, v17
    v_mul_u32_u24 v18, 28, v17
    v_sub_u32 v16, v16, v18
    v_lshrrev_b32 v18, 1, v17
    v_and_b32 v18, 2, v18
    v_xor_b32_e64 v16, v16, v18
    v_mul_u32_u24 v17, 7168, v17
    v_lshl_add_u32 v16, v16, 4, v17
    v_add_u32_e64 v16, s23, v16
    v_subrev_u32 v118, 2048, v16
    v_add_u32_e64 v16, s20, v1
    v_add_u32 v16, 192, v16
    v_mul_u32_u24 v17, s33, v16
    v_lshrrev_b32 v17, 18, v17
    v_mul_u32_u24 v18, 28, v17
    v_sub_u32 v16, v16, v18
    v_lshrrev_b32 v18, 1, v17
    v_and_b32 v18, 2, v18
    v_xor_b32_e64 v16, v16, v18
    v_mul_u32_u24 v17, 7168, v17
    v_lshl_add_u32 v16, v16, 4, v17
    v_add_u32_e64 v16, s23, v16
    v_subrev_u32 v119, 3072, v16
    s_mul_i32 s33, s16, 458752
    s_add_u32 s28, s12, 16777216
    s_addc_u32 s29, s13, 0
    s_nop 0
    s_mov_b32 s30, 4194304
    s_mov_b32 s31, 0x20000
    s_lshl_b32 s20, s2, 2
    s_add_u32 s20, s20, s14
    s_mul_i32 s20, s20, 7168
    s_add_u32 s46, s10, s20
    s_addc_u32 s47, s11, 0
    s_mov_b32 s40, s8
    s_mov_b32 s41, s9
    s_mov_b32 s42, 7168
    s_mov_b32 s43, 0x20000
    s_mul_i32 s53, s16, 896
    s_mul_i32 s52, s14, 224
    s_add_u32 s53, s53, s52
    s_lshr_b32 s52, s53, 1
    v_min_u32 v20, 13, v3
    v_lshlrev_b32 v21, 3, v20
    v_lshlrev_b32_e64 v20, 4, v20
    v_mul_u32_u24 v19, 57344, v4
    v_add_u32_e64 v19, v19, v20
    buffer_load_dwordx2 v[112:113], v21, s[40:43], s52 offen
    s_cmp_ge_u32 s14, 2
    s_cbranch_scc1 sequential_preLN__ssm_conv_h3__dense_activation_squared_relu__prompt_kernel_g_h1
sequential_preLN__ssm_conv_h3__dense_activation_squared_relu__prompt_kernel_g_h0:
    v_mov_b32 v6, 150544
    s_mov_b32 s61, 0
sequential_preLN__ssm_conv_h3__dense_activation_squared_relu__prompt_kernel_g_h0_ar:
    s_sleep 2
    ds_read_b32 v41, v6 offset:36
    s_add_u32 s61, s61, 1
    s_waitcnt lgkmcnt(0)
    v_readfirstlane_b32 s62, v41
    s_nop 0
    s_cmp_gt_u32 s61, 0x400000
    s_cbranch_scc1 sequential_preLN__ssm_conv_h3__dense_activation_squared_relu__prompt_kernel_g_h0_arx
    s_cmp_lt_u32 s62, 4
    s_cbranch_scc1 sequential_preLN__ssm_conv_h3__dense_activation_squared_relu__prompt_kernel_g_h0_ar
sequential_preLN__ssm_conv_h3__dense_activation_squared_relu__prompt_kernel_g_h0_arx:
    s_add_u32 m0, 0, s18
    s_nop 0
    s_nop 0
    buffer_load_dwordx4 v116, s[24:27], s33 offen  lds
    buffer_load_dwordx4 v117, s[24:27], s33 offen offset:1024  lds
    buffer_load_dwordx4 v118, s[24:27], s33 offen offset:2048  lds
    buffer_load_dwordx4 v119, s[24:27], s33 offen offset:3072  lds
    s_add_u32 s33, s33, 229376
    s_cmp_eq_u32 s33, 7340032
    s_cselect_b32 s33, 0, s33
    s_nop 0
    s_add_u32 m0, 22528, s18
    s_nop 0
    s_nop 0
    buffer_load_dwordx4 v116, s[24:27], s33 offen  lds
    buffer_load_dwordx4 v117, s[24:27], s33 offen offset:1024  lds
    buffer_load_dwordx4 v118, s[24:27], s33 offen offset:2048  lds
    buffer_load_dwordx4 v119, s[24:27], s33 offen offset:3072  lds
    s_add_u32 s33, s33, 229376
    s_cmp_eq_u32 s33, 7340032
    s_cselect_b32 s33, 0, s33
    s_nop 0
    s_add_u32 m0, 45056, s18
    s_nop 0
    s_nop 0
    buffer_load_dwordx4 v116, s[24:27], s33 offen  lds
    buffer_load_dwordx4 v117, s[24:27], s33 offen offset:1024  lds
    buffer_load_dwordx4 v118, s[24:27], s33 offen offset:2048  lds
    buffer_load_dwordx4 v119, s[24:27], s33 offen offset:3072  lds
    s_add_u32 s33, s33, 229376
    s_cmp_eq_u32 s33, 7340032
    s_cselect_b32 s33, 0, s33
    s_nop 0
    s_add_u32 m0, 67584, s18
    s_nop 0
    s_nop 0
    buffer_load_dwordx4 v116, s[24:27], s33 offen  lds
    buffer_load_dwordx4 v117, s[24:27], s33 offen offset:1024  lds
    buffer_load_dwordx4 v118, s[24:27], s33 offen offset:2048  lds
    buffer_load_dwordx4 v119, s[24:27], s33 offen offset:3072  lds
    s_add_u32 s33, s33, 229376
    s_cmp_eq_u32 s33, 7340032
    s_cselect_b32 s33, 0, s33
    s_nop 0
    s_add_u32 m0, 90112, s18
    s_nop 0
    s_nop 0
    buffer_load_dwordx4 v116, s[24:27], s33 offen  lds
    buffer_load_dwordx4 v117, s[24:27], s33 offen offset:1024  lds
    buffer_load_dwordx4 v118, s[24:27], s33 offen offset:2048  lds
    buffer_load_dwordx4 v119, s[24:27], s33 offen offset:3072  lds
    s_add_u32 s33, s33, 229376
    s_cmp_eq_u32 s33, 7340032
    s_cselect_b32 s33, 0, s33
    s_nop 0
    s_add_u32 m0, 112640, s18
    s_nop 0
    s_nop 0
    buffer_load_dwordx4 v116, s[24:27], s33 offen  lds
    buffer_load_dwordx4 v117, s[24:27], s33 offen offset:1024  lds
    buffer_load_dwordx4 v118, s[24:27], s33 offen offset:2048  lds
    buffer_load_dwordx4 v119, s[24:27], s33 offen offset:3072  lds
    s_add_u32 s33, s33, 229376
    s_cmp_eq_u32 s33, 7340032
    s_cselect_b32 s33, 0, s33
    s_nop 0
    s_add_u32 s48, s12, 33619968
    s_addc_u32 s49, s13, 0
    s_nop 0
    s_mov_b32 s50, 131072
    s_mov_b32 s51, 0x20000
    v_lshlrev_b32_e64 v60, 8, v1
    s_mov_b32 s44, 16384
    s_mov_b32 s45, 32768
    s_mov_b32 s52, 49152
    v_lshrrev_b32 v61, 3, v1
    v_min_u32 v61, 5, v61
    s_lshl_b32 s62, s16, 1
    v_add_u32 v61, s62, v61
    v_and_b32 v61, 31, v61
    v_and_b32 v62, 3, v61
    v_lshrrev_b32_e64 v61, 2, v61
    v_lshl_add_u32 v61, v62, 6, v61
    v_and_b32_e64 v62, 7, v1
    v_lshl_add_u32 v61, v62, 3, v61
    v_lshlrev_b32_e64 v61, 8, v61
    v_add_u32 v61, 65536, v61
    s_cmp_lg_u32 s14, 0
    s_cbranch_scc1 sequential_preLN__ssm_conv_h3__dense_activation_squared_relu__prompt_kernel_g_h0_t1x
    s_mov_b32 s61, 0
sequential_preLN__ssm_conv_h3__dense_activation_squared_relu__prompt_kernel_g_h0_t1p:
    s_nop 0
    buffer_load_dword v42, v61, s[48:51], 0 offen sc1
    s_add_u32 s61, s61, 1
    s_waitcnt vmcnt(0)
    v_xor_b32_e64 v42, s3, v42
    v_and_b32 v42, 0xffffff0f, v42
    v_cmp_ne_u32_e64 vcc, 0, v42
    s_cmp_gt_u32 s61, 0x20000
    s_cbranch_scc1 sequential_preLN__ssm_conv_h3__dense_activation_squared_relu__prompt_kernel_g_h0_t1x
    s_cbranch_vccz sequential_preLN__ssm_conv_h3__dense_activation_squared_relu__prompt_kernel_g_h0_t1x
    s_sleep 8
    s_branch sequential_preLN__ssm_conv_h3__dense_activation_squared_relu__prompt_kernel_g_h0_t1p
sequential_preLN__ssm_conv_h3__dense_activation_squared_relu__prompt_kernel_g_h0_t1x:
    s_barrier
    s_mov_b32 s32, 0
    s_add_u32 m0, 0, s19
    s_nop 0
    buffer_load_dwordx4 v9, s[28:31], s34 offen sc1 lds
    buffer_load_dwordx4 v10, s[28:31], s34 offen offset:1024 sc1 lds
    s_add_u32 s34, s34, 131072
    s_and_b32 s34, s34, 0x3fffff
    s_add_u32 m0, 22528, s19
    s_nop 0
    s_nop 0
    buffer_load_dwordx4 v9, s[28:31], s34 offen sc1 lds
    buffer_load_dwordx4 v10, s[28:31], s34 offen offset:1024 sc1 lds
    s_add_u32 s34, s34, 131072
    s_and_b32 s34, s34, 0x3fffff
    s_waitcnt vmcnt(2)
    s_barrier
    s_add_u32 m0, 45056, s19
    s_nop 0
    s_nop 0
    buffer_load_dwordx4 v9, s[28:31], s34 offen sc1 lds
    buffer_load_dwordx4 v10, s[28:31], s34 offen offset:1024 sc1 lds
    s_add_u32 s34, s34, 131072
    s_and_b32 s34, s34, 0x3fffff
    s_add_u32 m0, 67584, s19
    s_nop 0
    s_nop 0
    buffer_load_dwordx4 v9, s[28:31], s34 offen sc1 lds
    buffer_load_dwordx4 v10, s[28:31], s34 offen offset:1024 sc1 lds
    s_add_u32 s34, s34, 131072
    s_and_b32 s34, s34, 0x3fffff
    s_add_u32 m0, 90112, s19
    s_nop 0
    s_nop 0
    buffer_load_dwordx4 v9, s[28:31], s34 offen sc1 lds
    buffer_load_dwordx4 v10, s[28:31], s34 offen offset:1024 sc1 lds
    s_add_u32 s34, s34, 131072
    s_and_b32 s34, s34, 0x3fffff
    s_add_u32 m0, 112640, s19
    s_nop 0
    s_nop 0
    buffer_load_dwordx4 v9, s[28:31], s34 offen sc1 lds
    buffer_load_dwordx4 v10, s[28:31], s34 offen offset:1024 sc1 lds
    s_add_u32 s34, s34, 131072
    s_and_b32 s34, s34, 0x3fffff
    s_waitcnt vmcnt(8)
    s_barrier
    s_add_u32 m0, 0, s18
    s_nop 0
    buffer_load_dwordx4 v116, s[24:27], s33 offen  lds
    buffer_load_dwordx4 v117, s[24:27], s33 offen offset:1024  lds
    buffer_load_dwordx4 v118, s[24:27], s33 offen offset:2048  lds
    buffer_load_dwordx4 v119, s[24:27], s33 offen offset:3072  lds
    s_add_u32 s33, s33, 229376
    s_cmp_eq_u32 s33, 7340032
    s_cselect_b32 s33, 0, s33
    s_waitcnt vmcnt(10)
    s_barrier
    s_cmp_lg_u32 s14, 0
    s_cbranch_scc1 sequential_preLN__ssm_conv_h3__dense_activation_squared_relu__prompt_kernel_g_h0_t2x
    s_mov_b32 s61, 0
sequential_preLN__ssm_conv_h3__dense_activation_squared_relu__prompt_kernel_g_h0_t2p:
    buffer_load_dword v42, v60, s[48:51], 0 offen sc1
    buffer_load_dword v43, v60, s[48:51], s44 offen sc1
    buffer_load_dword v44, v60, s[48:51], s45 offen sc1
    buffer_load_dword v45, v60, s[48:51], s52 offen sc1
    s_add_u32 s61, s61, 1
    s_waitcnt vmcnt(0)
    v_xor_b32 v42, s3, v42
    v_xor_b32 v43, s3, v43
    v_xor_b32 v44, s3, v44
    v_xor_b32 v45, s3, v45
    v_or3_b32 v42, v42, v43, v44
    v_or_b32_e64 v42, v42, v45
    v_and_b32 v42, 0xffffff0f, v42
    v_cmp_ne_u32_e64 vcc, 0, v42
    s_cmp_gt_u32 s61, 0x20000
    s_cbranch_scc1 sequential_preLN__ssm_conv_h3__dense_activation_squared_relu__prompt_kernel_g_h0_t2x
    s_cbranch_vccz sequential_preLN__ssm_conv_h3__dense_activation_squared_relu__prompt_kernel_g_h0_t2x
    s_sleep 8
    s_branch sequential_preLN__ssm_conv_h3__dense_activation_squared_relu__prompt_kernel_g_h0_t2p
sequential_preLN__ssm_conv_h3__dense_activation_squared_relu__prompt_kernel_g_h0_t2x:
    s_waitcnt vmcnt(6)
    s_barrier
    s_add_u32 m0, 0, s19
    s_nop 0
    buffer_load_dwordx4 v9, s[28:31], s34 offen sc1 lds
    buffer_load_dwordx4 v10, s[28:31], s34 offen offset:1024 sc1 lds
    s_add_u32 s34, s34, 131072
    s_and_b32 s34, s34, 0x3fffff
    s_mov_b32 s32, 22528
    s_add_u32 m0, s32, s18
    s_add_u32 s50, s32, s19
    buffer_load_dwordx4 v116, s[24:27], s33 offen  lds
    buffer_load_dwordx4 v117, s[24:27], s33 offen offset:1024  lds
    buffer_load_dwordx4 v118, s[24:27], s33 offen offset:2048  lds
    buffer_load_dwordx4 v119, s[24:27], s33 offen offset:3072  lds
    s_mov_b32 m0, s50
    s_nop 0
    s_add_u32 s33, s33, 229376
    buffer_load_dwordx4 v9, s[28:31], s34 offen sc1 lds
    buffer_load_dwordx4 v10, s[28:31], s34 offen offset:1024 sc1 lds
    s_add_u32 s34, s34, 131072
    s_and_b32 s34, s34, 0x3fffff
    s_cmp_eq_u32 s33, 7340032
    s_cselect_b32 s33, 0, s33
    s_nop 0
    s_add_u32 s32, s32, 22528
    s_cmp_eq_u32 s32, 135168
    s_cselect_b32 s32, 0, s32
    s_add_u32 m0, s32, s18
    s_add_u32 s50, s32, s19
    s_nop 0
    buffer_load_dwordx4 v116, s[24:27], s33 offen  lds
    buffer_load_dwordx4 v117, s[24:27], s33 offen offset:1024  lds
    buffer_load_dwordx4 v118, s[24:27], s33 offen offset:2048  lds
    buffer_load_dwordx4 v119, s[24:27], s33 offen offset:3072  lds
    s_mov_b32 m0, s50
    s_nop 0
    s_add_u32 s33, s33, 229376
    buffer_load_dwordx4 v9, s[28:31], s34 offen sc1 lds
    buffer_load_dwordx4 v10, s[28:31], s34 offen offset:1024 sc1 lds
    s_add_u32 s34, s34, 131072
    s_and_b32 s34, s34, 0x3fffff
    s_cmp_eq_u32 s33, 7340032
    s_cselect_b32 s33, 0, s33
    s_nop 0
    s_add_u32 s32, s32, 22528
    s_cmp_eq_u32 s32, 135168
    s_cselect_b32 s32, 0, s32
    s_mov_b32 s22, 1
    s_branch sequential_preLN__ssm_conv_h3__dense_activation_squared_relu__prompt_kernel_g_h0_back
    s_mov_b32 s22, 1
sequential_preLN__ssm_conv_h3__dense_activation_squared_relu__prompt_kernel_g_h0_loop:
    s_waitcnt vmcnt(12)
    s_barrier
    s_add_u32 m0, s32, s18
    s_add_u32 s50, s32, s19
    buffer_load_dwordx4 v116, s[24:27], s33 offen  lds
    buffer_load_dwordx4 v117, s[24:27], s33 offen offset:1024  lds
    buffer_load_dwordx4 v118, s[24:27], s33 offen offset:2048  lds
    buffer_load_dwordx4 v119, s[24:27], s33 offen offset:3072  lds
    s_mov_b32 m0, s50
    s_nop 0
    s_add_u32 s33, s33, 229376
    buffer_load_dwordx4 v9, s[28:31], s34 offen sc1 lds
    buffer_load_dwordx4 v10, s[28:31], s34 offen offset:1024 sc1 lds
    s_add_u32 s34, s34, 131072
    s_and_b32 s34, s34, 0x3fffff
    s_cmp_eq_u32 s33, 7340032
    s_cselect_b32 s33, 0, s33
    s_nop 0
    s_add_u32 s32, s32, 22528
    s_cmp_eq_u32 s32, 135168
    s_cselect_b32 s32, 0, s32
    s_add_u32 m0, s32, s18
    s_add_u32 s50, s32, s19
    s_nop 0
    buffer_load_dwordx4 v116, s[24:27], s33 offen  lds
    buffer_load_dwordx4 v117, s[24:27], s33 offen offset:1024  lds
    buffer_load_dwordx4 v118, s[24:27], s33 offen offset:2048  lds
    buffer_load_dwordx4 v119, s[24:27], s33 offen offset:3072  lds
    s_mov_b32 m0, s50
    s_nop 0
    s_add_u32 s33, s33, 229376
    buffer_load_dwordx4 v9, s[28:31], s34 offen sc1 lds
    buffer_load_dwordx4 v10, s[28:31], s34 offen offset:1024 sc1 lds
    s_add_u32 s34, s34, 131072
    s_and_b32 s34, s34, 0x3fffff
    s_cmp_eq_u32 s33, 7340032
    s_cselect_b32 s33, 0, s33
    s_nop 0
    s_add_u32 s32, s32, 22528
    s_cmp_eq_u32 s32, 135168
    s_cselect_b32 s32, 0, s32
    s_cmp_lg_u32 s22, 6
    s_cbranch_scc1 sequential_preLN__ssm_conv_h3__dense_activation_squared_relu__prompt_kernel_g_h0_ncs
    s_nop 0
    s_add_u32 s40, s12, 31522816
    s_addc_u32 s41, s13, 0
    s_nop 0
    s_mov_b32 s42, 229376
    s_mov_b32 s43, 0x20000
    buffer_load_dwordx4 v[96:99], v19, s[40:43], s53 offen sc1
    s_add_u32 s53, s53, 14336
    buffer_load_dwordx4 v[100:103], v19, s[40:43], s53 offen sc1
    s_add_u32 s53, s53, 14336
    buffer_load_dwordx4 v[104:107], v19, s[40:43], s53 offen sc1
    s_add_u32 s53, s53, 14336
    buffer_load_dwordx4 v[108:111], v19, s[40:43], s53 offen sc1
sequential_preLN__ssm_conv_h3__dense_activation_squared_relu__prompt_kernel_g_h0_ncs:
    s_cmp_lg_u32 s22, 9
    s_cbranch_scc1 sequential_preLN__ssm_conv_h3__dense_activation_squared_relu__prompt_kernel_g_h0_nc
    s_getpc_b64 s[44:45]
sequential_preLN__ssm_conv_h3__dense_activation_squared_relu__prompt_kernel_g_h0_pc:
    s_nop 0
    s_add_u32 s44, s44, sequential_preLN__ssm_conv_h3__dense_activation_squared_relu__prompt_kernel_g_hfin-sequential_preLN__ssm_conv_h3__dense_activation_squared_relu__prompt_kernel_g_h0_pc
    s_addc_u32 s45, s45, 0
    s_lshl_b32 s20, s14, 13
    v_lshlrev_b32 v6, 7, v1
    v_add_u32 v6, s20, v6
    v_min_u32 v6, code_end_lbl-sequential_preLN__ssm_conv_h3__dense_activation_squared_relu__prompt_kernel_g_hfin-4, v6
    global_load_dword v63, v6, s[44:45]
sequential_preLN__ssm_conv_h3__dense_activation_squared_relu__prompt_kernel_g_h0_nc:
sequential_preLN__ssm_conv_h3__dense_activation_squared_relu__prompt_kernel_g_h0_back:
    s_add_u32 s22, s22, 1
    s_cmp_lt_u32 s22, 13
    s_cbranch_scc1 sequential_preLN__ssm_conv_h3__dense_activation_squared_relu__prompt_kernel_g_h0_loop
    s_waitcnt vmcnt(12)
    s_barrier
    s_add_u32 m0, s32, s18
    s_add_u32 s50, s32, s19
    s_nop 0
    buffer_load_dwordx4 v116, s[24:27], s33 offen  lds
    buffer_load_dwordx4 v117, s[24:27], s33 offen offset:1024  lds
    buffer_load_dwordx4 v118, s[24:27], s33 offen offset:2048  lds
    buffer_load_dwordx4 v119, s[24:27], s33 offen offset:3072  lds
    s_mov_b32 m0, s50
    s_nop 0
    s_add_u32 s33, s33, 229376
    buffer_load_dwordx4 v9, s[28:31], s34 offen sc1 lds
    buffer_load_dwordx4 v10, s[28:31], s34 offen offset:1024 sc1 lds
    s_add_u32 s34, s34, 131072
    s_and_b32 s34, s34, 0x3fffff
    s_cmp_eq_u32 s33, 7340032
    s_cselect_b32 s33, 0, s33
    s_nop 0
    s_add_u32 s32, s32, 22528
    s_cmp_eq_u32 s32, 135168
    s_cselect_b32 s32, 0, s32
    s_setprio 3
    s_add_u32 s36, s12, 32505856
    s_addc_u32 s37, s13, 0
    s_nop 0
    s_mov_b32 s38, 262144
    s_mov_b32 s39, 0x20000
    v_and_b32_e64 v22, 31, v1
    v_lshlrev_b32 v22, 3, v22
    s_lshl_b32 s20, s15, 14
    s_lshl_b32 s23, s14, 8
    s_add_u32 s20, s20, s23
    s_add_u32 s23, s20, 4096
    v_lshrrev_b32_e64 v23, 5, v1
    v_lshl_add_u32 v23, v23, 13, v22
    buffer_load_dwordx2 v[32:33], v23, s[36:39], s20 offen offset:0 sc1
    buffer_load_dwordx2 v[34:35], v23, s[36:39], s20 offen offset:1024 sc1
    buffer_load_dwordx2 v[36:37], v23, s[36:39], s20 offen offset:2048 sc1
    buffer_load_dwordx2 v[38:39], v23, s[36:39], s20 offen offset:3072 sc1
    buffer_load_dwordx2 v[40:41], v23, s[36:39], s23 offen offset:0 sc1
    buffer_load_dwordx2 v[42:43], v23, s[36:39], s23 offen offset:1024 sc1
    buffer_load_dwordx2 v[44:45], v23, s[36:39], s23 offen offset:2048 sc1
    buffer_load_dwordx2 v[46:47], v23, s[36:39], s23 offen offset:3072 sc1
    s_add_u32 s40, s12, 0
    s_addc_u32 s41, s13, 0
    s_mov_b32 s42, 14680064
    s_mov_b32 s43, 0x20000
    s_lshl_b32 s44, s15, 3
    s_lshl_b32 s45, s14, 1
    s_add_u32 s44, s44, s45
    s_nop 0
    s_mul_i32 s44, s44, 114688
    s_mul_i32 s45, s16, 7168
    s_add_u32 s44, s44, s45
    s_nop 0
    s_add_u32 s45, s44, 114688
    v_lshlrev_b32_e64 v6, 7, v1
    v_min_u32 v6, 7040, v6
    buffer_load_dword v61, v6, s[40:43], s44 offen
    buffer_load_dword v62, v6, s[40:43], s45 offen
    s_mov_b32 s40, s10
    s_mov_b32 s41, s11
    s_mov_b32 s42, 7340032
    s_mov_b32 s43, 0x20000
    s_lshl_b32 s44, s2, 2
    s_add_u32 s44, s44, s14
    s_mul_i32 s44, s44, 7168
    v_lshlrev_b32 v6, 7, v1
    v_add_u32 v6, 0, v6
    v_min_u32 v6, 7040, v6
    buffer_load_dword v60, v6, s[40:43], s44 offen
    v_pk_add_f32 v[96:97], v[96:97], v[100:101]
    v_pk_add_f32 v[98:99], v[98:99], v[102:103]
    v_pk_add_f32 v[104:105], v[104:105], v[108:109]
    v_pk_add_f32 v[106:107], v[106:107], v[110:111]
    v_pk_add_f32 v[96:97], v[96:97], v[104:105]
    v_pk_add_f32 v[98:99], v[98:99], v[106:107]
    v_mov_b32 v100, v96
    v_mov_b32 v101, v97
    v_mov_b32_e64 v102, v98
    v_mov_b32 v103, v99
    s_nop 1
    v_permlane16_swap_b32 v96, v100
    v_permlane16_swap_b32 v97, v101
    v_permlane16_swap_b32 v98, v102
    v_permlane16_swap_b32 v99, v103
    v_add_f32 v96, v96, v100
    v_add_f32 v97, v97, v101
    v_add_f32 v98, v98, v102
    v_add_f32 v99, v99, v103
    v_mov_b32 v100, v96
    v_mov_b32 v101, v97
    v_mov_b32_e64 v102, v98
    v_mov_b32 v103, v99
    s_nop 1
    v_permlane32_swap_b32 v96, v100
    v_permlane32_swap_b32 v97, v101
    v_permlane32_swap_b32 v98, v102
    v_permlane32_swap_b32 v99, v103
    v_add_f32 v96, v96, v100
    v_add_f32 v97, v97, v101
    v_add_f32 v98, v98, v102
    v_add_f32 v99, v99, v103
    v_lshlrev_b32_e64 v100, 16, v112
    v_and_b32 v101, 0xffff0000, v112
    v_lshlrev_b32_e64 v102, 16, v113
    v_and_b32 v103, 0xffff0000, v113
    s_mul_i32 s52, s14, 224
    s_add_u32 s52, s52, 148480
    v_add_u32_e64 v20, s52, v20
    s_mov_b64 exec, 0x3fff
    ds_write_b128 v20, v[96:99]
    ds_write_b128 v20, v[100:103] offset:896
    s_mov_b64 exec, -1
    s_waitcnt lgkmcnt(0)
    s_waitcnt vmcnt(17)
    s_barrier
    s_branch sequential_preLN__ssm_conv_h3__dense_activation_squared_relu__prompt_kernel_g_hfin
sequential_preLN__ssm_conv_h3__dense_activation_squared_relu__prompt_kernel_g_h0_xs:
    s_cmp_eq_u32 s22, 1
    s_cbranch_scc1 sequential_preLN__ssm_conv_h3__dense_activation_squared_relu__prompt_kernel_g_h0_x1
    s_cmp_eq_u32 s22, 3
    s_cbranch_scc1 sequential_preLN__ssm_conv_h3__dense_activation_squared_relu__prompt_kernel_g_h0_x2
    s_cmp_eq_u32 s22, 4
    s_cbranch_scc0 sequential_preLN__ssm_conv_h3__dense_activation_squared_relu__prompt_kernel_g_h0_back
    s_cmp_lg_u32 s14, 0
    s_cbranch_scc1 sequential_preLN__ssm_conv_h3__dense_activation_squared_relu__prompt_kernel_g_h0_back
    s_nop 0
    v_add_u32 v21, 148480, v5
    v_cmp_gt_u32 vcc, 56, v1
    s_and_saveexec_b64 s[48:49], vcc
    ds_read_b128 v[96:99], v21
    ds_read_b128 v[100:103], v21 offset:1792
    ds_read_b128 v[104:107], v21 offset:2688
    ds_read_b128 v[108:111], v21 offset:3584
    s_waitcnt lgkmcnt(0)
    s_nop 0
    v_pk_add_f32 v[96:97], v[96:97], v[100:101]
    v_pk_add_f32 v[98:99], v[98:99], v[102:103]
    v_pk_add_f32 v[104:105], v[104:105], v[108:109]
    v_pk_add_f32 v[106:107], v[106:107], v[110:111]
    v_pk_add_f32 v[96:97], v[96:97], v[104:105]
    v_pk_add_f32 v[98:99], v[98:99], v[106:107]
    ds_write_b128 v21, v[96:99]
    s_mov_b64 exec, s[48:49]
    s_waitcnt lgkmcnt(0)
    s_branch sequential_preLN__ssm_conv_h3__dense_activation_squared_relu__prompt_kernel_g_h0_back
sequential_preLN__ssm_conv_h3__dense_activation_squared_relu__prompt_kernel_g_h0_x1:
    s_nop 0
    s_add_u32 s36, s12, 31522816
    s_addc_u32 s37, s13, 0
    s_nop 0
    s_mov_b32 s38, 229376
    s_mov_b32 s39, 0x20000
    s_mov_b32 s40, s8
    s_mov_b32 s41, s9
    s_mov_b32 s42, 7168
    s_mov_b32 s43, 0x20000
    s_mul_i32 s20, s16, 896
    s_mul_i32 s23, s14, 57344
    s_add_u32 s20, s20, s23
    s_nop 0
    s_mul_i32 s23, s16, 448
    v_lshlrev_b32_e64 v22, 3, v1
    buffer_load_dwordx4 v[96:99], v5, s[36:39], s20 offen sc1
    s_add_u32 s20, s20, 14336
    buffer_load_dwordx4 v[100:103], v5, s[36:39], s20 offen sc1
    s_add_u32 s20, s20, 14336
    buffer_load_dwordx4 v[104:107], v5, s[36:39], s20 offen sc1
    s_add_u32 s20, s20, 14336
    buffer_load_dwordx4 v[108:111], v5, s[36:39], s20 offen sc1
    buffer_load_dwordx2 v[112:113], v22, s[40:43], s23 offen
    s_branch sequential_preLN__ssm_conv_h3__dense_activation_squared_relu__prompt_kernel_g_h0_back
sequential_preLN__ssm_conv_h3__dense_activation_squared_relu__prompt_kernel_g_h0_x2:
    s_nop 0
    v_pk_add_f32 v[96:97], v[96:97], v[100:101]
    v_pk_add_f32 v[98:99], v[98:99], v[102:103]
    v_pk_add_f32 v[104:105], v[104:105], v[108:109]
    v_pk_add_f32 v[106:107], v[106:107], v[110:111]
    v_pk_add_f32 v[96:97], v[96:97], v[104:105]
    v_pk_add_f32 v[98:99], v[98:99], v[106:107]
    v_lshlrev_b32_e64 v100, 16, v112
    v_and_b32 v101, 0xffff0000, v112
    v_lshlrev_b32_e64 v102, 16, v113
    v_and_b32 v103, 0xffff0000, v113
    v_add_u32 v20, 148480, v5
    s_mul_i32 s20, s14, 896
    s_cmp_eq_u32 s14, 0
    s_nop 0
    s_cselect_b32 s23, 0, 896
    s_add_u32 s20, s20, s23
    v_add_u32 v21, s20, v20
    v_cmp_gt_u32 vcc, 56, v1
    s_and_saveexec_b64 s[48:49], vcc
    ds_write_b128 v21, v[96:99]
    ds_write_b128 v20, v[100:103] offset:896
    s_mov_b64 exec, s[48:49]
    s_waitcnt lgkmcnt(0)
    s_branch sequential_preLN__ssm_conv_h3__dense_activation_squared_relu__prompt_kernel_g_h0_back
sequential_preLN__ssm_conv_h3__dense_activation_squared_relu__prompt_kernel_g_h1:
    s_nop 0
    v_mov_b32 v6, 150544
    s_mov_b32 s61, 0
sequential_preLN__ssm_conv_h3__dense_activation_squared_relu__prompt_kernel_g_h1_ar:
    s_sleep 2
    ds_read_b32 v41, v6 offset:36
    s_add_u32 s61, s61, 1
    s_waitcnt lgkmcnt(0)
    v_readfirstlane_b32 s62, v41
    s_nop 0
    s_cmp_gt_u32 s61, 0x400000
    s_cbranch_scc1 sequential_preLN__ssm_conv_h3__dense_activation_squared_relu__prompt_kernel_g_h1_arx
    s_cmp_lt_u32 s62, 4
    s_cbranch_scc1 sequential_preLN__ssm_conv_h3__dense_activation_squared_relu__prompt_kernel_g_h1_ar
sequential_preLN__ssm_conv_h3__dense_activation_squared_relu__prompt_kernel_g_h1_arx:
    s_add_u32 m0, 0, s18
    s_nop 0
    s_nop 0
    buffer_load_dwordx4 v116, s[24:27], s33 offen  lds
    buffer_load_dwordx4 v117, s[24:27], s33 offen offset:1024  lds
    buffer_load_dwordx4 v118, s[24:27], s33 offen offset:2048  lds
    s_add_u32 s33, s33, 229376
    s_cmp_eq_u32 s33, 7340032
    s_cselect_b32 s33, 0, s33
    s_nop 0
    s_add_u32 m0, 22528, s18
    s_nop 0
    s_nop 0
    buffer_load_dwordx4 v116, s[24:27], s33 offen  lds
    buffer_load_dwordx4 v117, s[24:27], s33 offen offset:1024  lds
    buffer_load_dwordx4 v118, s[24:27], s33 offen offset:2048  lds
    s_add_u32 s33, s33, 229376
    s_cmp_eq_u32 s33, 7340032
    s_cselect_b32 s33, 0, s33
    s_nop 0
    s_add_u32 m0, 45056, s18
    s_nop 0
    s_nop 0
    buffer_load_dwordx4 v116, s[24:27], s33 offen  lds
    buffer_load_dwordx4 v117, s[24:27], s33 offen offset:1024  lds
    buffer_load_dwordx4 v118, s[24:27], s33 offen offset:2048  lds
    s_add_u32 s33, s33, 229376
    s_cmp_eq_u32 s33, 7340032
    s_cselect_b32 s33, 0, s33
    s_nop 0
    s_add_u32 m0, 67584, s18
    s_nop 0
    s_nop 0
    buffer_load_dwordx4 v116, s[24:27], s33 offen  lds
    buffer_load_dwordx4 v117, s[24:27], s33 offen offset:1024  lds
    buffer_load_dwordx4 v118, s[24:27], s33 offen offset:2048  lds
    s_add_u32 s33, s33, 229376
    s_cmp_eq_u32 s33, 7340032
    s_cselect_b32 s33, 0, s33
    s_nop 0
    s_add_u32 m0, 90112, s18
    s_nop 0
    s_nop 0
    buffer_load_dwordx4 v116, s[24:27], s33 offen  lds
    buffer_load_dwordx4 v117, s[24:27], s33 offen offset:1024  lds
    buffer_load_dwordx4 v118, s[24:27], s33 offen offset:2048  lds
    s_add_u32 s33, s33, 229376
    s_cmp_eq_u32 s33, 7340032
    s_cselect_b32 s33, 0, s33
    s_nop 0
    s_add_u32 m0, 112640, s18
    s_nop 0
    s_nop 0
    buffer_load_dwordx4 v116, s[24:27], s33 offen  lds
    buffer_load_dwordx4 v117, s[24:27], s33 offen offset:1024  lds
    buffer_load_dwordx4 v118, s[24:27], s33 offen offset:2048  lds
    s_add_u32 s33, s33, 229376
    s_cmp_eq_u32 s33, 7340032
    s_cselect_b32 s33, 0, s33
    s_barrier
    s_mov_b32 s32, 0
    s_add_u32 m0, 0, s19
    s_nop 0
    s_nop 0
    buffer_load_dwordx4 v9, s[28:31], s34 offen sc1 lds
    buffer_load_dwordx4 v10, s[28:31], s34 offen offset:1024 sc1 lds
    s_add_u32 s34, s34, 131072
    s_and_b32 s34, s34, 0x3fffff
    s_add_u32 m0, 22528, s19
    s_nop 0
    s_nop 0
    buffer_load_dwordx4 v9, s[28:31], s34 offen sc1 lds
    buffer_load_dwordx4 v10, s[28:31], s34 offen offset:1024 sc1 lds
    s_add_u32 s34, s34, 131072
    s_and_b32 s34, s34, 0x3fffff
    s_waitcnt vmcnt(2)
    s_barrier
    s_add_u32 m0, 45056, s19
    s_nop 0
    s_nop 0
    buffer_load_dwordx4 v9, s[28:31], s34 offen sc1 lds
    buffer_load_dwordx4 v10, s[28:31], s34 offen offset:1024 sc1 lds
    s_add_u32 s34, s34, 131072
    s_and_b32 s34, s34, 0x3fffff
    s_add_u32 m0, 67584, s19
    s_nop 0
    s_nop 0
    buffer_load_dwordx4 v9, s[28:31], s34 offen sc1 lds
    buffer_load_dwordx4 v10, s[28:31], s34 offen offset:1024 sc1 lds
    s_add_u32 s34, s34, 131072
    s_and_b32 s34, s34, 0x3fffff
    s_add_u32 m0, 90112, s19
    s_nop 0
    s_nop 0
    buffer_load_dwordx4 v9, s[28:31], s34 offen sc1 lds
    buffer_load_dwordx4 v10, s[28:31], s34 offen offset:1024 sc1 lds
    s_add_u32 s34, s34, 131072
    s_and_b32 s34, s34, 0x3fffff
    s_add_u32 m0, 112640, s19
    s_nop 0
    s_nop 0
    buffer_load_dwordx4 v9, s[28:31], s34 offen sc1 lds
    buffer_load_dwordx4 v10, s[28:31], s34 offen offset:1024 sc1 lds
    s_add_u32 s34, s34, 131072
    s_and_b32 s34, s34, 0x3fffff
    s_waitcnt vmcnt(8)
    s_barrier
    s_add_u32 m0, 0, s18
    s_nop 0
    buffer_load_dwordx4 v116, s[24:27], s33 offen  lds
    buffer_load_dwordx4 v117, s[24:27], s33 offen offset:1024  lds
    buffer_load_dwordx4 v118, s[24:27], s33 offen offset:2048  lds
    s_add_u32 s33, s33, 229376
    s_cmp_eq_u32 s33, 7340032
    s_cselect_b32 s33, 0, s33
    s_waitcnt vmcnt(9)
    s_barrier
    s_waitcnt vmcnt(5)
    s_barrier
    s_add_u32 m0, 0, s19
    s_nop 0
    s_nop 0
    buffer_load_dwordx4 v9, s[28:31], s34 offen sc1 lds
    buffer_load_dwordx4 v10, s[28:31], s34 offen offset:1024 sc1 lds
    s_add_u32 s34, s34, 131072
    s_and_b32 s34, s34, 0x3fffff
    s_mov_b32 s32, 22528
    s_add_u32 m0, s32, s18
    s_add_u32 s50, s32, s19
    buffer_load_dwordx4 v116, s[24:27], s33 offen  lds
    buffer_load_dwordx4 v117, s[24:27], s33 offen offset:1024  lds
    buffer_load_dwordx4 v118, s[24:27], s33 offen offset:2048  lds
    s_mov_b32 m0, s50
    s_nop 0
    s_add_u32 s33, s33, 229376
    buffer_load_dwordx4 v9, s[28:31], s34 offen sc1 lds
    buffer_load_dwordx4 v10, s[28:31], s34 offen offset:1024 sc1 lds
    s_add_u32 s34, s34, 131072
    s_and_b32 s34, s34, 0x3fffff
    s_cmp_eq_u32 s33, 7340032
    s_cselect_b32 s33, 0, s33
    s_nop 0
    s_add_u32 s32, s32, 22528
    s_cmp_eq_u32 s32, 135168
    s_cselect_b32 s32, 0, s32
    s_add_u32 m0, s32, s18
    s_add_u32 s50, s32, s19
    s_nop 0
    buffer_load_dwordx4 v116, s[24:27], s33 offen  lds
    buffer_load_dwordx4 v117, s[24:27], s33 offen offset:1024  lds
    buffer_load_dwordx4 v118, s[24:27], s33 offen offset:2048  lds
    s_mov_b32 m0, s50
    s_nop 0
    s_add_u32 s33, s33, 229376
    buffer_load_dwordx4 v9, s[28:31], s34 offen sc1 lds
    buffer_load_dwordx4 v10, s[28:31], s34 offen offset:1024 sc1 lds
    s_add_u32 s34, s34, 131072
    s_and_b32 s34, s34, 0x3fffff
    s_cmp_eq_u32 s33, 7340032
    s_cselect_b32 s33, 0, s33
    s_nop 0
    s_add_u32 s32, s32, 22528
    s_cmp_eq_u32 s32, 135168
    s_cselect_b32 s32, 0, s32
    s_mov_b32 s22, 1
    s_branch sequential_preLN__ssm_conv_h3__dense_activation_squared_relu__prompt_kernel_g_h1_back
    s_mov_b32 s22, 1
sequential_preLN__ssm_conv_h3__dense_activation_squared_relu__prompt_kernel_g_h1_loop:
    s_waitcnt vmcnt(10)
    s_barrier
    s_add_u32 m0, s32, s18
    s_add_u32 s50, s32, s19
    buffer_load_dwordx4 v116, s[24:27], s33 offen  lds
    buffer_load_dwordx4 v117, s[24:27], s33 offen offset:1024  lds
    buffer_load_dwordx4 v118, s[24:27], s33 offen offset:2048  lds
    s_mov_b32 m0, s50
    s_nop 0
    s_add_u32 s33, s33, 229376
    buffer_load_dwordx4 v9, s[28:31], s34 offen sc1 lds
    buffer_load_dwordx4 v10, s[28:31], s34 offen offset:1024 sc1 lds
    s_add_u32 s34, s34, 131072
    s_and_b32 s34, s34, 0x3fffff
    s_cmp_eq_u32 s33, 7340032
    s_cselect_b32 s33, 0, s33
    s_nop 0
    s_add_u32 s32, s32, 22528
    s_cmp_eq_u32 s32, 135168
    s_cselect_b32 s32, 0, s32
    s_add_u32 m0, s32, s18
    s_add_u32 s50, s32, s19
    s_nop 0
    buffer_load_dwordx4 v116, s[24:27], s33 offen  lds
    buffer_load_dwordx4 v117, s[24:27], s33 offen offset:1024  lds
    buffer_load_dwordx4 v118, s[24:27], s33 offen offset:2048  lds
    s_mov_b32 m0, s50
    s_nop 0
    s_add_u32 s33, s33, 229376
    buffer_load_dwordx4 v9, s[28:31], s34 offen sc1 lds
    buffer_load_dwordx4 v10, s[28:31], s34 offen offset:1024 sc1 lds
    s_add_u32 s34, s34, 131072
    s_and_b32 s34, s34, 0x3fffff
    s_cmp_eq_u32 s33, 7340032
    s_cselect_b32 s33, 0, s33
    s_nop 0
    s_add_u32 s32, s32, 22528
    s_cmp_eq_u32 s32, 135168
    s_cselect_b32 s32, 0, s32
    s_cmp_lg_u32 s22, 6
    s_cbranch_scc1 sequential_preLN__ssm_conv_h3__dense_activation_squared_relu__prompt_kernel_g_h1_ncs
    s_nop 0
    s_add_u32 s40, s12, 31522816
    s_addc_u32 s41, s13, 0
    s_nop 0
    s_mov_b32 s42, 229376
    s_mov_b32 s43, 0x20000
    buffer_load_dwordx4 v[96:99], v19, s[40:43], s53 offen sc1
    s_add_u32 s53, s53, 14336
    buffer_load_dwordx4 v[100:103], v19, s[40:43], s53 offen sc1
    s_add_u32 s53, s53, 14336
    buffer_load_dwordx4 v[104:107], v19, s[40:43], s53 offen sc1
    s_add_u32 s53, s53, 14336
    buffer_load_dwordx4 v[108:111], v19, s[40:43], s53 offen sc1
sequential_preLN__ssm_conv_h3__dense_activation_squared_relu__prompt_kernel_g_h1_ncs:
    s_cmp_lg_u32 s22, 9
    s_cbranch_scc1 sequential_preLN__ssm_conv_h3__dense_activation_squared_relu__prompt_kernel_g_h1_nc
    s_getpc_b64 s[44:45]
sequential_preLN__ssm_conv_h3__dense_activation_squared_relu__prompt_kernel_g_h1_pc:
    s_nop 0
    s_add_u32 s44, s44, sequential_preLN__ssm_conv_h3__dense_activation_squared_relu__prompt_kernel_g_hfin-sequential_preLN__ssm_conv_h3__dense_activation_squared_relu__prompt_kernel_g_h1_pc
    s_addc_u32 s45, s45, 0
    s_lshl_b32 s20, s14, 13
    v_lshlrev_b32 v6, 7, v1
    v_add_u32 v6, s20, v6
    v_min_u32 v6, code_end_lbl-sequential_preLN__ssm_conv_h3__dense_activation_squared_relu__prompt_kernel_g_hfin-4, v6
    global_load_dword v63, v6, s[44:45]
sequential_preLN__ssm_conv_h3__dense_activation_squared_relu__prompt_kernel_g_h1_nc:
sequential_preLN__ssm_conv_h3__dense_activation_squared_relu__prompt_kernel_g_h1_back:
    s_add_u32 s22, s22, 1
    s_cmp_lt_u32 s22, 13
    s_cbranch_scc1 sequential_preLN__ssm_conv_h3__dense_activation_squared_relu__prompt_kernel_g_h1_loop
    s_waitcnt vmcnt(10)
    s_barrier
    s_add_u32 m0, s32, s18
    s_add_u32 s50, s32, s19
    s_nop 0
    buffer_load_dwordx4 v116, s[24:27], s33 offen  lds
    buffer_load_dwordx4 v117, s[24:27], s33 offen offset:1024  lds
    buffer_load_dwordx4 v118, s[24:27], s33 offen offset:2048  lds
    s_mov_b32 m0, s50
    s_nop 0
    s_add_u32 s33, s33, 229376
    buffer_load_dwordx4 v9, s[28:31], s34 offen sc1 lds
    buffer_load_dwordx4 v10, s[28:31], s34 offen offset:1024 sc1 lds
    s_add_u32 s34, s34, 131072
    s_and_b32 s34, s34, 0x3fffff
    s_cmp_eq_u32 s33, 7340032
    s_cselect_b32 s33, 0, s33
    s_nop 0
    s_add_u32 s32, s32, 22528
    s_cmp_eq_u32 s32, 135168
    s_cselect_b32 s32, 0, s32
    s_setprio 3
    s_add_u32 s36, s12, 32505856
    s_addc_u32 s37, s13, 0
    s_nop 0
    s_mov_b32 s38, 262144
    s_mov_b32 s39, 0x20000
    v_and_b32_e64 v22, 31, v1
    v_lshlrev_b32 v22, 3, v22
    s_lshl_b32 s20, s15, 14
    s_lshl_b32 s23, s14, 8
    s_add_u32 s20, s20, s23
    s_add_u32 s23, s20, 4096
    v_lshrrev_b32_e64 v23, 5, v1
    v_lshl_add_u32 v23, v23, 13, v22
    buffer_load_dwordx2 v[32:33], v23, s[36:39], s20 offen offset:0 sc1
    buffer_load_dwordx2 v[34:35], v23, s[36:39], s20 offen offset:1024 sc1
    buffer_load_dwordx2 v[36:37], v23, s[36:39], s20 offen offset:2048 sc1
    buffer_load_dwordx2 v[38:39], v23, s[36:39], s20 offen offset:3072 sc1
    buffer_load_dwordx2 v[40:41], v23, s[36:39], s23 offen offset:0 sc1
    buffer_load_dwordx2 v[42:43], v23, s[36:39], s23 offen offset:1024 sc1
    buffer_load_dwordx2 v[44:45], v23, s[36:39], s23 offen offset:2048 sc1
    buffer_load_dwordx2 v[46:47], v23, s[36:39], s23 offen offset:3072 sc1
    s_add_u32 s40, s12, 0
    s_addc_u32 s41, s13, 0
    s_mov_b32 s42, 14680064
    s_mov_b32 s43, 0x20000
    s_lshl_b32 s44, s15, 3
    s_lshl_b32 s45, s14, 1
    s_add_u32 s44, s44, s45
    s_nop 0
    s_mul_i32 s44, s44, 114688
    s_mul_i32 s45, s16, 7168
    s_add_u32 s44, s44, s45
    s_nop 0
    s_add_u32 s45, s44, 114688
    v_lshlrev_b32_e64 v6, 7, v1
    v_min_u32 v6, 7040, v6
    buffer_load_dword v61, v6, s[40:43], s44 offen
    buffer_load_dword v62, v6, s[40:43], s45 offen
    s_mov_b32 s40, s10
    s_mov_b32 s41, s11
    s_mov_b32 s42, 7340032
    s_mov_b32 s43, 0x20000
    s_lshl_b32 s44, s2, 2
    s_add_u32 s44, s44, s14
    s_mul_i32 s44, s44, 7168
    v_lshlrev_b32 v6, 7, v1
    v_add_u32 v6, 0, v6
    v_min_u32 v6, 7040, v6
    buffer_load_dword v60, v6, s[40:43], s44 offen
    v_pk_add_f32 v[96:97], v[96:97], v[100:101]
    v_pk_add_f32 v[98:99], v[98:99], v[102:103]
    v_pk_add_f32 v[104:105], v[104:105], v[108:109]
    v_pk_add_f32 v[106:107], v[106:107], v[110:111]
    v_pk_add_f32 v[96:97], v[96:97], v[104:105]
    v_pk_add_f32 v[98:99], v[98:99], v[106:107]
    v_mov_b32 v100, v96
    v_mov_b32 v101, v97
    v_mov_b32_e64 v102, v98
    v_mov_b32 v103, v99
    s_nop 1
    v_permlane16_swap_b32 v96, v100
    v_permlane16_swap_b32 v97, v101
    v_permlane16_swap_b32 v98, v102
    v_permlane16_swap_b32 v99, v103
    v_add_f32 v96, v96, v100
    v_add_f32 v97, v97, v101
    v_add_f32 v98, v98, v102
    v_add_f32 v99, v99, v103
    v_mov_b32 v100, v96
    v_mov_b32 v101, v97
    v_mov_b32_e64 v102, v98
    v_mov_b32 v103, v99
    s_nop 1
    v_permlane32_swap_b32 v96, v100
    v_permlane32_swap_b32 v97, v101
    v_permlane32_swap_b32 v98, v102
    v_permlane32_swap_b32 v99, v103
    v_add_f32 v96, v96, v100
    v_add_f32 v97, v97, v101
    v_add_f32 v98, v98, v102
    v_add_f32 v99, v99, v103
    v_lshlrev_b32_e64 v100, 16, v112
    v_and_b32 v101, 0xffff0000, v112
    v_lshlrev_b32_e64 v102, 16, v113
    v_and_b32 v103, 0xffff0000, v113
    s_mul_i32 s52, s14, 224
    s_add_u32 s52, s52, 148480
    v_add_u32_e64 v20, s52, v20
    s_mov_b64 exec, 0x3fff
    ds_write_b128 v20, v[96:99]
    ds_write_b128 v20, v[100:103] offset:896
    s_mov_b64 exec, -1
    s_waitcnt lgkmcnt(0)
    s_waitcnt vmcnt(16)
    s_barrier
    s_branch sequential_preLN__ssm_conv_h3__dense_activation_squared_relu__prompt_kernel_g_hfin
sequential_preLN__ssm_conv_h3__dense_activation_squared_relu__prompt_kernel_g_h1_xs:
    s_cmp_eq_u32 s22, 1
    s_cbranch_scc1 sequential_preLN__ssm_conv_h3__dense_activation_squared_relu__prompt_kernel_g_h1_x1
    s_cmp_eq_u32 s22, 3
    s_cbranch_scc1 sequential_preLN__ssm_conv_h3__dense_activation_squared_relu__prompt_kernel_g_h1_x2
    s_cmp_eq_u32 s22, 4
    s_cbranch_scc0 sequential_preLN__ssm_conv_h3__dense_activation_squared_relu__prompt_kernel_g_h1_back
    s_branch sequential_preLN__ssm_conv_h3__dense_activation_squared_relu__prompt_kernel_g_h1_back
sequential_preLN__ssm_conv_h3__dense_activation_squared_relu__prompt_kernel_g_h1_x1:
    s_add_u32 s36, s12, 31522816
    s_addc_u32 s37, s13, 0
    s_nop 0
    s_mov_b32 s38, 229376
    s_mov_b32 s39, 0x20000
    s_mov_b32 s40, s8
    s_mov_b32 s41, s9
    s_mov_b32 s42, 7168
    s_mov_b32 s43, 0x20000
    s_mul_i32 s20, s16, 896
    s_mul_i32 s23, s14, 57344
    s_add_u32 s20, s20, s23
    s_nop 0
    s_mul_i32 s23, s16, 448
    v_lshlrev_b32_e64 v22, 3, v1
    buffer_load_dwordx4 v[96:99], v5, s[36:39], s20 offen sc1
    s_add_u32 s20, s20, 14336
    buffer_load_dwordx4 v[100:103], v5, s[36:39], s20 offen sc1
    s_add_u32 s20, s20, 14336
    buffer_load_dwordx4 v[104:107], v5, s[36:39], s20 offen sc1
    s_add_u32 s20, s20, 14336
    buffer_load_dwordx4 v[108:111], v5, s[36:39], s20 offen sc1
    buffer_load_dwordx2 v[112:113], v22, s[40:43], s23 offen
    s_branch sequential_preLN__ssm_conv_h3__dense_activation_squared_relu__prompt_kernel_g_h1_back
sequential_preLN__ssm_conv_h3__dense_activation_squared_relu__prompt_kernel_g_h1_x2:
    s_nop 0
    v_pk_add_f32 v[96:97], v[96:97], v[100:101]
    v_pk_add_f32 v[98:99], v[98:99], v[102:103]
    v_pk_add_f32 v[104:105], v[104:105], v[108:109]
    v_pk_add_f32 v[106:107], v[106:107], v[110:111]
    v_pk_add_f32 v[96:97], v[96:97], v[104:105]
    v_pk_add_f32 v[98:99], v[98:99], v[106:107]
    v_lshlrev_b32_e64 v100, 16, v112
    v_and_b32 v101, 0xffff0000, v112
    v_lshlrev_b32_e64 v102, 16, v113
    v_and_b32 v103, 0xffff0000, v113
    v_add_u32 v20, 148480, v5
    s_mul_i32 s20, s14, 896
    s_cmp_eq_u32 s14, 0
    s_nop 0
    s_cselect_b32 s23, 0, 896
    s_add_u32 s20, s20, s23
    v_add_u32 v21, s20, v20
    v_cmp_gt_u32 vcc, 56, v1
    s_and_saveexec_b64 s[48:49], vcc
    ds_write_b128 v21, v[96:99]
    ds_write_b128 v20, v[100:103] offset:896
    s_mov_b64 exec, s[48:49]
    s_waitcnt lgkmcnt(0)
    s_branch sequential_preLN__ssm_conv_h3__dense_activation_squared_relu__prompt_kernel_g_h1_back
sequential_preLN__ssm_conv_h3__dense_activation_squared_relu__prompt_kernel_g_hfin:
    s_mov_b32 s22, 0
    s_waitcnt vmcnt(3)
sequential_preLN__ssm_conv_h3__dense_activation_squared_relu__prompt_kernel_g_pchk:
    s_nop 0
    v_max3_u32 v20, v33, v35, v37
    v_max3_u32 v20, v20, v39, v41
    v_max3_u32 v20, v20, v43, v45
    v_max_u32 v20, v20, v47
    v_cmp_eq_u32 vcc, -1, v20
    s_cmp_gt_u32 s22, 0x20000
    s_cbranch_scc1 sequential_preLN__ssm_conv_h3__dense_activation_squared_relu__prompt_kernel_g_pollx
    s_cbranch_vccz sequential_preLN__ssm_conv_h3__dense_activation_squared_relu__prompt_kernel_g_pollx
    buffer_load_dwordx2 v[32:33], v23, s[36:39], s20 offen offset:0 sc1
    buffer_load_dwordx2 v[34:35], v23, s[36:39], s20 offen offset:1024 sc1
    buffer_load_dwordx2 v[36:37], v23, s[36:39], s20 offen offset:2048 sc1
    buffer_load_dwordx2 v[38:39], v23, s[36:39], s20 offen offset:3072 sc1
    buffer_load_dwordx2 v[40:41], v23, s[36:39], s23 offen offset:0 sc1
    buffer_load_dwordx2 v[42:43], v23, s[36:39], s23 offen offset:1024 sc1
    buffer_load_dwordx2 v[44:45], v23, s[36:39], s23 offen offset:2048 sc1
    buffer_load_dwordx2 v[46:47], v23, s[36:39], s23 offen offset:3072 sc1
    s_add_u32 s22, s22, 1
    s_waitcnt vmcnt(0)
    s_branch sequential_preLN__ssm_conv_h3__dense_activation_squared_relu__prompt_kernel_g_pchk
sequential_preLN__ssm_conv_h3__dense_activation_squared_relu__prompt_kernel_g_pollx:
    s_nop 0
    v_pk_add_f32 v[32:33], v[32:33], v[40:41]
    v_pk_add_f32 v[34:35], v[34:35], v[42:43]
    v_pk_add_f32 v[36:37], v[36:37], v[44:45]
    v_pk_add_f32 v[38:39], v[38:39], v[46:47]
    v_pk_add_f32 v[32:33], v[32:33], v[36:37]
    v_pk_add_f32 v[34:35], v[34:35], v[38:39]
    v_pk_add_f32 v[16:17], v[32:33], v[34:35]
    v_mov_b32_e64 v24, v16
    v_mov_b32 v25, v17
    s_nop 1
    v_permlane32_swap_b32 v16, v24
    v_permlane32_swap_b32 v17, v25
    v_pk_add_f32 v[16:17], v[16:17], v[24:25]
    s_mov_b32 s20, 0x3a800000
    v_mul_f32 v16, s20, v16
    v_mul_f32 v17, s20, v17
    v_fma_f32 v17, -v16, v16, v17
    v_max_f32_e64 v17, 0, v17
    v_cvt_pk_bf16_f32 v18, v16, v17
    v_lshlrev_b32_e64 v16, 16, v18
    v_and_b32 v17, 0xffff0000, v18
    v_add_f32 v17, 0x3727c5ac, v17
    v_cvt_pk_bf16_f32 v17, v17, v17
    v_lshlrev_b32_e64 v17, 16, v17
    v_sqrt_f32 v17, v17
    s_nop 0
    v_cvt_pk_bf16_f32 v17, v17, v17
    v_lshlrev_b32_e64 v17, 16, v17
    v_rcp_f32 v18, v17
    s_lshl_b32 s20, s14, 8
    s_add_u32 s20, s20, 147456
    v_mul_f32 v19, -v16, v18
    v_add_u32_e64 v22, s20, v22
    ds_write_b64 v22, v[18:19]
    s_waitcnt lgkmcnt(0)
    s_setprio 0
    s_barrier
    s_barrier
    s_bfe_u32 s34, s2, 0x10002
    s_lshr_b32 s3, s2, 5
    s_xor_b32 s16, s3, 0
    v_lshrrev_b32 v8, 3, v1
    v_and_b32 v9, 6, v8
    v_and_b32_e64 v10, 7, v1
    v_xor_b32 v9, v9, v10
    s_lshl_b32 s18, s14, 3
    v_add_u32 v8, s18, v8
    s_lshr_b32 s19, s10, 7
    s_add_u32 s20, s12, 37748736
    s_addc_u32 s21, s13, 0
    s_lshl_b32 s17, s16, 1
    s_xor_b32 s18, s34, 0
    s_add_u32 s17, s17, s18
    s_add_u32 s18, s17, s19
    s_and_b32 s18, s18, 7
    s_lshr_b32 s23, s17, 3
    s_nop 0
    s_mul_i32 s23, s23, 458752
    s_lshl_b32 s17, s17, 7
    s_cmp_eq_u32 s18, 8
    s_cselect_b32 s24, s20, s10
    s_cselect_b32 s25, s21, s11
    s_cselect_b32 s28, 12, 16
    s_cselect_b32 s17, s23, s17
    s_cselect_b32 s18, 7, 11
    s_nop 0
    s_mov_b32 s26, 7340032
    s_mov_b32 s27, 0x20000
    v_lshlrev_b32_e64 v7, s18, v8
    v_lshl_add_u32 v7, v9, 4, v7
    v_add_u32_e64 v7, s17, v7
    s_lshl_b32 s17, s16, 1
    s_xor_b32 s18, s34, 1
    s_add_u32 s17, s17, s18
    s_add_u32 s18, s17, s19
    s_and_b32 s18, s18, 7
    s_lshr_b32 s23, s17, 3
    s_mul_i32 s23, s23, 458752
    s_lshl_b32 s17, s17, 7
    s_cmp_eq_u32 s18, 8
    s_cselect_b32 s40, s20, s10
    s_cselect_b32 s41, s21, s11
    s_cselect_b32 s31, 12, 16
    s_cselect_b32 s17, s23, s17
    s_cselect_b32 s18, 7, 11
    s_nop 0
    s_mov_b32 s42, 7340032
    s_mov_b32 s43, 0x20000
    v_lshlrev_b32_e64 v15, s18, v8
    v_lshl_add_u32 v15, v9, 4, v15
    v_add_u32_e64 v15, s17, v15
    s_mul_i32 s29, s34, 56
    s_lshl_b32 s30, s14, 10
    s_add_u32 s44, s29, 56
    s_mov_b32 s45, s29
    s_mul_i32 s33, s3, 7
    s_add_u32 s29, s29, s33
    s_mov_b32 m0, s30
    s_lshl_b32 s46, s29, s28
    buffer_load_dwordx4 v7, s[24:27], s46 offen lds
    s_add_u32 m0, s30, 4096
    s_lshl_b32 s46, s29, s31
    s_nop 0
    buffer_load_dwordx4 v15, s[40:43], s46 offen lds
    s_add_u32 s29, s29, 1
    s_cmp_eq_u32 s29, s44
    s_cselect_b32 s29, s45, s29
    s_nop 0
    s_add_u32 m0, s30, 8192
    s_lshl_b32 s46, s29, s28
    s_nop 0
    buffer_load_dwordx4 v7, s[24:27], s46 offen lds
    s_add_u32 m0, s30, 12288
    s_lshl_b32 s46, s29, s31
    s_nop 0
    buffer_load_dwordx4 v15, s[40:43], s46 offen lds
    s_add_u32 s29, s29, 1
    s_cmp_eq_u32 s29, s44
    s_cselect_b32 s29, s45, s29
    s_nop 0
    s_add_u32 m0, s30, 16384
    s_lshl_b32 s46, s29, s28
    s_nop 0
    buffer_load_dwordx4 v7, s[24:27], s46 offen lds
    s_add_u32 m0, s30, 20480
    s_lshl_b32 s46, s29, s31
    s_nop 0
    buffer_load_dwordx4 v15, s[40:43], s46 offen lds
    s_add_u32 s29, s29, 1
    s_cmp_eq_u32 s29, s44
    s_cselect_b32 s29, s45, s29
    s_nop 0
    s_add_u32 m0, s30, 24576
    s_lshl_b32 s46, s29, s28
    s_nop 0
    buffer_load_dwordx4 v7, s[24:27], s46 offen lds
    s_add_u32 m0, s30, 28672
    s_lshl_b32 s46, s29, s31
    s_nop 0
    buffer_load_dwordx4 v15, s[40:43], s46 offen lds
    s_add_u32 s29, s29, 1
    s_cmp_eq_u32 s29, s44
    s_cselect_b32 s29, s45, s29
    s_nop 0
    s_add_u32 s30, s30, 32768
    s_and_b32 s30, s30, 0x1ffff
    s_mov_b32 m0, s30
    s_lshl_b32 s46, s29, s28
    buffer_load_dwordx4 v7, s[24:27], s46 offen lds
    s_add_u32 m0, s30, 4096
    s_lshl_b32 s46, s29, s31
    s_nop 0
    buffer_load_dwordx4 v15, s[40:43], s46 offen lds
    s_add_u32 s29, s29, 1
    s_cmp_eq_u32 s29, s44
    s_cselect_b32 s29, s45, s29
    s_nop 0
    s_add_u32 m0, s30, 8192
    s_lshl_b32 s46, s29, s28
    s_nop 0
    buffer_load_dwordx4 v7, s[24:27], s46 offen lds
    s_add_u32 m0, s30, 12288
    s_lshl_b32 s46, s29, s31
    s_nop 0
    buffer_load_dwordx4 v15, s[40:43], s46 offen lds
    s_add_u32 s29, s29, 1
    s_cmp_eq_u32 s29, s44
    s_cselect_b32 s29, s45, s29
    s_nop 0
    s_add_u32 m0, s30, 16384
    s_lshl_b32 s46, s29, s28
    s_nop 0
    buffer_load_dwordx4 v7, s[24:27], s46 offen lds
    s_add_u32 m0, s30, 20480
    s_lshl_b32 s46, s29, s31
    s_nop 0
    buffer_load_dwordx4 v15, s[40:43], s46 offen lds
    s_add_u32 s29, s29, 1
    s_cmp_eq_u32 s29, s44
    s_cselect_b32 s29, s45, s29
    s_nop 0
    s_add_u32 m0, s30, 24576
    s_lshl_b32 s46, s29, s28
    s_nop 0
    buffer_load_dwordx4 v7, s[24:27], s46 offen lds
    s_add_u32 m0, s30, 28672
    s_lshl_b32 s46, s29, s31
    s_nop 0
    buffer_load_dwordx4 v15, s[40:43], s46 offen lds
    s_add_u32 s29, s29, 1
    s_cmp_eq_u32 s29, s44
    s_cselect_b32 s29, s45, s29
    s_nop 0
    s_add_u32 s30, s30, 32768
    s_and_b32 s30, s30, 0x1ffff
    s_waitcnt vmcnt(8)
    s_barrier
    s_barrier
    s_waitcnt vmcnt(0)
    s_barrier
    s_mov_b32 m0, s30
    s_lshl_b32 s46, s29, s28
    s_nop 0
    buffer_load_dwordx4 v7, s[24:27], s46 offen lds
    s_add_u32 m0, s30, 4096
    s_lshl_b32 s46, s29, s31
    s_nop 0
    buffer_load_dwordx4 v15, s[40:43], s46 offen lds
    s_add_u32 s29, s29, 1
    s_cmp_eq_u32 s29, s44
    s_cselect_b32 s29, s45, s29
    s_nop 0
    s_add_u32 m0, s30, 8192
    s_lshl_b32 s46, s29, s28
    s_nop 0
    buffer_load_dwordx4 v7, s[24:27], s46 offen lds
    s_add_u32 m0, s30, 12288
    s_lshl_b32 s46, s29, s31
    s_nop 0
    buffer_load_dwordx4 v15, s[40:43], s46 offen lds
    s_add_u32 s29, s29, 1
    s_cmp_eq_u32 s29, s44
    s_cselect_b32 s29, s45, s29
    s_nop 0
    s_add_u32 m0, s30, 16384
    s_lshl_b32 s46, s29, s28
    s_nop 0
    buffer_load_dwordx4 v7, s[24:27], s46 offen lds
    s_add_u32 m0, s30, 20480
    s_lshl_b32 s46, s29, s31
    s_nop 0
    buffer_load_dwordx4 v15, s[40:43], s46 offen lds
    s_add_u32 s29, s29, 1
    s_cmp_eq_u32 s29, s44
    s_cselect_b32 s29, s45, s29
    s_nop 0
    s_add_u32 m0, s30, 24576
    s_lshl_b32 s46, s29, s28
    s_nop 0
    buffer_load_dwordx4 v7, s[24:27], s46 offen lds
    s_add_u32 m0, s30, 28672
    s_lshl_b32 s46, s29, s31
    s_nop 0
    buffer_load_dwordx4 v15, s[40:43], s46 offen lds
    s_add_u32 s29, s29, 1
    s_cmp_eq_u32 s29, s44
    s_cselect_b32 s29, s45, s29
    s_nop 0
    s_add_u32 s30, s30, 32768
    s_and_b32 s30, s30, 0x1ffff
    s_mov_b32 m0, s30
    s_lshl_b32 s46, s29, s28
    buffer_load_dwordx4 v7, s[24:27], s46 offen lds
    s_add_u32 m0, s30, 4096
    s_lshl_b32 s46, s29, s31
    s_nop 0
    buffer_load_dwordx4 v15, s[40:43], s46 offen lds
    s_add_u32 s29, s29, 1
    s_cmp_eq_u32 s29, s44
    s_cselect_b32 s29, s45, s29
    s_nop 0
    s_add_u32 m0, s30, 8192
    s_lshl_b32 s46, s29, s28
    s_nop 0
    buffer_load_dwordx4 v7, s[24:27], s46 offen lds
    s_add_u32 m0, s30, 12288
    s_lshl_b32 s46, s29, s31
    s_nop 0
    buffer_load_dwordx4 v15, s[40:43], s46 offen lds
    s_add_u32 s29, s29, 1
    s_cmp_eq_u32 s29, s44
    s_cselect_b32 s29, s45, s29
    s_nop 0
    s_add_u32 m0, s30, 16384
    s_lshl_b32 s46, s29, s28
    s_nop 0
    buffer_load_dwordx4 v7, s[24:27], s46 offen lds
    s_add_u32 m0, s30, 20480
    s_lshl_b32 s46, s29, s31
    s_nop 0
    buffer_load_dwordx4 v15, s[40:43], s46 offen lds
    s_add_u32 s29, s29, 1
    s_cmp_eq_u32 s29, s44
    s_cselect_b32 s29, s45, s29
    s_nop 0
    s_add_u32 m0, s30, 24576
    s_lshl_b32 s46, s29, s28
    s_nop 0
    buffer_load_dwordx4 v7, s[24:27], s46 offen lds
    s_add_u32 m0, s30, 28672
    s_lshl_b32 s46, s29, s31
    s_nop 0
    buffer_load_dwordx4 v15, s[40:43], s46 offen lds
    s_add_u32 s29, s29, 1
    s_cmp_eq_u32 s29, s44
    s_cselect_b32 s29, s45, s29
    s_nop 0
    s_add_u32 s30, s30, 32768
    s_and_b32 s30, s30, 0x1ffff
    s_mov_b32 m0, s30
    s_lshl_b32 s46, s29, s28
    buffer_load_dwordx4 v7, s[24:27], s46 offen lds
    s_add_u32 m0, s30, 4096
    s_lshl_b32 s46, s29, s31
    s_nop 0
    buffer_load_dwordx4 v15, s[40:43], s46 offen lds
    s_add_u32 s29, s29, 1
    s_cmp_eq_u32 s29, s44
    s_cselect_b32 s29, s45, s29
    s_nop 0
    s_add_u32 m0, s30, 8192
    s_lshl_b32 s46, s29, s28
    s_nop 0
    buffer_load_dwordx4 v7, s[24:27], s46 offen lds
    s_add_u32 m0, s30, 12288
    s_lshl_b32 s46, s29, s31
    s_nop 0
    buffer_load_dwordx4 v15, s[40:43], s46 offen lds
    s_add_u32 s29, s29, 1
    s_cmp_eq_u32 s29, s44
    s_cselect_b32 s29, s45, s29
    s_nop 0
    s_add_u32 m0, s30, 16384
    s_lshl_b32 s46, s29, s28
    s_nop 0
    buffer_load_dwordx4 v7, s[24:27], s46 offen lds
    s_add_u32 m0, s30, 20480
    s_lshl_b32 s46, s29, s31
    s_nop 0
    buffer_load_dwordx4 v15, s[40:43], s46 offen lds
    s_add_u32 s29, s29, 1
    s_cmp_eq_u32 s29, s44
    s_cselect_b32 s29, s45, s29
    s_nop 0
    s_add_u32 m0, s30, 24576
    s_lshl_b32 s46, s29, s28
    s_nop 0
    buffer_load_dwordx4 v7, s[24:27], s46 offen lds
    s_add_u32 m0, s30, 28672
    s_lshl_b32 s46, s29, s31
    s_nop 0
    buffer_load_dwordx4 v15, s[40:43], s46 offen lds
    s_add_u32 s29, s29, 1
    s_cmp_eq_u32 s29, s44
    s_cselect_b32 s29, s45, s29
    s_nop 0
    s_add_u32 s30, s30, 32768
    s_and_b32 s30, s30, 0x1ffff
    s_mov_b32 s22, 1
sequential_preLN__ssm_conv_h3__dense_activation_squared_relu__prompt_kernel_g_g2h:
    s_waitcnt vmcnt(16)
    s_barrier
    s_mov_b32 m0, s30
    s_lshl_b32 s46, s29, s28
    s_nop 0
    buffer_load_dwordx4 v7, s[24:27], s46 offen lds
    s_add_u32 m0, s30, 4096
    s_lshl_b32 s46, s29, s31
    s_nop 0
    buffer_load_dwordx4 v15, s[40:43], s46 offen lds
    s_add_u32 s29, s29, 1
    s_cmp_eq_u32 s29, s44
    s_cselect_b32 s29, s45, s29
    s_nop 0
    s_add_u32 m0, s30, 8192
    s_lshl_b32 s46, s29, s28
    s_nop 0
    buffer_load_dwordx4 v7, s[24:27], s46 offen lds
    s_add_u32 m0, s30, 12288
    s_lshl_b32 s46, s29, s31
    s_nop 0
    buffer_load_dwordx4 v15, s[40:43], s46 offen lds
    s_add_u32 s29, s29, 1
    s_cmp_eq_u32 s29, s44
    s_cselect_b32 s29, s45, s29
    s_nop 0
    s_add_u32 m0, s30, 16384
    s_lshl_b32 s46, s29, s28
    s_nop 0
    buffer_load_dwordx4 v7, s[24:27], s46 offen lds
    s_add_u32 m0, s30, 20480
    s_lshl_b32 s46, s29, s31
    s_nop 0
    buffer_load_dwordx4 v15, s[40:43], s46 offen lds
    s_add_u32 s29, s29, 1
    s_cmp_eq_u32 s29, s44
    s_cselect_b32 s29, s45, s29
    s_nop 0
    s_add_u32 m0, s30, 24576
    s_lshl_b32 s46, s29, s28
    s_nop 0
    buffer_load_dwordx4 v7, s[24:27], s46 offen lds
    s_add_u32 m0, s30, 28672
    s_lshl_b32 s46, s29, s31
    s_nop 0
    buffer_load_dwordx4 v15, s[40:43], s46 offen lds
    s_add_u32 s29, s29, 1
    s_cmp_eq_u32 s29, s44
    s_cselect_b32 s29, s45, s29
    s_nop 0
    s_add_u32 s30, s30, 32768
    s_and_b32 s30, s30, 0x1ffff
    s_add_u32 s22, s22, 1
    s_cmp_lt_u32 s22, 10
    s_cbranch_scc1 sequential_preLN__ssm_conv_h3__dense_activation_squared_relu__prompt_kernel_g_g2h
    s_nop 0
    s_add_u32 s36, s12, 16777216
    s_addc_u32 s37, s13, 0
    s_nop 0
    s_mov_b32 s38, 4194304
    s_mov_b32 s39, 0x20000
    s_lshl_b32 s35, s16, 1
    s_add_u32 s35, s35, s34
    s_lshl_b32 s17, s35, 6
    s_lshl_b32 s18, s14, 4
    s_add_u32 s17, s17, s18
    s_lshl_b32 s17, s17, 12
    s_lshl_b32 s18, s15, 8
    s_add_u32 s17, s17, s18
    v_lshlrev_b32 v8, 12, v4
    v_lshlrev_b32 v9, 1, v4
    v_xor_b32_e64 v9, v9, v3
    v_lshl_add_u32 v8, v9, 4, v8
    v_xor_b32 v9, 128, v8
    v_add_u32 v9, 15360, v9
    s_lshl_b32 s18, s14, 12
    s_nop 0
    s_add_u32 m0, s18, 131072
    s_add_u32 s18, s17, 30720
    buffer_load_dwordx4 v8, s[36:39], s17 offen sc1 lds
    buffer_load_dwordx4 v9, s[36:39], s17 offen offset:1024 sc1 lds
    buffer_load_dwordx4 v8, s[36:39], s18 offen offset:2048 sc1 lds
    buffer_load_dwordx4 v9, s[36:39], s18 offen offset:3072 sc1 lds
    s_waitcnt vmcnt(20)
    s_barrier
    s_waitcnt vmcnt(12)
    s_barrier
    s_waitcnt vmcnt(0)
    s_barrier
sequential_preLN__ssm_conv_h3__dense_activation_squared_relu__prompt_kernel_g_hend:
    s_endpgm
sequential_preLN__ssm_conv_h3__dense_activation_squared_relu__prompt_kernel_g_cons:
    v_lshrrev_b32 v6, 2, v1
    v_lshlrev_b32 v7, 8, v6
    v_and_b32 v6, 7, v6
    v_lshl_add_u32 v7, v6, 5, v7
    v_and_b32_e64 v6, 3, v1
    v_lshl_add_u32 v7, v6, 3, v7
    v_add_u32 v7, 14336, v7
    s_and_b32 s18, s14, 1
    s_lshr_b32 s19, s14, 1
    s_lshl_b32 s20, s18, 7
    v_xor_b32 v218, s20, v7
    v_xor_b32 v219, 32, v218
    v_xor_b32 v220, 64, v218
    v_xor_b32 v221, 96, v218
    s_lshl_b32 s20, s19, 13
    v_add_u32 v216, s20, v5
    s_lshl_b32 s20, s19, 10
    s_nop 0
    s_add_u32 s20, s20, 6144
    v_add_u32 v217, s20, v5
    v_lshrrev_b32 v6, 2, v1
    v_mul_u32_u24 v216, 448, v6
    v_and_b32_e64 v7, 3, v1
    v_lshl_add_u32 v216, v7, 3, v216
    v_lshlrev_b32 v6, 3, v6
    v_and_b32 v6, 32, v6
    s_lshl_b32 s20, s19, 8
    v_add_u32 v216, s20, v216
    v_sub_u32 v217, v216, v6
    v_add_u32 v216, v216, v6
    s_mul_i32 s20, s19, 224
    s_sub_u32 s20, 192, s20
    s_cmp_eq_u32 s19, 0
    s_cselect_b64 vcc, -1, 0
    v_cndmask_b32 v248, v217, v216, vcc
    v_add_u32 v248, s20, v248
    v_add_u32 v249, 67584, v248
    v_add_u32 v222, 67584, v216
    v_add_u32 v223, 67584, v217
    v_add_u32 v224, 67584, v218
    v_add_u32 v225, 67584, v219
    v_add_u32 v226, 67584, v220
    v_add_u32 v227, 67584, v221
    v_mov_b32 v244, 0x3f803f80
    v_mov_b32 v245, 0x3f803f80
    v_mov_b32 v246, 0x3f803f80
    v_mov_b32 v247, 0x3f803f80
    s_waitcnt lgkmcnt(0)
    s_nop 0
    s_add_u32 s24, s12, 32505856
    s_addc_u32 s25, s13, 0
    s_nop 0
    s_mov_b32 s26, 262144
    s_mov_b32 s27, 0x20000
    s_mov_b32 s28, s10
    s_mov_b32 s29, s11
    s_mov_b32 s30, 7340032
    s_mov_b32 s31, 0x20000
    v_and_b32_e64 v8, 3, v1
    v_cmp_eq_u32 s[54:55], 1, v8
    v_cmp_eq_u32 s[56:57], 2, v8
    v_cmp_eq_u32 s[58:59], 3, v8
    v_lshrrev_b32_e64 v8, 2, v3
    v_cmp_eq_u32 s[52:53], v8, v4
    s_lshl_b32 s20, s15, 4
    s_add_u32 s20, s20, s16
    s_lshl_b32 s20, s20, 10
    s_lshl_b32 s44, s18, 9
    s_add_u32 s20, s20, s44
    s_lshl_b32 s44, s19, 8
    s_add_u32 s20, s20, s44
    v_lshlrev_b32 v9, 3, v3
    s_lshl_b32 s21, s2, 2
    s_add_u32 s21, s21, s14
    s_mul_i32 s21, s21, 7168
    v_lshlrev_b32_e64 v8, 7, v1
    v_min_u32 v8, 7040, v8
    s_mov_b32 s22, 0
    s_barrier
    s_add_u32 s48, s12, 41943040
    s_addc_u32 s49, s13, 0
    s_nop 0
    s_mov_b32 s50, 8519680
    s_mov_b32 s51, 0x20000
    s_getreg_b32 s60, hwreg(HW_REG_XCC_ID, 0, 4)
    s_lshl_b32 s61, s2, 2
    s_add_u32 s61, s61, s14
    s_lshl_b32 s61, s61, 7
    s_add_u32 s61, s61, 8388608
    v_mov_b32_e64 v10, s60
    v_mov_b32 v13, 0
    s_mov_b64 exec, 1
    buffer_store_dword v10, v13, s[48:51], s61 offen sc1
    s_mov_b64 exec, -1
    s_and_b32 s62, s2, 31
    v_and_b32 v14, 7, v1
    v_lshlrev_b32 v14, 5, v14
    v_add_u32 v14, s62, v14
    s_xor_b32 s62, s2, 4
    v_mov_b32 v15, s62
    v_cmp_eq_u32 vcc, 8, v1
    s_nop 1
    v_cndmask_b32 v14, v14, v15, vcc
    v_lshlrev_b32_e64 v14, 9, v14
    v_add_u32 v14, 8388608, v14
    s_barrier
    s_nop 0
    ds_read_b64_tr_b16 v[156:157], v218 offset:0
    ds_read_b64_tr_b16 v[158:159], v218 offset:4096
    ds_read_b64_tr_b16 v[128:129], v216 offset:0
    ds_read_b64_tr_b16 v[130:131], v216 offset:7168
    ds_read_b64_tr_b16 v[160:161], v219 offset:0
    ds_read_b64_tr_b16 v[162:163], v219 offset:4096
    ds_read_b64_tr_b16 v[132:133], v217 offset:32
    ds_read_b64_tr_b16 v[134:135], v217 offset:7200
    ds_read_b64_tr_b16 v[164:165], v220 offset:0
    ds_read_b64_tr_b16 v[166:167], v220 offset:4096
    ds_read_b64_tr_b16 v[136:137], v216 offset:64
    ds_read_b64_tr_b16 v[138:139], v216 offset:7232
    ds_read_b64_tr_b16 v[168:169], v221 offset:0
    ds_read_b64_tr_b16 v[170:171], v221 offset:4096
    ds_read_b64_tr_b16 v[140:141], v217 offset:96
    ds_read_b64_tr_b16 v[142:143], v217 offset:7264
    ds_read_b64_tr_b16 v[144:145], v216 offset:128
    ds_read_b64_tr_b16 v[146:147], v216 offset:7296
    ds_read_b64_tr_b16 v[148:149], v217 offset:160
    ds_read_b64_tr_b16 v[150:151], v217 offset:7328
    ds_read_b64_tr_b16 v[152:153], v248 offset:0
    ds_read_b64_tr_b16 v[154:155], v248 offset:7168
    s_waitcnt lgkmcnt(0)
    s_nop 0
    v_mfma_f32_16x16x32_bf16 v[16:19], v[128:131], v[156:159], 0
    v_mfma_f32_16x16x32_bf16 v[20:23], v[128:131], v[160:163], 0
    v_mfma_f32_16x16x32_bf16 v[24:27], v[128:131], v[164:167], 0
    v_mfma_f32_16x16x32_bf16 v[28:31], v[128:131], v[168:171], 0
    v_mfma_f32_16x16x32_bf16 v[32:35], v[132:135], v[156:159], 0
    v_mfma_f32_16x16x32_bf16 v[36:39], v[132:135], v[160:163], 0
    v_mfma_f32_16x16x32_bf16 v[40:43], v[132:135], v[164:167], 0
    v_mfma_f32_16x16x32_bf16 v[44:47], v[132:135], v[168:171], 0
    v_mfma_f32_16x16x32_bf16 v[48:51], v[136:139], v[156:159], 0
    v_mfma_f32_16x16x32_bf16 v[52:55], v[136:139], v[160:163], 0
    v_mfma_f32_16x16x32_bf16 v[56:59], v[136:139], v[164:167], 0
    v_mfma_f32_16x16x32_bf16 v[60:63], v[136:139], v[168:171], 0
    s_barrier
    s_nop 0
    ds_read_b64_tr_b16 v[200:201], v218 offset:22528
    ds_read_b64_tr_b16 v[202:203], v218 offset:26624
    v_mfma_f32_16x16x32_bf16 v[64:67], v[140:143], v[156:159], 0
    ds_read_b64_tr_b16 v[172:173], v216 offset:22528
    ds_read_b64_tr_b16 v[174:175], v216 offset:29696
    v_mfma_f32_16x16x32_bf16 v[68:71], v[140:143], v[160:163], 0
    ds_read_b64_tr_b16 v[204:205], v219 offset:22528
    v_mfma_f32_16x16x32_bf16 v[72:75], v[140:143], v[164:167], 0
    ds_read_b64_tr_b16 v[206:207], v219 offset:26624
    ds_read_b64_tr_b16 v[176:177], v217 offset:22560
    v_mfma_f32_16x16x32_bf16 v[76:79], v[140:143], v[168:171], 0
    ds_read_b64_tr_b16 v[178:179], v217 offset:29728
    v_mfma_f32_16x16x32_bf16 v[80:83], v[144:147], v[156:159], 0
    ds_read_b64_tr_b16 v[208:209], v220 offset:22528
    ds_read_b64_tr_b16 v[210:211], v220 offset:26624
    v_mfma_f32_16x16x32_bf16 v[84:87], v[144:147], v[160:163], 0
    ds_read_b64_tr_b16 v[180:181], v216 offset:22592
    v_mfma_f32_16x16x32_bf16 v[88:91], v[144:147], v[164:167], 0
    ds_read_b64_tr_b16 v[182:183], v216 offset:29760
    ds_read_b64_tr_b16 v[212:213], v221 offset:22528
    v_mfma_f32_16x16x32_bf16 v[92:95], v[144:147], v[168:171], 0
    ds_read_b64_tr_b16 v[214:215], v221 offset:26624
    ds_read_b64_tr_b16 v[184:185], v217 offset:22624
    v_mfma_f32_16x16x32_bf16 v[96:99], v[148:151], v[156:159], 0
    ds_read_b64_tr_b16 v[186:187], v217 offset:29792
    v_mfma_f32_16x16x32_bf16 v[100:103], v[148:151], v[160:163], 0
    ds_read_b64_tr_b16 v[188:189], v216 offset:22656
    ds_read_b64_tr_b16 v[190:191], v216 offset:29824
    v_mfma_f32_16x16x32_bf16 v[104:107], v[148:151], v[164:167], 0
    ds_read_b64_tr_b16 v[192:193], v217 offset:22688
    v_mfma_f32_16x16x32_bf16 v[108:111], v[148:151], v[168:171], 0
    ds_read_b64_tr_b16 v[194:195], v217 offset:29856
    ds_read_b64_tr_b16 v[196:197], v248 offset:22528
    v_mfma_f32_16x16x32_bf16 v[112:115], v[152:155], v[156:159], 0
    ds_read_b64_tr_b16 v[198:199], v248 offset:29696
    v_mfma_f32_16x16x32_bf16 v[116:119], v[152:155], v[160:163], 0
    v_mfma_f32_16x16x32_bf16 v[120:123], v[152:155], v[164:167], 0
    v_mfma_f32_16x16x32_bf16 v[124:127], v[152:155], v[168:171], 0
    s_cmp_eq_u32 s19, 0
    s_cbranch_scc0 sequential_preLN__ssm_conv_h3__dense_activation_squared_relu__prompt_kernel_g_s1_b
    v_mfma_f32_16x16x32_bf16 v[228:231], v[244:247], v[156:159], 0
    v_mfma_f32_16x16x32_bf16 v[232:235], v[156:159], v[156:159], 0
    v_mfma_f32_16x16x32_bf16 v[236:239], v[244:247], v[160:163], 0
    v_mfma_f32_16x16x32_bf16 v[240:243], v[160:163], v[160:163], 0
    s_branch sequential_preLN__ssm_conv_h3__dense_activation_squared_relu__prompt_kernel_g_s1_e
sequential_preLN__ssm_conv_h3__dense_activation_squared_relu__prompt_kernel_g_s1_b:
    s_nop 0
    v_mfma_f32_16x16x32_bf16 v[228:231], v[244:247], v[164:167], 0
    v_mfma_f32_16x16x32_bf16 v[232:235], v[164:167], v[164:167], 0
    v_mfma_f32_16x16x32_bf16 v[236:239], v[244:247], v[168:171], 0
    v_mfma_f32_16x16x32_bf16 v[240:243], v[168:171], v[168:171], 0
sequential_preLN__ssm_conv_h3__dense_activation_squared_relu__prompt_kernel_g_s1_e:
    s_waitcnt lgkmcnt(0)
    s_nop 0
    v_mfma_f32_16x16x32_bf16 v[16:19], v[172:175], v[200:203], v[16:19]
    v_mfma_f32_16x16x32_bf16 v[20:23], v[172:175], v[204:207], v[20:23]
    v_mfma_f32_16x16x32_bf16 v[24:27], v[172:175], v[208:211], v[24:27]
    v_mfma_f32_16x16x32_bf16 v[28:31], v[172:175], v[212:215], v[28:31]
    v_mfma_f32_16x16x32_bf16 v[32:35], v[176:179], v[200:203], v[32:35]
    v_mfma_f32_16x16x32_bf16 v[36:39], v[176:179], v[204:207], v[36:39]
    v_mfma_f32_16x16x32_bf16 v[40:43], v[176:179], v[208:211], v[40:43]
    v_mfma_f32_16x16x32_bf16 v[44:47], v[176:179], v[212:215], v[44:47]
    v_mfma_f32_16x16x32_bf16 v[48:51], v[180:183], v[200:203], v[48:51]
    v_mfma_f32_16x16x32_bf16 v[52:55], v[180:183], v[204:207], v[52:55]
    v_mfma_f32_16x16x32_bf16 v[56:59], v[180:183], v[208:211], v[56:59]
    v_mfma_f32_16x16x32_bf16 v[60:63], v[180:183], v[212:215], v[60:63]
    s_barrier
    s_nop 0
    ds_read_b64_tr_b16 v[156:157], v218 offset:45056
    ds_read_b64_tr_b16 v[158:159], v218 offset:49152
    v_mfma_f32_16x16x32_bf16 v[64:67], v[184:187], v[200:203], v[64:67]
    ds_read_b64_tr_b16 v[128:129], v216 offset:45056
    ds_read_b64_tr_b16 v[130:131], v216 offset:52224
    v_mfma_f32_16x16x32_bf16 v[68:71], v[184:187], v[204:207], v[68:71]
    ds_read_b64_tr_b16 v[160:161], v219 offset:45056
    v_mfma_f32_16x16x32_bf16 v[72:75], v[184:187], v[208:211], v[72:75]
    ds_read_b64_tr_b16 v[162:163], v219 offset:49152
    ds_read_b64_tr_b16 v[132:133], v217 offset:45088
    v_mfma_f32_16x16x32_bf16 v[76:79], v[184:187], v[212:215], v[76:79]
    ds_read_b64_tr_b16 v[134:135], v217 offset:52256
    v_mfma_f32_16x16x32_bf16 v[80:83], v[188:191], v[200:203], v[80:83]
    ds_read_b64_tr_b16 v[164:165], v220 offset:45056
    ds_read_b64_tr_b16 v[166:167], v220 offset:49152
    v_mfma_f32_16x16x32_bf16 v[84:87], v[188:191], v[204:207], v[84:87]
    ds_read_b64_tr_b16 v[136:137], v216 offset:45120
    v_mfma_f32_16x16x32_bf16 v[88:91], v[188:191], v[208:211], v[88:91]
    ds_read_b64_tr_b16 v[138:139], v216 offset:52288
    ds_read_b64_tr_b16 v[168:169], v221 offset:45056
    v_mfma_f32_16x16x32_bf16 v[92:95], v[188:191], v[212:215], v[92:95]
    ds_read_b64_tr_b16 v[170:171], v221 offset:49152
    ds_read_b64_tr_b16 v[140:141], v217 offset:45152
    v_mfma_f32_16x16x32_bf16 v[96:99], v[192:195], v[200:203], v[96:99]
    ds_read_b64_tr_b16 v[142:143], v217 offset:52320
    v_mfma_f32_16x16x32_bf16 v[100:103], v[192:195], v[204:207], v[100:103]
    ds_read_b64_tr_b16 v[144:145], v216 offset:45184
    ds_read_b64_tr_b16 v[146:147], v216 offset:52352
    v_mfma_f32_16x16x32_bf16 v[104:107], v[192:195], v[208:211], v[104:107]
    ds_read_b64_tr_b16 v[148:149], v217 offset:45216
    v_mfma_f32_16x16x32_bf16 v[108:111], v[192:195], v[212:215], v[108:111]
    ds_read_b64_tr_b16 v[150:151], v217 offset:52384
    ds_read_b64_tr_b16 v[152:153], v248 offset:45056
    v_mfma_f32_16x16x32_bf16 v[112:115], v[196:199], v[200:203], v[112:115]
    ds_read_b64_tr_b16 v[154:155], v248 offset:52224
    v_mfma_f32_16x16x32_bf16 v[116:119], v[196:199], v[204:207], v[116:119]
    v_mfma_f32_16x16x32_bf16 v[120:123], v[196:199], v[208:211], v[120:123]
    v_mfma_f32_16x16x32_bf16 v[124:127], v[196:199], v[212:215], v[124:127]
    s_cmp_eq_u32 s19, 0
    s_cbranch_scc0 sequential_preLN__ssm_conv_h3__dense_activation_squared_relu__prompt_kernel_g_s2_b
    v_mfma_f32_16x16x32_bf16 v[228:231], v[244:247], v[200:203], v[228:231]
    v_mfma_f32_16x16x32_bf16 v[232:235], v[200:203], v[200:203], v[232:235]
    v_mfma_f32_16x16x32_bf16 v[236:239], v[244:247], v[204:207], v[236:239]
    v_mfma_f32_16x16x32_bf16 v[240:243], v[204:207], v[204:207], v[240:243]
    s_branch sequential_preLN__ssm_conv_h3__dense_activation_squared_relu__prompt_kernel_g_s2_e
sequential_preLN__ssm_conv_h3__dense_activation_squared_relu__prompt_kernel_g_s2_b:
    s_nop 0
    v_mfma_f32_16x16x32_bf16 v[228:231], v[244:247], v[208:211], v[228:231]
    v_mfma_f32_16x16x32_bf16 v[232:235], v[208:211], v[208:211], v[232:235]
    v_mfma_f32_16x16x32_bf16 v[236:239], v[244:247], v[212:215], v[236:239]
    v_mfma_f32_16x16x32_bf16 v[240:243], v[212:215], v[212:215], v[240:243]
sequential_preLN__ssm_conv_h3__dense_activation_squared_relu__prompt_kernel_g_s2_e:
    s_waitcnt lgkmcnt(0)
    s_nop 4
    v_cndmask_b32 v229, v232, v233, s[54:55]
    v_cndmask_b32 v229, v229, v234, s[56:57]
    v_cndmask_b32 v229, v229, v235, s[58:59]
    v_cndmask_b32 v237, v240, v241, s[54:55]
    v_cndmask_b32 v237, v237, v242, s[56:57]
    v_cndmask_b32 v237, v237, v243, s[58:59]
    s_mov_b64 exec, s[52:53]
    s_nop 0
    buffer_store_dwordx2 v[228:229], v9, s[24:27], s20 offen sc1
    buffer_store_dwordx2 v[236:237], v9, s[24:27], s20 offen offset:128 sc1
    s_mov_b64 exec, -1
sequential_preLN__ssm_conv_h3__dense_activation_squared_relu__prompt_kernel_g_cloop:
    s_barrier
    v_mfma_f32_16x16x32_bf16 v[16:19], v[128:131], v[156:159], v[16:19]
    ds_read_b64_tr_b16 v[200:201], v224 offset:0
    v_mfma_f32_16x16x32_bf16 v[20:23], v[128:131], v[160:163], v[20:23]
    ds_read_b64_tr_b16 v[202:203], v224 offset:4096
    v_mfma_f32_16x16x32_bf16 v[24:27], v[128:131], v[164:167], v[24:27]
    ds_read_b64_tr_b16 v[172:173], v222 offset:0
    v_mfma_f32_16x16x32_bf16 v[28:31], v[128:131], v[168:171], v[28:31]
    ds_read_b64_tr_b16 v[174:175], v222 offset:7168
    v_mfma_f32_16x16x32_bf16 v[32:35], v[132:135], v[156:159], v[32:35]
    ds_read_b64_tr_b16 v[204:205], v225 offset:0
    v_mfma_f32_16x16x32_bf16 v[36:39], v[132:135], v[160:163], v[36:39]
    ds_read_b64_tr_b16 v[206:207], v225 offset:4096
    v_mfma_f32_16x16x32_bf16 v[40:43], v[132:135], v[164:167], v[40:43]
    ds_read_b64_tr_b16 v[176:177], v223 offset:32
    v_mfma_f32_16x16x32_bf16 v[44:47], v[132:135], v[168:171], v[44:47]
    ds_read_b64_tr_b16 v[178:179], v223 offset:7200
    v_mfma_f32_16x16x32_bf16 v[48:51], v[136:139], v[156:159], v[48:51]
    ds_read_b64_tr_b16 v[208:209], v226 offset:0
    v_mfma_f32_16x16x32_bf16 v[52:55], v[136:139], v[160:163], v[52:55]
    ds_read_b64_tr_b16 v[210:211], v226 offset:4096
    v_mfma_f32_16x16x32_bf16 v[56:59], v[136:139], v[164:167], v[56:59]
    ds_read_b64_tr_b16 v[180:181], v222 offset:64
    v_mfma_f32_16x16x32_bf16 v[60:63], v[136:139], v[168:171], v[60:63]
    ds_read_b64_tr_b16 v[182:183], v222 offset:7232
    v_mfma_f32_16x16x32_bf16 v[64:67], v[140:143], v[156:159], v[64:67]
    ds_read_b64_tr_b16 v[212:213], v227 offset:0
    v_mfma_f32_16x16x32_bf16 v[68:71], v[140:143], v[160:163], v[68:71]
    ds_read_b64_tr_b16 v[214:215], v227 offset:4096
    v_mfma_f32_16x16x32_bf16 v[72:75], v[140:143], v[164:167], v[72:75]
    ds_read_b64_tr_b16 v[184:185], v223 offset:96
    v_mfma_f32_16x16x32_bf16 v[76:79], v[140:143], v[168:171], v[76:79]
    ds_read_b64_tr_b16 v[186:187], v223 offset:7264
    v_mfma_f32_16x16x32_bf16 v[80:83], v[144:147], v[156:159], v[80:83]
    ds_read_b64_tr_b16 v[188:189], v222 offset:128
    v_mfma_f32_16x16x32_bf16 v[84:87], v[144:147], v[160:163], v[84:87]
    ds_read_b64_tr_b16 v[190:191], v222 offset:7296
    v_mfma_f32_16x16x32_bf16 v[88:91], v[144:147], v[164:167], v[88:91]
    ds_read_b64_tr_b16 v[192:193], v223 offset:160
    v_mfma_f32_16x16x32_bf16 v[92:95], v[144:147], v[168:171], v[92:95]
    ds_read_b64_tr_b16 v[194:195], v223 offset:7328
    v_mfma_f32_16x16x32_bf16 v[96:99], v[148:151], v[156:159], v[96:99]
    ds_read_b64_tr_b16 v[196:197], v249 offset:0
    v_mfma_f32_16x16x32_bf16 v[100:103], v[148:151], v[160:163], v[100:103]
    ds_read_b64_tr_b16 v[198:199], v249 offset:7168
    v_mfma_f32_16x16x32_bf16 v[104:107], v[148:151], v[164:167], v[104:107]
    v_mfma_f32_16x16x32_bf16 v[108:111], v[148:151], v[168:171], v[108:111]
    v_mfma_f32_16x16x32_bf16 v[112:115], v[152:155], v[156:159], v[112:115]
    v_mfma_f32_16x16x32_bf16 v[116:119], v[152:155], v[160:163], v[116:119]
    v_mfma_f32_16x16x32_bf16 v[120:123], v[152:155], v[164:167], v[120:123]
    v_mfma_f32_16x16x32_bf16 v[124:127], v[152:155], v[168:171], v[124:127]
    s_waitcnt lgkmcnt(0)
    s_nop 0
    v_mfma_f32_16x16x32_bf16 v[16:19], v[172:175], v[200:203], v[16:19]
    ds_read_b64_tr_b16 v[156:157], v224 offset:22528
    v_mfma_f32_16x16x32_bf16 v[20:23], v[172:175], v[204:207], v[20:23]
    ds_read_b64_tr_b16 v[158:159], v224 offset:26624
    v_mfma_f32_16x16x32_bf16 v[24:27], v[172:175], v[208:211], v[24:27]
    ds_read_b64_tr_b16 v[128:129], v222 offset:22528
    v_mfma_f32_16x16x32_bf16 v[28:31], v[172:175], v[212:215], v[28:31]
    ds_read_b64_tr_b16 v[130:131], v222 offset:29696
    v_mfma_f32_16x16x32_bf16 v[32:35], v[176:179], v[200:203], v[32:35]
    ds_read_b64_tr_b16 v[160:161], v225 offset:22528
    v_mfma_f32_16x16x32_bf16 v[36:39], v[176:179], v[204:207], v[36:39]
    ds_read_b64_tr_b16 v[162:163], v225 offset:26624
    v_mfma_f32_16x16x32_bf16 v[40:43], v[176:179], v[208:211], v[40:43]
    ds_read_b64_tr_b16 v[132:133], v223 offset:22560
    v_mfma_f32_16x16x32_bf16 v[44:47], v[176:179], v[212:215], v[44:47]
    ds_read_b64_tr_b16 v[134:135], v223 offset:29728
    v_mfma_f32_16x16x32_bf16 v[48:51], v[180:183], v[200:203], v[48:51]
    ds_read_b64_tr_b16 v[164:165], v226 offset:22528
    v_mfma_f32_16x16x32_bf16 v[52:55], v[180:183], v[204:207], v[52:55]
    ds_read_b64_tr_b16 v[166:167], v226 offset:26624
    v_mfma_f32_16x16x32_bf16 v[56:59], v[180:183], v[208:211], v[56:59]
    ds_read_b64_tr_b16 v[136:137], v222 offset:22592
    v_mfma_f32_16x16x32_bf16 v[60:63], v[180:183], v[212:215], v[60:63]
    ds_read_b64_tr_b16 v[138:139], v222 offset:29760
    v_mfma_f32_16x16x32_bf16 v[64:67], v[184:187], v[200:203], v[64:67]
    ds_read_b64_tr_b16 v[168:169], v227 offset:22528
    v_mfma_f32_16x16x32_bf16 v[68:71], v[184:187], v[204:207], v[68:71]
    ds_read_b64_tr_b16 v[170:171], v227 offset:26624
    v_mfma_f32_16x16x32_bf16 v[72:75], v[184:187], v[208:211], v[72:75]
    ds_read_b64_tr_b16 v[140:141], v223 offset:22624
    v_mfma_f32_16x16x32_bf16 v[76:79], v[184:187], v[212:215], v[76:79]
    ds_read_b64_tr_b16 v[142:143], v223 offset:29792
    v_mfma_f32_16x16x32_bf16 v[80:83], v[188:191], v[200:203], v[80:83]
    ds_read_b64_tr_b16 v[144:145], v222 offset:22656
    v_mfma_f32_16x16x32_bf16 v[84:87], v[188:191], v[204:207], v[84:87]
    ds_read_b64_tr_b16 v[146:147], v222 offset:29824
    v_mfma_f32_16x16x32_bf16 v[88:91], v[188:191], v[208:211], v[88:91]
    ds_read_b64_tr_b16 v[148:149], v223 offset:22688
    v_mfma_f32_16x16x32_bf16 v[92:95], v[188:191], v[212:215], v[92:95]
    ds_read_b64_tr_b16 v[150:151], v223 offset:29856
    v_mfma_f32_16x16x32_bf16 v[96:99], v[192:195], v[200:203], v[96:99]
    ds_read_b64_tr_b16 v[152:153], v249 offset:22528
    v_mfma_f32_16x16x32_bf16 v[100:103], v[192:195], v[204:207], v[100:103]
    ds_read_b64_tr_b16 v[154:155], v249 offset:29696
    v_mfma_f32_16x16x32_bf16 v[104:107], v[192:195], v[208:211], v[104:107]
    v_mfma_f32_16x16x32_bf16 v[108:111], v[192:195], v[212:215], v[108:111]
    v_mfma_f32_16x16x32_bf16 v[112:115], v[196:199], v[200:203], v[112:115]
    v_mfma_f32_16x16x32_bf16 v[116:119], v[196:199], v[204:207], v[116:119]
    v_mfma_f32_16x16x32_bf16 v[120:123], v[196:199], v[208:211], v[120:123]
    v_mfma_f32_16x16x32_bf16 v[124:127], v[196:199], v[212:215], v[124:127]
    s_waitcnt lgkmcnt(0)
    s_barrier
    v_mfma_f32_16x16x32_bf16 v[16:19], v[128:131], v[156:159], v[16:19]
    ds_read_b64_tr_b16 v[200:201], v224 offset:45056
    v_mfma_f32_16x16x32_bf16 v[20:23], v[128:131], v[160:163], v[20:23]
    ds_read_b64_tr_b16 v[202:203], v224 offset:49152
    v_mfma_f32_16x16x32_bf16 v[24:27], v[128:131], v[164:167], v[24:27]
    ds_read_b64_tr_b16 v[172:173], v222 offset:45056
    v_mfma_f32_16x16x32_bf16 v[28:31], v[128:131], v[168:171], v[28:31]
    ds_read_b64_tr_b16 v[174:175], v222 offset:52224
    v_mfma_f32_16x16x32_bf16 v[32:35], v[132:135], v[156:159], v[32:35]
    ds_read_b64_tr_b16 v[204:205], v225 offset:45056
    v_mfma_f32_16x16x32_bf16 v[36:39], v[132:135], v[160:163], v[36:39]
    ds_read_b64_tr_b16 v[206:207], v225 offset:49152
    v_mfma_f32_16x16x32_bf16 v[40:43], v[132:135], v[164:167], v[40:43]
    ds_read_b64_tr_b16 v[176:177], v223 offset:45088
    v_mfma_f32_16x16x32_bf16 v[44:47], v[132:135], v[168:171], v[44:47]
    ds_read_b64_tr_b16 v[178:179], v223 offset:52256
    v_mfma_f32_16x16x32_bf16 v[48:51], v[136:139], v[156:159], v[48:51]
    ds_read_b64_tr_b16 v[208:209], v226 offset:45056
    v_mfma_f32_16x16x32_bf16 v[52:55], v[136:139], v[160:163], v[52:55]
    ds_read_b64_tr_b16 v[210:211], v226 offset:49152
    v_mfma_f32_16x16x32_bf16 v[56:59], v[136:139], v[164:167], v[56:59]
    ds_read_b64_tr_b16 v[180:181], v222 offset:45120
    v_mfma_f32_16x16x32_bf16 v[60:63], v[136:139], v[168:171], v[60:63]
    ds_read_b64_tr_b16 v[182:183], v222 offset:52288
    v_mfma_f32_16x16x32_bf16 v[64:67], v[140:143], v[156:159], v[64:67]
    ds_read_b64_tr_b16 v[212:213], v227 offset:45056
    v_mfma_f32_16x16x32_bf16 v[68:71], v[140:143], v[160:163], v[68:71]
    ds_read_b64_tr_b16 v[214:215], v227 offset:49152
    v_mfma_f32_16x16x32_bf16 v[72:75], v[140:143], v[164:167], v[72:75]
    ds_read_b64_tr_b16 v[184:185], v223 offset:45152
    v_mfma_f32_16x16x32_bf16 v[76:79], v[140:143], v[168:171], v[76:79]
    ds_read_b64_tr_b16 v[186:187], v223 offset:52320
    v_mfma_f32_16x16x32_bf16 v[80:83], v[144:147], v[156:159], v[80:83]
    ds_read_b64_tr_b16 v[188:189], v222 offset:45184
    v_mfma_f32_16x16x32_bf16 v[84:87], v[144:147], v[160:163], v[84:87]
    ds_read_b64_tr_b16 v[190:191], v222 offset:52352
    v_mfma_f32_16x16x32_bf16 v[88:91], v[144:147], v[164:167], v[88:91]
    ds_read_b64_tr_b16 v[192:193], v223 offset:45216
    v_mfma_f32_16x16x32_bf16 v[92:95], v[144:147], v[168:171], v[92:95]
    ds_read_b64_tr_b16 v[194:195], v223 offset:52384
    v_mfma_f32_16x16x32_bf16 v[96:99], v[148:151], v[156:159], v[96:99]
    ds_read_b64_tr_b16 v[196:197], v249 offset:45056
    v_mfma_f32_16x16x32_bf16 v[100:103], v[148:151], v[160:163], v[100:103]
    ds_read_b64_tr_b16 v[198:199], v249 offset:52224
    v_mfma_f32_16x16x32_bf16 v[104:107], v[148:151], v[164:167], v[104:107]
    v_mfma_f32_16x16x32_bf16 v[108:111], v[148:151], v[168:171], v[108:111]
    v_mfma_f32_16x16x32_bf16 v[112:115], v[152:155], v[156:159], v[112:115]
    v_mfma_f32_16x16x32_bf16 v[116:119], v[152:155], v[160:163], v[116:119]
    v_mfma_f32_16x16x32_bf16 v[120:123], v[152:155], v[164:167], v[120:123]
    v_mfma_f32_16x16x32_bf16 v[124:127], v[152:155], v[168:171], v[124:127]
    s_waitcnt lgkmcnt(0)
    s_nop 0
    v_mfma_f32_16x16x32_bf16 v[16:19], v[172:175], v[200:203], v[16:19]
    ds_read_b64_tr_b16 v[156:157], v218 offset:0
    v_mfma_f32_16x16x32_bf16 v[20:23], v[172:175], v[204:207], v[20:23]
    ds_read_b64_tr_b16 v[158:159], v218 offset:4096
    v_mfma_f32_16x16x32_bf16 v[24:27], v[172:175], v[208:211], v[24:27]
    ds_read_b64_tr_b16 v[128:129], v216 offset:0
    v_mfma_f32_16x16x32_bf16 v[28:31], v[172:175], v[212:215], v[28:31]
    ds_read_b64_tr_b16 v[130:131], v216 offset:7168
    v_mfma_f32_16x16x32_bf16 v[32:35], v[176:179], v[200:203], v[32:35]
    ds_read_b64_tr_b16 v[160:161], v219 offset:0
    v_mfma_f32_16x16x32_bf16 v[36:39], v[176:179], v[204:207], v[36:39]
    ds_read_b64_tr_b16 v[162:163], v219 offset:4096
    v_mfma_f32_16x16x32_bf16 v[40:43], v[176:179], v[208:211], v[40:43]
    ds_read_b64_tr_b16 v[132:133], v217 offset:32
    v_mfma_f32_16x16x32_bf16 v[44:47], v[176:179], v[212:215], v[44:47]
    ds_read_b64_tr_b16 v[134:135], v217 offset:7200
    v_mfma_f32_16x16x32_bf16 v[48:51], v[180:183], v[200:203], v[48:51]
    ds_read_b64_tr_b16 v[164:165], v220 offset:0
    v_mfma_f32_16x16x32_bf16 v[52:55], v[180:183], v[204:207], v[52:55]
    ds_read_b64_tr_b16 v[166:167], v220 offset:4096
    v_mfma_f32_16x16x32_bf16 v[56:59], v[180:183], v[208:211], v[56:59]
    ds_read_b64_tr_b16 v[136:137], v216 offset:64
    v_mfma_f32_16x16x32_bf16 v[60:63], v[180:183], v[212:215], v[60:63]
    ds_read_b64_tr_b16 v[138:139], v216 offset:7232
    v_mfma_f32_16x16x32_bf16 v[64:67], v[184:187], v[200:203], v[64:67]
    ds_read_b64_tr_b16 v[168:169], v221 offset:0
    v_mfma_f32_16x16x32_bf16 v[68:71], v[184:187], v[204:207], v[68:71]
    ds_read_b64_tr_b16 v[170:171], v221 offset:4096
    v_mfma_f32_16x16x32_bf16 v[72:75], v[184:187], v[208:211], v[72:75]
    ds_read_b64_tr_b16 v[140:141], v217 offset:96
    v_mfma_f32_16x16x32_bf16 v[76:79], v[184:187], v[212:215], v[76:79]
    ds_read_b64_tr_b16 v[142:143], v217 offset:7264
    v_mfma_f32_16x16x32_bf16 v[80:83], v[188:191], v[200:203], v[80:83]
    ds_read_b64_tr_b16 v[144:145], v216 offset:128
    v_mfma_f32_16x16x32_bf16 v[84:87], v[188:191], v[204:207], v[84:87]
    ds_read_b64_tr_b16 v[146:147], v216 offset:7296
    v_mfma_f32_16x16x32_bf16 v[88:91], v[188:191], v[208:211], v[88:91]
    ds_read_b64_tr_b16 v[148:149], v217 offset:160
    v_mfma_f32_16x16x32_bf16 v[92:95], v[188:191], v[212:215], v[92:95]
    ds_read_b64_tr_b16 v[150:151], v217 offset:7328
    v_mfma_f32_16x16x32_bf16 v[96:99], v[192:195], v[200:203], v[96:99]
    ds_read_b64_tr_b16 v[152:153], v248 offset:0
    v_mfma_f32_16x16x32_bf16 v[100:103], v[192:195], v[204:207], v[100:103]
    ds_read_b64_tr_b16 v[154:155], v248 offset:7168
    v_mfma_f32_16x16x32_bf16 v[104:107], v[192:195], v[208:211], v[104:107]
    v_mfma_f32_16x16x32_bf16 v[108:111], v[192:195], v[212:215], v[108:111]
    v_mfma_f32_16x16x32_bf16 v[112:115], v[196:199], v[200:203], v[112:115]
    v_mfma_f32_16x16x32_bf16 v[116:119], v[196:199], v[204:207], v[116:119]
    v_mfma_f32_16x16x32_bf16 v[120:123], v[196:199], v[208:211], v[120:123]
    v_mfma_f32_16x16x32_bf16 v[124:127], v[196:199], v[212:215], v[124:127]
    s_waitcnt lgkmcnt(0)
    s_barrier
    v_mfma_f32_16x16x32_bf16 v[16:19], v[128:131], v[156:159], v[16:19]
    ds_read_b64_tr_b16 v[200:201], v218 offset:22528
    v_mfma_f32_16x16x32_bf16 v[20:23], v[128:131], v[160:163], v[20:23]
    ds_read_b64_tr_b16 v[202:203], v218 offset:26624
    v_mfma_f32_16x16x32_bf16 v[24:27], v[128:131], v[164:167], v[24:27]
    ds_read_b64_tr_b16 v[172:173], v216 offset:22528
    v_mfma_f32_16x16x32_bf16 v[28:31], v[128:131], v[168:171], v[28:31]
    ds_read_b64_tr_b16 v[174:175], v216 offset:29696
    v_mfma_f32_16x16x32_bf16 v[32:35], v[132:135], v[156:159], v[32:35]
    ds_read_b64_tr_b16 v[204:205], v219 offset:22528
    v_mfma_f32_16x16x32_bf16 v[36:39], v[132:135], v[160:163], v[36:39]
    ds_read_b64_tr_b16 v[206:207], v219 offset:26624
    v_mfma_f32_16x16x32_bf16 v[40:43], v[132:135], v[164:167], v[40:43]
    ds_read_b64_tr_b16 v[176:177], v217 offset:22560
    v_mfma_f32_16x16x32_bf16 v[44:47], v[132:135], v[168:171], v[44:47]
    ds_read_b64_tr_b16 v[178:179], v217 offset:29728
    v_mfma_f32_16x16x32_bf16 v[48:51], v[136:139], v[156:159], v[48:51]
    ds_read_b64_tr_b16 v[208:209], v220 offset:22528
    v_mfma_f32_16x16x32_bf16 v[52:55], v[136:139], v[160:163], v[52:55]
    ds_read_b64_tr_b16 v[210:211], v220 offset:26624
    v_mfma_f32_16x16x32_bf16 v[56:59], v[136:139], v[164:167], v[56:59]
    ds_read_b64_tr_b16 v[180:181], v216 offset:22592
    v_mfma_f32_16x16x32_bf16 v[60:63], v[136:139], v[168:171], v[60:63]
    ds_read_b64_tr_b16 v[182:183], v216 offset:29760
    v_mfma_f32_16x16x32_bf16 v[64:67], v[140:143], v[156:159], v[64:67]
    ds_read_b64_tr_b16 v[212:213], v221 offset:22528
    v_mfma_f32_16x16x32_bf16 v[68:71], v[140:143], v[160:163], v[68:71]
    ds_read_b64_tr_b16 v[214:215], v221 offset:26624
    v_mfma_f32_16x16x32_bf16 v[72:75], v[140:143], v[164:167], v[72:75]
    ds_read_b64_tr_b16 v[184:185], v217 offset:22624
    v_mfma_f32_16x16x32_bf16 v[76:79], v[140:143], v[168:171], v[76:79]
    ds_read_b64_tr_b16 v[186:187], v217 offset:29792
    v_mfma_f32_16x16x32_bf16 v[80:83], v[144:147], v[156:159], v[80:83]
    ds_read_b64_tr_b16 v[188:189], v216 offset:22656
    v_mfma_f32_16x16x32_bf16 v[84:87], v[144:147], v[160:163], v[84:87]
    ds_read_b64_tr_b16 v[190:191], v216 offset:29824
    v_mfma_f32_16x16x32_bf16 v[88:91], v[144:147], v[164:167], v[88:91]
    ds_read_b64_tr_b16 v[192:193], v217 offset:22688
    v_mfma_f32_16x16x32_bf16 v[92:95], v[144:147], v[168:171], v[92:95]
    ds_read_b64_tr_b16 v[194:195], v217 offset:29856
    v_mfma_f32_16x16x32_bf16 v[96:99], v[148:151], v[156:159], v[96:99]
    ds_read_b64_tr_b16 v[196:197], v248 offset:22528
    v_mfma_f32_16x16x32_bf16 v[100:103], v[148:151], v[160:163], v[100:103]
    ds_read_b64_tr_b16 v[198:199], v248 offset:29696
    v_mfma_f32_16x16x32_bf16 v[104:107], v[148:151], v[164:167], v[104:107]
    v_mfma_f32_16x16x32_bf16 v[108:111], v[148:151], v[168:171], v[108:111]
    v_mfma_f32_16x16x32_bf16 v[112:115], v[152:155], v[156:159], v[112:115]
    v_mfma_f32_16x16x32_bf16 v[116:119], v[152:155], v[160:163], v[116:119]
    v_mfma_f32_16x16x32_bf16 v[120:123], v[152:155], v[164:167], v[120:123]
    v_mfma_f32_16x16x32_bf16 v[124:127], v[152:155], v[168:171], v[124:127]
    s_waitcnt lgkmcnt(0)
    s_nop 0
    v_mfma_f32_16x16x32_bf16 v[16:19], v[172:175], v[200:203], v[16:19]
    ds_read_b64_tr_b16 v[156:157], v218 offset:45056
    v_mfma_f32_16x16x32_bf16 v[20:23], v[172:175], v[204:207], v[20:23]
    ds_read_b64_tr_b16 v[158:159], v218 offset:49152
    v_mfma_f32_16x16x32_bf16 v[24:27], v[172:175], v[208:211], v[24:27]
    ds_read_b64_tr_b16 v[128:129], v216 offset:45056
    v_mfma_f32_16x16x32_bf16 v[28:31], v[172:175], v[212:215], v[28:31]
    ds_read_b64_tr_b16 v[130:131], v216 offset:52224
    v_mfma_f32_16x16x32_bf16 v[32:35], v[176:179], v[200:203], v[32:35]
    ds_read_b64_tr_b16 v[160:161], v219 offset:45056
    v_mfma_f32_16x16x32_bf16 v[36:39], v[176:179], v[204:207], v[36:39]
    ds_read_b64_tr_b16 v[162:163], v219 offset:49152
    v_mfma_f32_16x16x32_bf16 v[40:43], v[176:179], v[208:211], v[40:43]
    ds_read_b64_tr_b16 v[132:133], v217 offset:45088
    v_mfma_f32_16x16x32_bf16 v[44:47], v[176:179], v[212:215], v[44:47]
    ds_read_b64_tr_b16 v[134:135], v217 offset:52256
    v_mfma_f32_16x16x32_bf16 v[48:51], v[180:183], v[200:203], v[48:51]
    ds_read_b64_tr_b16 v[164:165], v220 offset:45056
    v_mfma_f32_16x16x32_bf16 v[52:55], v[180:183], v[204:207], v[52:55]
    ds_read_b64_tr_b16 v[166:167], v220 offset:49152
    v_mfma_f32_16x16x32_bf16 v[56:59], v[180:183], v[208:211], v[56:59]
    ds_read_b64_tr_b16 v[136:137], v216 offset:45120
    v_mfma_f32_16x16x32_bf16 v[60:63], v[180:183], v[212:215], v[60:63]
    ds_read_b64_tr_b16 v[138:139], v216 offset:52288
    v_mfma_f32_16x16x32_bf16 v[64:67], v[184:187], v[200:203], v[64:67]
    ds_read_b64_tr_b16 v[168:169], v221 offset:45056
    v_mfma_f32_16x16x32_bf16 v[68:71], v[184:187], v[204:207], v[68:71]
    ds_read_b64_tr_b16 v[170:171], v221 offset:49152
    v_mfma_f32_16x16x32_bf16 v[72:75], v[184:187], v[208:211], v[72:75]
    ds_read_b64_tr_b16 v[140:141], v217 offset:45152
    v_mfma_f32_16x16x32_bf16 v[76:79], v[184:187], v[212:215], v[76:79]
    ds_read_b64_tr_b16 v[142:143], v217 offset:52320
    v_mfma_f32_16x16x32_bf16 v[80:83], v[188:191], v[200:203], v[80:83]
    ds_read_b64_tr_b16 v[144:145], v216 offset:45184
    v_mfma_f32_16x16x32_bf16 v[84:87], v[188:191], v[204:207], v[84:87]
    ds_read_b64_tr_b16 v[146:147], v216 offset:52352
    v_mfma_f32_16x16x32_bf16 v[88:91], v[188:191], v[208:211], v[88:91]
    ds_read_b64_tr_b16 v[148:149], v217 offset:45216
    v_mfma_f32_16x16x32_bf16 v[92:95], v[188:191], v[212:215], v[92:95]
    ds_read_b64_tr_b16 v[150:151], v217 offset:52384
    v_mfma_f32_16x16x32_bf16 v[96:99], v[192:195], v[200:203], v[96:99]
    ds_read_b64_tr_b16 v[152:153], v248 offset:45056
    v_mfma_f32_16x16x32_bf16 v[100:103], v[192:195], v[204:207], v[100:103]
    ds_read_b64_tr_b16 v[154:155], v248 offset:52224
    v_mfma_f32_16x16x32_bf16 v[104:107], v[192:195], v[208:211], v[104:107]
    s_add_u32 s22, s22, 1
    s_cmp_lt_u32 s22, 4
    v_mfma_f32_16x16x32_bf16 v[108:111], v[192:195], v[212:215], v[108:111]
    v_mfma_f32_16x16x32_bf16 v[112:115], v[196:199], v[200:203], v[112:115]
    v_mfma_f32_16x16x32_bf16 v[116:119], v[196:199], v[204:207], v[116:119]
    v_mfma_f32_16x16x32_bf16 v[120:123], v[196:199], v[208:211], v[120:123]
    v_mfma_f32_16x16x32_bf16 v[124:127], v[196:199], v[212:215], v[124:127]
    s_waitcnt lgkmcnt(0)
    s_cbranch_scc1 sequential_preLN__ssm_conv_h3__dense_activation_squared_relu__prompt_kernel_g_cloop
    buffer_load_dword v15, v14, s[48:51], 0 offen sc1
    s_barrier
    s_nop 0
    v_mfma_f32_16x16x32_bf16 v[16:19], v[128:131], v[156:159], v[16:19]
    ds_read_b64_tr_b16 v[200:201], v224 offset:0
    v_mfma_f32_16x16x32_bf16 v[20:23], v[128:131], v[160:163], v[20:23]
    ds_read_b64_tr_b16 v[202:203], v224 offset:4096
    v_mfma_f32_16x16x32_bf16 v[24:27], v[128:131], v[164:167], v[24:27]
    ds_read_b64_tr_b16 v[172:173], v222 offset:0
    v_mfma_f32_16x16x32_bf16 v[28:31], v[128:131], v[168:171], v[28:31]
    ds_read_b64_tr_b16 v[174:175], v222 offset:7168
    v_mfma_f32_16x16x32_bf16 v[32:35], v[132:135], v[156:159], v[32:35]
    ds_read_b64_tr_b16 v[204:205], v225 offset:0
    v_mfma_f32_16x16x32_bf16 v[36:39], v[132:135], v[160:163], v[36:39]
    ds_read_b64_tr_b16 v[206:207], v225 offset:4096
    v_mfma_f32_16x16x32_bf16 v[40:43], v[132:135], v[164:167], v[40:43]
    ds_read_b64_tr_b16 v[176:177], v223 offset:32
    v_mfma_f32_16x16x32_bf16 v[44:47], v[132:135], v[168:171], v[44:47]
    ds_read_b64_tr_b16 v[178:179], v223 offset:7200
    v_mfma_f32_16x16x32_bf16 v[48:51], v[136:139], v[156:159], v[48:51]
    ds_read_b64_tr_b16 v[208:209], v226 offset:0
    v_mfma_f32_16x16x32_bf16 v[52:55], v[136:139], v[160:163], v[52:55]
    ds_read_b64_tr_b16 v[210:211], v226 offset:4096
    v_mfma_f32_16x16x32_bf16 v[56:59], v[136:139], v[164:167], v[56:59]
    ds_read_b64_tr_b16 v[180:181], v222 offset:64
    v_mfma_f32_16x16x32_bf16 v[60:63], v[136:139], v[168:171], v[60:63]
    ds_read_b64_tr_b16 v[182:183], v222 offset:7232
    v_mfma_f32_16x16x32_bf16 v[64:67], v[140:143], v[156:159], v[64:67]
    ds_read_b64_tr_b16 v[212:213], v227 offset:0
    v_mfma_f32_16x16x32_bf16 v[68:71], v[140:143], v[160:163], v[68:71]
    ds_read_b64_tr_b16 v[214:215], v227 offset:4096
    v_mfma_f32_16x16x32_bf16 v[72:75], v[140:143], v[164:167], v[72:75]
    ds_read_b64_tr_b16 v[184:185], v223 offset:96
    v_mfma_f32_16x16x32_bf16 v[76:79], v[140:143], v[168:171], v[76:79]
    ds_read_b64_tr_b16 v[186:187], v223 offset:7264
    v_mfma_f32_16x16x32_bf16 v[80:83], v[144:147], v[156:159], v[80:83]
    ds_read_b64_tr_b16 v[188:189], v222 offset:128
    v_mfma_f32_16x16x32_bf16 v[84:87], v[144:147], v[160:163], v[84:87]
    ds_read_b64_tr_b16 v[190:191], v222 offset:7296
    v_mfma_f32_16x16x32_bf16 v[88:91], v[144:147], v[164:167], v[88:91]
    ds_read_b64_tr_b16 v[192:193], v223 offset:160
    v_mfma_f32_16x16x32_bf16 v[92:95], v[144:147], v[168:171], v[92:95]
    ds_read_b64_tr_b16 v[194:195], v223 offset:7328
    v_mfma_f32_16x16x32_bf16 v[96:99], v[148:151], v[156:159], v[96:99]
    ds_read_b64_tr_b16 v[196:197], v249 offset:0
    v_mfma_f32_16x16x32_bf16 v[100:103], v[148:151], v[160:163], v[100:103]
    ds_read_b64_tr_b16 v[198:199], v249 offset:7168
    v_mfma_f32_16x16x32_bf16 v[104:107], v[148:151], v[164:167], v[104:107]
    v_mfma_f32_16x16x32_bf16 v[108:111], v[148:151], v[168:171], v[108:111]
    v_mfma_f32_16x16x32_bf16 v[112:115], v[152:155], v[156:159], v[112:115]
    v_mfma_f32_16x16x32_bf16 v[116:119], v[152:155], v[160:163], v[116:119]
    v_mfma_f32_16x16x32_bf16 v[120:123], v[152:155], v[164:167], v[120:123]
    v_mfma_f32_16x16x32_bf16 v[124:127], v[152:155], v[168:171], v[124:127]
    s_waitcnt lgkmcnt(0)
    s_nop 0
    v_mfma_f32_16x16x32_bf16 v[16:19], v[172:175], v[200:203], v[16:19]
    ds_read_b64_tr_b16 v[156:157], v224 offset:22528
    v_mfma_f32_16x16x32_bf16 v[20:23], v[172:175], v[204:207], v[20:23]
    ds_read_b64_tr_b16 v[158:159], v224 offset:26624
    v_mfma_f32_16x16x32_bf16 v[24:27], v[172:175], v[208:211], v[24:27]
    ds_read_b64_tr_b16 v[128:129], v222 offset:22528
    v_mfma_f32_16x16x32_bf16 v[28:31], v[172:175], v[212:215], v[28:31]
    ds_read_b64_tr_b16 v[130:131], v222 offset:29696
    v_mfma_f32_16x16x32_bf16 v[32:35], v[176:179], v[200:203], v[32:35]
    ds_read_b64_tr_b16 v[160:161], v225 offset:22528
    v_mfma_f32_16x16x32_bf16 v[36:39], v[176:179], v[204:207], v[36:39]
    ds_read_b64_tr_b16 v[162:163], v225 offset:26624
    v_mfma_f32_16x16x32_bf16 v[40:43], v[176:179], v[208:211], v[40:43]
    ds_read_b64_tr_b16 v[132:133], v223 offset:22560
    v_mfma_f32_16x16x32_bf16 v[44:47], v[176:179], v[212:215], v[44:47]
    ds_read_b64_tr_b16 v[134:135], v223 offset:29728
    v_mfma_f32_16x16x32_bf16 v[48:51], v[180:183], v[200:203], v[48:51]
    ds_read_b64_tr_b16 v[164:165], v226 offset:22528
    v_mfma_f32_16x16x32_bf16 v[52:55], v[180:183], v[204:207], v[52:55]
    ds_read_b64_tr_b16 v[166:167], v226 offset:26624
    v_mfma_f32_16x16x32_bf16 v[56:59], v[180:183], v[208:211], v[56:59]
    ds_read_b64_tr_b16 v[136:137], v222 offset:22592
    v_mfma_f32_16x16x32_bf16 v[60:63], v[180:183], v[212:215], v[60:63]
    ds_read_b64_tr_b16 v[138:139], v222 offset:29760
    v_mfma_f32_16x16x32_bf16 v[64:67], v[184:187], v[200:203], v[64:67]
    ds_read_b64_tr_b16 v[168:169], v227 offset:22528
    v_mfma_f32_16x16x32_bf16 v[68:71], v[184:187], v[204:207], v[68:71]
    ds_read_b64_tr_b16 v[170:171], v227 offset:26624
    v_mfma_f32_16x16x32_bf16 v[72:75], v[184:187], v[208:211], v[72:75]
    ds_read_b64_tr_b16 v[140:141], v223 offset:22624
    v_mfma_f32_16x16x32_bf16 v[76:79], v[184:187], v[212:215], v[76:79]
    ds_read_b64_tr_b16 v[142:143], v223 offset:29792
    v_mfma_f32_16x16x32_bf16 v[80:83], v[188:191], v[200:203], v[80:83]
    ds_read_b64_tr_b16 v[144:145], v222 offset:22656
    s_lshl_b32 s20, s18, 9
    s_nop 0
    v_mfma_f32_16x16x32_bf16 v[84:87], v[188:191], v[204:207], v[84:87]
    ds_read_b64_tr_b16 v[146:147], v222 offset:29824
    s_add_u32 s20, s20, 147456
    v_mfma_f32_16x16x32_bf16 v[88:91], v[188:191], v[208:211], v[88:91]
    ds_read_b64_tr_b16 v[148:149], v223 offset:22688
    v_lshl_add_u32 v8, v3, 3, s20
    v_mfma_f32_16x16x32_bf16 v[92:95], v[188:191], v[212:215], v[92:95]
    ds_read_b64_tr_b16 v[150:151], v223 offset:29856
    v_mfma_f32_16x16x32_bf16 v[96:99], v[192:195], v[200:203], v[96:99]
    ds_read_b64_tr_b16 v[152:153], v249 offset:22528
    s_lshl_b32 s20, s19, 9
    s_nop 0
    v_mfma_f32_16x16x32_bf16 v[100:103], v[192:195], v[204:207], v[100:103]
    ds_read_b64_tr_b16 v[154:155], v249 offset:29696
    s_add_u32 s20, s20, 148480
    v_mfma_f32_16x16x32_bf16 v[104:107], v[192:195], v[208:211], v[104:107]
    v_lshl_add_u32 v9, v4, 4, s20
    v_mfma_f32_16x16x32_bf16 v[108:111], v[192:195], v[212:215], v[108:111]
    v_mfma_f32_16x16x32_bf16 v[112:115], v[196:199], v[200:203], v[112:115]
    s_lshl_b32 s20, s19, 6
    s_nop 0
    v_mfma_f32_16x16x32_bf16 v[116:119], v[196:199], v[204:207], v[116:119]
    s_add_u32 s20, s20, 148864
    v_mfma_f32_16x16x32_bf16 v[120:123], v[196:199], v[208:211], v[120:123]
    v_lshl_add_u32 v10, v4, 4, s20
    v_mfma_f32_16x16x32_bf16 v[124:127], v[196:199], v[212:215], v[124:127]
    s_waitcnt lgkmcnt(0)
    s_barrier
    v_mfma_f32_16x16x32_bf16 v[16:19], v[128:131], v[156:159], v[16:19]
    ds_read_b64_tr_b16 v[200:201], v224 offset:45056
    v_mfma_f32_16x16x32_bf16 v[20:23], v[128:131], v[160:163], v[20:23]
    ds_read_b64_tr_b16 v[202:203], v224 offset:49152
    v_mfma_f32_16x16x32_bf16 v[24:27], v[128:131], v[164:167], v[24:27]
    ds_read_b64_tr_b16 v[172:173], v222 offset:45056
    v_mfma_f32_16x16x32_bf16 v[28:31], v[128:131], v[168:171], v[28:31]
    ds_read_b64_tr_b16 v[174:175], v222 offset:52224
    v_mfma_f32_16x16x32_bf16 v[32:35], v[132:135], v[156:159], v[32:35]
    ds_read_b64_tr_b16 v[204:205], v225 offset:45056
    v_mfma_f32_16x16x32_bf16 v[36:39], v[132:135], v[160:163], v[36:39]
    ds_read_b64_tr_b16 v[206:207], v225 offset:49152
    v_mfma_f32_16x16x32_bf16 v[40:43], v[132:135], v[164:167], v[40:43]
    ds_read_b64_tr_b16 v[176:177], v223 offset:45088
    v_mfma_f32_16x16x32_bf16 v[44:47], v[132:135], v[168:171], v[44:47]
    ds_read_b64_tr_b16 v[178:179], v223 offset:52256
    v_mfma_f32_16x16x32_bf16 v[48:51], v[136:139], v[156:159], v[48:51]
    ds_read_b64_tr_b16 v[208:209], v226 offset:45056
    v_mfma_f32_16x16x32_bf16 v[52:55], v[136:139], v[160:163], v[52:55]
    ds_read_b64_tr_b16 v[210:211], v226 offset:49152
    v_mfma_f32_16x16x32_bf16 v[56:59], v[136:139], v[164:167], v[56:59]
    ds_read_b64_tr_b16 v[180:181], v222 offset:45120
    v_mfma_f32_16x16x32_bf16 v[60:63], v[136:139], v[168:171], v[60:63]
    ds_read_b64_tr_b16 v[182:183], v222 offset:52288
    v_mfma_f32_16x16x32_bf16 v[64:67], v[140:143], v[156:159], v[64:67]
    ds_read_b64_tr_b16 v[212:213], v227 offset:45056
    v_mfma_f32_16x16x32_bf16 v[68:71], v[140:143], v[160:163], v[68:71]
    ds_read_b64_tr_b16 v[214:215], v227 offset:49152
    v_mfma_f32_16x16x32_bf16 v[72:75], v[140:143], v[164:167], v[72:75]
    ds_read_b64_tr_b16 v[184:185], v223 offset:45152
    v_mfma_f32_16x16x32_bf16 v[76:79], v[140:143], v[168:171], v[76:79]
    ds_read_b64_tr_b16 v[186:187], v223 offset:52320
    v_mfma_f32_16x16x32_bf16 v[80:83], v[144:147], v[156:159], v[80:83]
    ds_read_b64_tr_b16 v[188:189], v222 offset:45184
    v_mfma_f32_16x16x32_bf16 v[84:87], v[144:147], v[160:163], v[84:87]
    ds_read_b64_tr_b16 v[190:191], v222 offset:52352
    v_mfma_f32_16x16x32_bf16 v[88:91], v[144:147], v[164:167], v[88:91]
    ds_read_b64_tr_b16 v[192:193], v223 offset:45216
    v_mfma_f32_16x16x32_bf16 v[92:95], v[144:147], v[168:171], v[92:95]
    ds_read_b64_tr_b16 v[194:195], v223 offset:52384
    v_mfma_f32_16x16x32_bf16 v[96:99], v[148:151], v[156:159], v[96:99]
    ds_read_b64_tr_b16 v[196:197], v249 offset:45056
    v_mfma_f32_16x16x32_bf16 v[100:103], v[148:151], v[160:163], v[100:103]
    ds_read_b64_tr_b16 v[198:199], v249 offset:52224
    v_mfma_f32_16x16x32_bf16 v[104:107], v[148:151], v[164:167], v[104:107]
    v_mfma_f32_16x16x32_bf16 v[108:111], v[148:151], v[168:171], v[108:111]
    v_mfma_f32_16x16x32_bf16 v[112:115], v[152:155], v[156:159], v[112:115]
    v_mfma_f32_16x16x32_bf16 v[116:119], v[152:155], v[160:163], v[116:119]
    v_mfma_f32_16x16x32_bf16 v[120:123], v[152:155], v[164:167], v[120:123]
    v_mfma_f32_16x16x32_bf16 v[124:127], v[152:155], v[168:171], v[124:127]
    s_waitcnt lgkmcnt(0)
    s_nop 0
    v_mfma_f32_16x16x32_bf16 v[16:19], v[172:175], v[200:203], v[16:19]
    ds_read_b64_tr_b16 v[156:157], v218 offset:0
    v_mfma_f32_16x16x32_bf16 v[20:23], v[172:175], v[204:207], v[20:23]
    ds_read_b64_tr_b16 v[158:159], v218 offset:4096
    v_mfma_f32_16x16x32_bf16 v[24:27], v[172:175], v[208:211], v[24:27]
    ds_read_b64_tr_b16 v[128:129], v216 offset:0
    v_mfma_f32_16x16x32_bf16 v[28:31], v[172:175], v[212:215], v[28:31]
    ds_read_b64_tr_b16 v[130:131], v216 offset:7168
    v_mfma_f32_16x16x32_bf16 v[32:35], v[176:179], v[200:203], v[32:35]
    ds_read_b64_tr_b16 v[160:161], v219 offset:0
    v_mfma_f32_16x16x32_bf16 v[36:39], v[176:179], v[204:207], v[36:39]
    ds_read_b64_tr_b16 v[162:163], v219 offset:4096
    v_mfma_f32_16x16x32_bf16 v[40:43], v[176:179], v[208:211], v[40:43]
    ds_read_b64_tr_b16 v[132:133], v217 offset:32
    v_mfma_f32_16x16x32_bf16 v[44:47], v[176:179], v[212:215], v[44:47]
    ds_read_b64_tr_b16 v[134:135], v217 offset:7200
    v_mfma_f32_16x16x32_bf16 v[48:51], v[180:183], v[200:203], v[48:51]
    ds_read_b64_tr_b16 v[164:165], v220 offset:0
    v_mfma_f32_16x16x32_bf16 v[52:55], v[180:183], v[204:207], v[52:55]
    ds_read_b64_tr_b16 v[166:167], v220 offset:4096
    v_mfma_f32_16x16x32_bf16 v[56:59], v[180:183], v[208:211], v[56:59]
    ds_read_b64_tr_b16 v[136:137], v216 offset:64
    v_mfma_f32_16x16x32_bf16 v[60:63], v[180:183], v[212:215], v[60:63]
    ds_read_b64_tr_b16 v[138:139], v216 offset:7232
    v_mfma_f32_16x16x32_bf16 v[64:67], v[184:187], v[200:203], v[64:67]
    ds_read_b64_tr_b16 v[168:169], v221 offset:0
    v_mfma_f32_16x16x32_bf16 v[68:71], v[184:187], v[204:207], v[68:71]
    ds_read_b64_tr_b16 v[170:171], v221 offset:4096
    v_mfma_f32_16x16x32_bf16 v[72:75], v[184:187], v[208:211], v[72:75]
    ds_read_b64_tr_b16 v[140:141], v217 offset:96
    v_mfma_f32_16x16x32_bf16 v[76:79], v[184:187], v[212:215], v[76:79]
    ds_read_b64_tr_b16 v[142:143], v217 offset:7264
    v_mfma_f32_16x16x32_bf16 v[80:83], v[188:191], v[200:203], v[80:83]
    ds_read_b64_tr_b16 v[144:145], v216 offset:128
    s_mul_i32 s23, s18, 28672
    v_mfma_f32_16x16x32_bf16 v[84:87], v[188:191], v[204:207], v[84:87]
    ds_read_b64_tr_b16 v[146:147], v216 offset:7296
    s_add_u32 s23, s23, 65536
    v_mfma_f32_16x16x32_bf16 v[88:91], v[188:191], v[208:211], v[88:91]
    ds_read_b64_tr_b16 v[148:149], v217 offset:160
    s_lshl_b32 s20, s19, 12
    s_nop 0
    v_mfma_f32_16x16x32_bf16 v[92:95], v[188:191], v[212:215], v[92:95]
    ds_read_b64_tr_b16 v[150:151], v217 offset:7328
    s_add_u32 s20, s20, s23
    s_nop 0
    v_mfma_f32_16x16x32_bf16 v[96:99], v[192:195], v[200:203], v[96:99]
    ds_read_b64_tr_b16 v[152:153], v248 offset:0
    v_add_u32_e64 v7, s20, v5
    v_mfma_f32_16x16x32_bf16 v[100:103], v[192:195], v[204:207], v[100:103]
    ds_read_b64_tr_b16 v[154:155], v248 offset:7168
    s_lshl_b32 s20, s19, 3
    s_nop 0
    v_mfma_f32_16x16x32_bf16 v[104:107], v[192:195], v[208:211], v[104:107]
    s_add_u32 s20, s20, s23
    s_nop 0
    v_mfma_f32_16x16x32_bf16 v[108:111], v[192:195], v[212:215], v[108:111]
    s_add_u32 s20, s20, 3072
    v_mfma_f32_16x16x32_bf16 v[112:115], v[196:199], v[200:203], v[112:115]
    v_add_u32_e64 v6, s20, v5
    v_mfma_f32_16x16x32_bf16 v[116:119], v[196:199], v[204:207], v[116:119]
    s_mul_i32 s20, s14, 14336
    v_mfma_f32_16x16x32_bf16 v[120:123], v[196:199], v[208:211], v[120:123]
    s_add_u32 s20, s20, 65536
    v_mfma_f32_16x16x32_bf16 v[124:127], v[196:199], v[212:215], v[124:127]
    v_add_u32_e64 v12, s20, v5
    s_waitcnt lgkmcnt(0)
    s_barrier
    v_mfma_f32_16x16x32_bf16 v[16:19], v[128:131], v[156:159], v[16:19]
    ds_read_b64_tr_b16 v[200:201], v218 offset:22528
    v_mfma_f32_16x16x32_bf16 v[20:23], v[128:131], v[160:163], v[20:23]
    ds_read_b64_tr_b16 v[202:203], v218 offset:26624
    v_mfma_f32_16x16x32_bf16 v[24:27], v[128:131], v[164:167], v[24:27]
    ds_read_b64_tr_b16 v[172:173], v216 offset:22528
    v_mfma_f32_16x16x32_bf16 v[28:31], v[128:131], v[168:171], v[28:31]
    ds_read_b64_tr_b16 v[174:175], v216 offset:29696
    v_mfma_f32_16x16x32_bf16 v[32:35], v[132:135], v[156:159], v[32:35]
    ds_read_b64_tr_b16 v[204:205], v219 offset:22528
    v_mfma_f32_16x16x32_bf16 v[36:39], v[132:135], v[160:163], v[36:39]
    ds_read_b64_tr_b16 v[206:207], v219 offset:26624
    v_mfma_f32_16x16x32_bf16 v[40:43], v[132:135], v[164:167], v[40:43]
    ds_read_b64_tr_b16 v[176:177], v217 offset:22560
    v_mfma_f32_16x16x32_bf16 v[44:47], v[132:135], v[168:171], v[44:47]
    ds_read_b64_tr_b16 v[178:179], v217 offset:29728
    v_mfma_f32_16x16x32_bf16 v[48:51], v[136:139], v[156:159], v[48:51]
    ds_read_b64_tr_b16 v[208:209], v220 offset:22528
    v_mfma_f32_16x16x32_bf16 v[52:55], v[136:139], v[160:163], v[52:55]
    ds_read_b64_tr_b16 v[210:211], v220 offset:26624
    v_mfma_f32_16x16x32_bf16 v[56:59], v[136:139], v[164:167], v[56:59]
    ds_read_b64_tr_b16 v[180:181], v216 offset:22592
    v_mfma_f32_16x16x32_bf16 v[60:63], v[136:139], v[168:171], v[60:63]
    ds_read_b64_tr_b16 v[182:183], v216 offset:29760
    v_mfma_f32_16x16x32_bf16 v[64:67], v[140:143], v[156:159], v[64:67]
    ds_read_b64_tr_b16 v[212:213], v221 offset:22528
    v_mfma_f32_16x16x32_bf16 v[68:71], v[140:143], v[160:163], v[68:71]
    ds_read_b64_tr_b16 v[214:215], v221 offset:26624
    v_mfma_f32_16x16x32_bf16 v[72:75], v[140:143], v[164:167], v[72:75]
    ds_read_b64_tr_b16 v[184:185], v217 offset:22624
    v_mfma_f32_16x16x32_bf16 v[76:79], v[140:143], v[168:171], v[76:79]
    ds_read_b64_tr_b16 v[186:187], v217 offset:29792
    v_mfma_f32_16x16x32_bf16 v[80:83], v[144:147], v[156:159], v[80:83]
    ds_read_b64_tr_b16 v[188:189], v216 offset:22656
    v_mfma_f32_16x16x32_bf16 v[84:87], v[144:147], v[160:163], v[84:87]
    ds_read_b64_tr_b16 v[190:191], v216 offset:29824
    v_mfma_f32_16x16x32_bf16 v[88:91], v[144:147], v[164:167], v[88:91]
    ds_read_b64_tr_b16 v[192:193], v217 offset:22688
    v_mfma_f32_16x16x32_bf16 v[92:95], v[144:147], v[168:171], v[92:95]
    ds_read_b64_tr_b16 v[194:195], v217 offset:29856
    v_mfma_f32_16x16x32_bf16 v[96:99], v[148:151], v[156:159], v[96:99]
    ds_read_b64_tr_b16 v[196:197], v248 offset:22528
    v_mfma_f32_16x16x32_bf16 v[100:103], v[148:151], v[160:163], v[100:103]
    ds_read_b64_tr_b16 v[198:199], v248 offset:29696
    v_mfma_f32_16x16x32_bf16 v[104:107], v[148:151], v[164:167], v[104:107]
    v_mfma_f32_16x16x32_bf16 v[108:111], v[148:151], v[168:171], v[108:111]
    v_mfma_f32_16x16x32_bf16 v[112:115], v[152:155], v[156:159], v[112:115]
    v_mfma_f32_16x16x32_bf16 v[116:119], v[152:155], v[160:163], v[116:119]
    v_mfma_f32_16x16x32_bf16 v[120:123], v[152:155], v[164:167], v[120:123]
    v_mfma_f32_16x16x32_bf16 v[124:127], v[152:155], v[168:171], v[124:127]
    s_waitcnt lgkmcnt(0)
    s_barrier
    v_mfma_f32_16x16x32_bf16 v[16:19], v[172:175], v[200:203], v[16:19]
    ds_read_b64 v[128:129], v8 offset:0
    ds_read_b64 v[130:131], v8 offset:128
    v_mfma_f32_16x16x32_bf16 v[32:35], v[176:179], v[200:203], v[32:35]
    ds_read_b64 v[132:133], v8 offset:256
    v_mfma_f32_16x16x32_bf16 v[48:51], v[180:183], v[200:203], v[48:51]
    ds_read_b64 v[134:135], v8 offset:384
    ds_read_b128 v[136:139], v9 offset:0
    v_mfma_f32_16x16x32_bf16 v[64:67], v[184:187], v[200:203], v[64:67]
    ds_read_b128 v[228:231], v9 offset:896
    v_mfma_f32_16x16x32_bf16 v[80:83], v[188:191], v[200:203], v[80:83]
    ds_read_b128 v[140:143], v9 offset:64
    ds_read_b128 v[232:235], v9 offset:960
    v_mfma_f32_16x16x32_bf16 v[96:99], v[192:195], v[200:203], v[96:99]
    ds_read_b128 v[144:147], v9 offset:128
    v_mfma_f32_16x16x32_bf16 v[112:115], v[196:199], v[200:203], v[112:115]
    ds_read_b128 v[236:239], v9 offset:1024
    ds_read_b128 v[148:151], v9 offset:192
    v_mfma_f32_16x16x32_bf16 v[20:23], v[172:175], v[204:207], v[20:23]
    ds_read_b128 v[240:243], v9 offset:1088
    v_mfma_f32_16x16x32_bf16 v[36:39], v[176:179], v[204:207], v[36:39]
    ds_read_b128 v[152:155], v9 offset:256
    ds_read_b128 v[244:247], v9 offset:1152
    v_mfma_f32_16x16x32_bf16 v[52:55], v[180:183], v[204:207], v[52:55]
    ds_read_b128 v[156:159], v9 offset:320
    v_mfma_f32_16x16x32_bf16 v[68:71], v[184:187], v[204:207], v[68:71]
    ds_read_b128 v[248:251], v9 offset:1216
    ds_read_b128 v[160:163], v10 offset:0
    v_mfma_f32_16x16x32_bf16 v[84:87], v[188:191], v[204:207], v[84:87]
    ds_read_b128 v[252:255], v10 offset:896
    v_mfma_f32_16x16x32_bf16 v[100:103], v[192:195], v[204:207], v[100:103]
    v_mfma_f32_16x16x32_bf16 v[116:119], v[196:199], v[204:207], v[116:119]
    v_mfma_f32_16x16x32_bf16 v[24:27], v[172:175], v[208:211], v[24:27]
    v_mfma_f32_16x16x32_bf16 v[40:43], v[176:179], v[208:211], v[40:43]
    s_waitcnt lgkmcnt(0)
    s_nop 0
    v_mfma_f32_16x16x32_bf16 v[56:59], v[180:183], v[208:211], v[56:59]
    v_pk_fma_f32 v[164:165], v[136:137], v[128:129], v[228:229] op_sel:[0,1,0] op_sel_hi:[1,1,1]
    v_pk_fma_f32 v[166:167], v[138:139], v[128:129], v[230:231] op_sel:[0,1,0] op_sel_hi:[1,1,1]
    v_mfma_f32_16x16x32_bf16 v[72:75], v[184:187], v[208:211], v[72:75]
    v_pk_fma_f32 v[16:17], v[16:17], v[128:129], v[164:165] op_sel:[0,0,0] op_sel_hi:[1,0,1]
    v_pk_fma_f32 v[18:19], v[18:19], v[128:129], v[166:167] op_sel:[0,0,0] op_sel_hi:[1,0,1]
    v_mfma_f32_16x16x32_bf16 v[88:91], v[188:191], v[208:211], v[88:91]
    v_max_f32 v16, 0, v16
    v_max_f32 v17, 0, v17
    v_mfma_f32_16x16x32_bf16 v[104:107], v[192:195], v[208:211], v[104:107]
    v_max_f32 v18, 0, v18
    v_max_f32 v19, 0, v19
    v_mfma_f32_16x16x32_bf16 v[120:123], v[196:199], v[208:211], v[120:123]
    v_pk_mul_f32 v[16:17], v[16:17], v[16:17]
    v_pk_mul_f32 v[18:19], v[18:19], v[18:19]
    v_mfma_f32_16x16x32_bf16 v[28:31], v[172:175], v[212:215], v[28:31]
    v_cvt_pk_bf16_f32 v216, v16, v17
    v_cvt_pk_bf16_f32 v217, v18, v19
    v_mfma_f32_16x16x32_bf16 v[44:47], v[176:179], v[212:215], v[44:47]
    v_pk_fma_f32 v[168:169], v[140:141], v[128:129], v[232:233] op_sel:[0,1,0] op_sel_hi:[1,1,1]
    v_pk_fma_f32 v[170:171], v[142:143], v[128:129], v[234:235] op_sel:[0,1,0] op_sel_hi:[1,1,1]
    v_mfma_f32_16x16x32_bf16 v[60:63], v[180:183], v[212:215], v[60:63]
    v_pk_fma_f32 v[32:33], v[32:33], v[128:129], v[168:169] op_sel:[0,0,0] op_sel_hi:[1,0,1]
    v_pk_fma_f32 v[34:35], v[34:35], v[128:129], v[170:171] op_sel:[0,0,0] op_sel_hi:[1,0,1]
    v_mfma_f32_16x16x32_bf16 v[76:79], v[184:187], v[212:215], v[76:79]
    v_max_f32 v32, 0, v32
    v_max_f32 v33, 0, v33
    v_mfma_f32_16x16x32_bf16 v[92:95], v[188:191], v[212:215], v[92:95]
    v_max_f32 v34, 0, v34
    v_max_f32 v35, 0, v35
    v_mfma_f32_16x16x32_bf16 v[108:111], v[192:195], v[212:215], v[108:111]
    v_pk_mul_f32 v[32:33], v[32:33], v[32:33]
    v_pk_mul_f32 v[34:35], v[34:35], v[34:35]
    v_mfma_f32_16x16x32_bf16 v[124:127], v[196:199], v[212:215], v[124:127]
    v_cvt_pk_bf16_f32 v218, v32, v33
    v_cvt_pk_bf16_f32 v219, v34, v35
    ds_write_b128 v7, v[216:219] offset:0
    v_pk_fma_f32 v[164:165], v[144:145], v[128:129], v[236:237] op_sel:[0,1,0] op_sel_hi:[1,1,1]
    v_pk_fma_f32 v[166:167], v[146:147], v[128:129], v[238:239] op_sel:[0,1,0] op_sel_hi:[1,1,1]
    v_pk_fma_f32 v[48:49], v[48:49], v[128:129], v[164:165] op_sel:[0,0,0] op_sel_hi:[1,0,1]
    v_pk_fma_f32 v[50:51], v[50:51], v[128:129], v[166:167] op_sel:[0,0,0] op_sel_hi:[1,0,1]
    v_max_f32 v48, 0, v48
    v_max_f32 v49, 0, v49
    v_max_f32 v50, 0, v50
    v_max_f32 v51, 0, v51
    v_pk_mul_f32 v[48:49], v[48:49], v[48:49]
    v_pk_mul_f32 v[50:51], v[50:51], v[50:51]
    v_cvt_pk_bf16_f32 v220, v48, v49
    v_cvt_pk_bf16_f32 v221, v50, v51
    v_pk_fma_f32 v[168:169], v[148:149], v[128:129], v[240:241] op_sel:[0,1,0] op_sel_hi:[1,1,1]
    v_pk_fma_f32 v[170:171], v[150:151], v[128:129], v[242:243] op_sel:[0,1,0] op_sel_hi:[1,1,1]
    v_pk_fma_f32 v[64:65], v[64:65], v[128:129], v[168:169] op_sel:[0,0,0] op_sel_hi:[1,0,1]
    v_pk_fma_f32 v[66:67], v[66:67], v[128:129], v[170:171] op_sel:[0,0,0] op_sel_hi:[1,0,1]
    v_max_f32 v64, 0, v64
    v_max_f32 v65, 0, v65
    v_max_f32 v66, 0, v66
    v_max_f32 v67, 0, v67
    v_pk_mul_f32 v[64:65], v[64:65], v[64:65]
    v_pk_mul_f32 v[66:67], v[66:67], v[66:67]
    v_cvt_pk_bf16_f32 v222, v64, v65
    v_cvt_pk_bf16_f32 v223, v66, v67
    ds_write_b128 v7, v[220:223] offset:1024
    v_pk_fma_f32 v[164:165], v[152:153], v[128:129], v[244:245] op_sel:[0,1,0] op_sel_hi:[1,1,1]
    v_pk_fma_f32 v[166:167], v[154:155], v[128:129], v[246:247] op_sel:[0,1,0] op_sel_hi:[1,1,1]
    v_pk_fma_f32 v[80:81], v[80:81], v[128:129], v[164:165] op_sel:[0,0,0] op_sel_hi:[1,0,1]
    v_pk_fma_f32 v[82:83], v[82:83], v[128:129], v[166:167] op_sel:[0,0,0] op_sel_hi:[1,0,1]
    v_max_f32 v80, 0, v80
    v_max_f32 v81, 0, v81
    v_max_f32 v82, 0, v82
    v_max_f32 v83, 0, v83
    v_pk_mul_f32 v[80:81], v[80:81], v[80:81]
    v_pk_mul_f32 v[82:83], v[82:83], v[82:83]
    v_cvt_pk_bf16_f32 v224, v80, v81
    v_cvt_pk_bf16_f32 v225, v82, v83
    v_pk_fma_f32 v[168:169], v[156:157], v[128:129], v[248:249] op_sel:[0,1,0] op_sel_hi:[1,1,1]
    v_pk_fma_f32 v[170:171], v[158:159], v[128:129], v[250:251] op_sel:[0,1,0] op_sel_hi:[1,1,1]
    v_pk_fma_f32 v[96:97], v[96:97], v[128:129], v[168:169] op_sel:[0,0,0] op_sel_hi:[1,0,1]
    v_pk_fma_f32 v[98:99], v[98:99], v[128:129], v[170:171] op_sel:[0,0,0] op_sel_hi:[1,0,1]
    v_max_f32 v96, 0, v96
    v_max_f32 v97, 0, v97
    v_max_f32 v98, 0, v98
    v_max_f32 v99, 0, v99
    v_pk_mul_f32 v[96:97], v[96:97], v[96:97]
    v_pk_mul_f32 v[98:99], v[98:99], v[98:99]
    v_cvt_pk_bf16_f32 v226, v96, v97
    v_cvt_pk_bf16_f32 v227, v98, v99
    ds_write_b128 v7, v[224:227] offset:2048
    v_pk_fma_f32 v[164:165], v[160:161], v[128:129], v[252:253] op_sel:[0,1,0] op_sel_hi:[1,1,1]
    v_pk_fma_f32 v[166:167], v[162:163], v[128:129], v[254:255] op_sel:[0,1,0] op_sel_hi:[1,1,1]
    v_pk_fma_f32 v[112:113], v[112:113], v[128:129], v[164:165] op_sel:[0,0,0] op_sel_hi:[1,0,1]
    v_pk_fma_f32 v[114:115], v[114:115], v[128:129], v[166:167] op_sel:[0,0,0] op_sel_hi:[1,0,1]
    v_max_f32 v112, 0, v112
    v_max_f32 v113, 0, v113
    v_max_f32 v114, 0, v114
    v_max_f32 v115, 0, v115
    v_pk_mul_f32 v[112:113], v[112:113], v[112:113]
    v_pk_mul_f32 v[114:115], v[114:115], v[114:115]
    v_cvt_pk_bf16_f32 v216, v112, v113
    v_cvt_pk_bf16_f32 v217, v114, v115
    ds_write_b64 v6, v[216:217] offset:0
    v_pk_fma_f32 v[164:165], v[136:137], v[130:131], v[228:229] op_sel:[0,1,0] op_sel_hi:[1,1,1]
    v_pk_fma_f32 v[166:167], v[138:139], v[130:131], v[230:231] op_sel:[0,1,0] op_sel_hi:[1,1,1]
    v_pk_fma_f32 v[20:21], v[20:21], v[130:131], v[164:165] op_sel:[0,0,0] op_sel_hi:[1,0,1]
    v_pk_fma_f32 v[22:23], v[22:23], v[130:131], v[166:167] op_sel:[0,0,0] op_sel_hi:[1,0,1]
    v_max_f32 v20, 0, v20
    v_max_f32 v21, 0, v21
    v_max_f32 v22, 0, v22
    v_max_f32 v23, 0, v23
    v_pk_mul_f32 v[20:21], v[20:21], v[20:21]
    v_pk_mul_f32 v[22:23], v[22:23], v[22:23]
    v_cvt_pk_bf16_f32 v220, v20, v21
    v_cvt_pk_bf16_f32 v221, v22, v23
    v_pk_fma_f32 v[168:169], v[140:141], v[130:131], v[232:233] op_sel:[0,1,0] op_sel_hi:[1,1,1]
    v_pk_fma_f32 v[170:171], v[142:143], v[130:131], v[234:235] op_sel:[0,1,0] op_sel_hi:[1,1,1]
    v_pk_fma_f32 v[36:37], v[36:37], v[130:131], v[168:169] op_sel:[0,0,0] op_sel_hi:[1,0,1]
    v_pk_fma_f32 v[38:39], v[38:39], v[130:131], v[170:171] op_sel:[0,0,0] op_sel_hi:[1,0,1]
    v_max_f32 v36, 0, v36
    v_max_f32 v37, 0, v37
    v_max_f32 v38, 0, v38
    v_max_f32 v39, 0, v39
    v_pk_mul_f32 v[36:37], v[36:37], v[36:37]
    v_pk_mul_f32 v[38:39], v[38:39], v[38:39]
    v_cvt_pk_bf16_f32 v222, v36, v37
    v_cvt_pk_bf16_f32 v223, v38, v39
    ds_write_b128 v7, v[220:223] offset:7168
    v_pk_fma_f32 v[164:165], v[144:145], v[130:131], v[236:237] op_sel:[0,1,0] op_sel_hi:[1,1,1]
    v_pk_fma_f32 v[166:167], v[146:147], v[130:131], v[238:239] op_sel:[0,1,0] op_sel_hi:[1,1,1]
    v_pk_fma_f32 v[52:53], v[52:53], v[130:131], v[164:165] op_sel:[0,0,0] op_sel_hi:[1,0,1]
    v_pk_fma_f32 v[54:55], v[54:55], v[130:131], v[166:167] op_sel:[0,0,0] op_sel_hi:[1,0,1]
    v_max_f32 v52, 0, v52
    v_max_f32 v53, 0, v53
    v_max_f32 v54, 0, v54
    v_max_f32 v55, 0, v55
    v_pk_mul_f32 v[52:53], v[52:53], v[52:53]
    v_pk_mul_f32 v[54:55], v[54:55], v[54:55]
    v_cvt_pk_bf16_f32 v224, v52, v53
    v_cvt_pk_bf16_f32 v225, v54, v55
    v_pk_fma_f32 v[168:169], v[148:149], v[130:131], v[240:241] op_sel:[0,1,0] op_sel_hi:[1,1,1]
    v_pk_fma_f32 v[170:171], v[150:151], v[130:131], v[242:243] op_sel:[0,1,0] op_sel_hi:[1,1,1]
    v_pk_fma_f32 v[68:69], v[68:69], v[130:131], v[168:169] op_sel:[0,0,0] op_sel_hi:[1,0,1]
    v_pk_fma_f32 v[70:71], v[70:71], v[130:131], v[170:171] op_sel:[0,0,0] op_sel_hi:[1,0,1]
    v_max_f32 v68, 0, v68
    v_max_f32 v69, 0, v69
    v_max_f32 v70, 0, v70
    v_max_f32 v71, 0, v71
    v_pk_mul_f32 v[68:69], v[68:69], v[68:69]
    v_pk_mul_f32 v[70:71], v[70:71], v[70:71]
    v_cvt_pk_bf16_f32 v226, v68, v69
    v_cvt_pk_bf16_f32 v227, v70, v71
    ds_write_b128 v7, v[224:227] offset:8192
    v_pk_fma_f32 v[164:165], v[152:153], v[130:131], v[244:245] op_sel:[0,1,0] op_sel_hi:[1,1,1]
    v_pk_fma_f32 v[166:167], v[154:155], v[130:131], v[246:247] op_sel:[0,1,0] op_sel_hi:[1,1,1]
    v_pk_fma_f32 v[84:85], v[84:85], v[130:131], v[164:165] op_sel:[0,0,0] op_sel_hi:[1,0,1]
    v_pk_fma_f32 v[86:87], v[86:87], v[130:131], v[166:167] op_sel:[0,0,0] op_sel_hi:[1,0,1]
    v_max_f32 v84, 0, v84
    v_max_f32 v85, 0, v85
    v_max_f32 v86, 0, v86
    v_max_f32 v87, 0, v87
    v_pk_mul_f32 v[84:85], v[84:85], v[84:85]
    v_pk_mul_f32 v[86:87], v[86:87], v[86:87]
    v_cvt_pk_bf16_f32 v216, v84, v85
    v_cvt_pk_bf16_f32 v217, v86, v87
    v_pk_fma_f32 v[168:169], v[156:157], v[130:131], v[248:249] op_sel:[0,1,0] op_sel_hi:[1,1,1]
    v_pk_fma_f32 v[170:171], v[158:159], v[130:131], v[250:251] op_sel:[0,1,0] op_sel_hi:[1,1,1]
    v_pk_fma_f32 v[100:101], v[100:101], v[130:131], v[168:169] op_sel:[0,0,0] op_sel_hi:[1,0,1]
    v_pk_fma_f32 v[102:103], v[102:103], v[130:131], v[170:171] op_sel:[0,0,0] op_sel_hi:[1,0,1]
    v_max_f32 v100, 0, v100
    v_max_f32 v101, 0, v101
    v_max_f32 v102, 0, v102
    v_max_f32 v103, 0, v103
    v_pk_mul_f32 v[100:101], v[100:101], v[100:101]
    v_pk_mul_f32 v[102:103], v[102:103], v[102:103]
    v_cvt_pk_bf16_f32 v218, v100, v101
    v_cvt_pk_bf16_f32 v219, v102, v103
    ds_write_b128 v7, v[216:219] offset:9216
    v_pk_fma_f32 v[164:165], v[160:161], v[130:131], v[252:253] op_sel:[0,1,0] op_sel_hi:[1,1,1]
    v_pk_fma_f32 v[166:167], v[162:163], v[130:131], v[254:255] op_sel:[0,1,0] op_sel_hi:[1,1,1]
    v_pk_fma_f32 v[116:117], v[116:117], v[130:131], v[164:165] op_sel:[0,0,0] op_sel_hi:[1,0,1]
    v_pk_fma_f32 v[118:119], v[118:119], v[130:131], v[166:167] op_sel:[0,0,0] op_sel_hi:[1,0,1]
    v_max_f32 v116, 0, v116
    v_max_f32 v117, 0, v117
    v_max_f32 v118, 0, v118
    v_max_f32 v119, 0, v119
    v_pk_mul_f32 v[116:117], v[116:117], v[116:117]
    v_pk_mul_f32 v[118:119], v[118:119], v[118:119]
    v_cvt_pk_bf16_f32 v220, v116, v117
    v_cvt_pk_bf16_f32 v221, v118, v119
    ds_write_b64 v6, v[220:221] offset:7168
    v_pk_fma_f32 v[164:165], v[136:137], v[132:133], v[228:229] op_sel:[0,1,0] op_sel_hi:[1,1,1]
    v_pk_fma_f32 v[166:167], v[138:139], v[132:133], v[230:231] op_sel:[0,1,0] op_sel_hi:[1,1,1]
    v_pk_fma_f32 v[24:25], v[24:25], v[132:133], v[164:165] op_sel:[0,0,0] op_sel_hi:[1,0,1]
    v_pk_fma_f32 v[26:27], v[26:27], v[132:133], v[166:167] op_sel:[0,0,0] op_sel_hi:[1,0,1]
    v_max_f32 v24, 0, v24
    v_max_f32 v25, 0, v25
    v_max_f32 v26, 0, v26
    v_max_f32 v27, 0, v27
    v_pk_mul_f32 v[24:25], v[24:25], v[24:25]
    v_pk_mul_f32 v[26:27], v[26:27], v[26:27]
    v_cvt_pk_bf16_f32 v224, v24, v25
    v_cvt_pk_bf16_f32 v225, v26, v27
    v_pk_fma_f32 v[168:169], v[140:141], v[132:133], v[232:233] op_sel:[0,1,0] op_sel_hi:[1,1,1]
    v_pk_fma_f32 v[170:171], v[142:143], v[132:133], v[234:235] op_sel:[0,1,0] op_sel_hi:[1,1,1]
    v_pk_fma_f32 v[40:41], v[40:41], v[132:133], v[168:169] op_sel:[0,0,0] op_sel_hi:[1,0,1]
    v_pk_fma_f32 v[42:43], v[42:43], v[132:133], v[170:171] op_sel:[0,0,0] op_sel_hi:[1,0,1]
    v_max_f32 v40, 0, v40
    v_max_f32 v41, 0, v41
    v_max_f32 v42, 0, v42
    v_max_f32 v43, 0, v43
    v_pk_mul_f32 v[40:41], v[40:41], v[40:41]
    v_pk_mul_f32 v[42:43], v[42:43], v[42:43]
    v_cvt_pk_bf16_f32 v226, v40, v41
    v_cvt_pk_bf16_f32 v227, v42, v43
    ds_write_b128 v7, v[224:227] offset:14336
    v_pk_fma_f32 v[164:165], v[144:145], v[132:133], v[236:237] op_sel:[0,1,0] op_sel_hi:[1,1,1]
    v_pk_fma_f32 v[166:167], v[146:147], v[132:133], v[238:239] op_sel:[0,1,0] op_sel_hi:[1,1,1]
    v_pk_fma_f32 v[56:57], v[56:57], v[132:133], v[164:165] op_sel:[0,0,0] op_sel_hi:[1,0,1]
    v_pk_fma_f32 v[58:59], v[58:59], v[132:133], v[166:167] op_sel:[0,0,0] op_sel_hi:[1,0,1]
    v_max_f32 v56, 0, v56
    v_max_f32 v57, 0, v57
    v_max_f32 v58, 0, v58
    v_max_f32 v59, 0, v59
    v_pk_mul_f32 v[56:57], v[56:57], v[56:57]
    v_pk_mul_f32 v[58:59], v[58:59], v[58:59]
    v_cvt_pk_bf16_f32 v216, v56, v57
    v_cvt_pk_bf16_f32 v217, v58, v59
    v_pk_fma_f32 v[168:169], v[148:149], v[132:133], v[240:241] op_sel:[0,1,0] op_sel_hi:[1,1,1]
    v_pk_fma_f32 v[170:171], v[150:151], v[132:133], v[242:243] op_sel:[0,1,0] op_sel_hi:[1,1,1]
    v_pk_fma_f32 v[72:73], v[72:73], v[132:133], v[168:169] op_sel:[0,0,0] op_sel_hi:[1,0,1]
    v_pk_fma_f32 v[74:75], v[74:75], v[132:133], v[170:171] op_sel:[0,0,0] op_sel_hi:[1,0,1]
    v_max_f32 v72, 0, v72
    v_max_f32 v73, 0, v73
    v_max_f32 v74, 0, v74
    v_max_f32 v75, 0, v75
    v_pk_mul_f32 v[72:73], v[72:73], v[72:73]
    v_pk_mul_f32 v[74:75], v[74:75], v[74:75]
    v_cvt_pk_bf16_f32 v218, v72, v73
    v_cvt_pk_bf16_f32 v219, v74, v75
    ds_write_b128 v7, v[216:219] offset:15360
    v_pk_fma_f32 v[164:165], v[152:153], v[132:133], v[244:245] op_sel:[0,1,0] op_sel_hi:[1,1,1]
    v_pk_fma_f32 v[166:167], v[154:155], v[132:133], v[246:247] op_sel:[0,1,0] op_sel_hi:[1,1,1]
    v_pk_fma_f32 v[88:89], v[88:89], v[132:133], v[164:165] op_sel:[0,0,0] op_sel_hi:[1,0,1]
    v_pk_fma_f32 v[90:91], v[90:91], v[132:133], v[166:167] op_sel:[0,0,0] op_sel_hi:[1,0,1]
    v_max_f32 v88, 0, v88
    v_max_f32 v89, 0, v89
    v_max_f32 v90, 0, v90
    v_max_f32 v91, 0, v91
    v_pk_mul_f32 v[88:89], v[88:89], v[88:89]
    v_pk_mul_f32 v[90:91], v[90:91], v[90:91]
    v_cvt_pk_bf16_f32 v220, v88, v89
    v_cvt_pk_bf16_f32 v221, v90, v91
    v_pk_fma_f32 v[168:169], v[156:157], v[132:133], v[248:249] op_sel:[0,1,0] op_sel_hi:[1,1,1]
    v_pk_fma_f32 v[170:171], v[158:159], v[132:133], v[250:251] op_sel:[0,1,0] op_sel_hi:[1,1,1]
    v_pk_fma_f32 v[104:105], v[104:105], v[132:133], v[168:169] op_sel:[0,0,0] op_sel_hi:[1,0,1]
    v_pk_fma_f32 v[106:107], v[106:107], v[132:133], v[170:171] op_sel:[0,0,0] op_sel_hi:[1,0,1]
    v_max_f32 v104, 0, v104
    v_max_f32 v105, 0, v105
    v_max_f32 v106, 0, v106
    v_max_f32 v107, 0, v107
    v_pk_mul_f32 v[104:105], v[104:105], v[104:105]
    v_pk_mul_f32 v[106:107], v[106:107], v[106:107]
    v_cvt_pk_bf16_f32 v222, v104, v105
    v_cvt_pk_bf16_f32 v223, v106, v107
    ds_write_b128 v7, v[220:223] offset:16384
    v_pk_fma_f32 v[164:165], v[160:161], v[132:133], v[252:253] op_sel:[0,1,0] op_sel_hi:[1,1,1]
    v_pk_fma_f32 v[166:167], v[162:163], v[132:133], v[254:255] op_sel:[0,1,0] op_sel_hi:[1,1,1]
    v_pk_fma_f32 v[120:121], v[120:121], v[132:133], v[164:165] op_sel:[0,0,0] op_sel_hi:[1,0,1]
    v_pk_fma_f32 v[122:123], v[122:123], v[132:133], v[166:167] op_sel:[0,0,0] op_sel_hi:[1,0,1]
    v_max_f32 v120, 0, v120
    v_max_f32 v121, 0, v121
    v_max_f32 v122, 0, v122
    v_max_f32 v123, 0, v123
    v_pk_mul_f32 v[120:121], v[120:121], v[120:121]
    v_pk_mul_f32 v[122:123], v[122:123], v[122:123]
    v_cvt_pk_bf16_f32 v224, v120, v121
    v_cvt_pk_bf16_f32 v225, v122, v123
    ds_write_b64 v6, v[224:225] offset:14336
    v_pk_fma_f32 v[164:165], v[136:137], v[134:135], v[228:229] op_sel:[0,1,0] op_sel_hi:[1,1,1]
    v_pk_fma_f32 v[166:167], v[138:139], v[134:135], v[230:231] op_sel:[0,1,0] op_sel_hi:[1,1,1]
    v_pk_fma_f32 v[28:29], v[28:29], v[134:135], v[164:165] op_sel:[0,0,0] op_sel_hi:[1,0,1]
    v_pk_fma_f32 v[30:31], v[30:31], v[134:135], v[166:167] op_sel:[0,0,0] op_sel_hi:[1,0,1]
    v_max_f32 v28, 0, v28
    v_max_f32 v29, 0, v29
    v_max_f32 v30, 0, v30
    v_max_f32 v31, 0, v31
    v_pk_mul_f32 v[28:29], v[28:29], v[28:29]
    v_pk_mul_f32 v[30:31], v[30:31], v[30:31]
    v_cvt_pk_bf16_f32 v216, v28, v29
    v_cvt_pk_bf16_f32 v217, v30, v31
    v_pk_fma_f32 v[168:169], v[140:141], v[134:135], v[232:233] op_sel:[0,1,0] op_sel_hi:[1,1,1]
    v_pk_fma_f32 v[170:171], v[142:143], v[134:135], v[234:235] op_sel:[0,1,0] op_sel_hi:[1,1,1]
    v_pk_fma_f32 v[44:45], v[44:45], v[134:135], v[168:169] op_sel:[0,0,0] op_sel_hi:[1,0,1]
    v_pk_fma_f32 v[46:47], v[46:47], v[134:135], v[170:171] op_sel:[0,0,0] op_sel_hi:[1,0,1]
    v_max_f32 v44, 0, v44
    v_max_f32 v45, 0, v45
    v_max_f32 v46, 0, v46
    v_max_f32 v47, 0, v47
    v_pk_mul_f32 v[44:45], v[44:45], v[44:45]
    v_pk_mul_f32 v[46:47], v[46:47], v[46:47]
    v_cvt_pk_bf16_f32 v218, v44, v45
    v_cvt_pk_bf16_f32 v219, v46, v47
    ds_write_b128 v7, v[216:219] offset:21504
    v_pk_fma_f32 v[164:165], v[144:145], v[134:135], v[236:237] op_sel:[0,1,0] op_sel_hi:[1,1,1]
    v_pk_fma_f32 v[166:167], v[146:147], v[134:135], v[238:239] op_sel:[0,1,0] op_sel_hi:[1,1,1]
    v_pk_fma_f32 v[60:61], v[60:61], v[134:135], v[164:165] op_sel:[0,0,0] op_sel_hi:[1,0,1]
    v_pk_fma_f32 v[62:63], v[62:63], v[134:135], v[166:167] op_sel:[0,0,0] op_sel_hi:[1,0,1]
    v_max_f32 v60, 0, v60
    v_max_f32 v61, 0, v61
    v_max_f32 v62, 0, v62
    v_max_f32 v63, 0, v63
    v_pk_mul_f32 v[60:61], v[60:61], v[60:61]
    v_pk_mul_f32 v[62:63], v[62:63], v[62:63]
    v_cvt_pk_bf16_f32 v220, v60, v61
    v_cvt_pk_bf16_f32 v221, v62, v63
    v_pk_fma_f32 v[168:169], v[148:149], v[134:135], v[240:241] op_sel:[0,1,0] op_sel_hi:[1,1,1]
    v_pk_fma_f32 v[170:171], v[150:151], v[134:135], v[242:243] op_sel:[0,1,0] op_sel_hi:[1,1,1]
    v_pk_fma_f32 v[76:77], v[76:77], v[134:135], v[168:169] op_sel:[0,0,0] op_sel_hi:[1,0,1]
    v_pk_fma_f32 v[78:79], v[78:79], v[134:135], v[170:171] op_sel:[0,0,0] op_sel_hi:[1,0,1]
    v_max_f32 v76, 0, v76
    v_max_f32 v77, 0, v77
    v_max_f32 v78, 0, v78
    v_max_f32 v79, 0, v79
    v_pk_mul_f32 v[76:77], v[76:77], v[76:77]
    v_pk_mul_f32 v[78:79], v[78:79], v[78:79]
    v_cvt_pk_bf16_f32 v222, v76, v77
    v_cvt_pk_bf16_f32 v223, v78, v79
    ds_write_b128 v7, v[220:223] offset:22528
    v_pk_fma_f32 v[164:165], v[152:153], v[134:135], v[244:245] op_sel:[0,1,0] op_sel_hi:[1,1,1]
    v_pk_fma_f32 v[166:167], v[154:155], v[134:135], v[246:247] op_sel:[0,1,0] op_sel_hi:[1,1,1]
    v_pk_fma_f32 v[92:93], v[92:93], v[134:135], v[164:165] op_sel:[0,0,0] op_sel_hi:[1,0,1]
    v_pk_fma_f32 v[94:95], v[94:95], v[134:135], v[166:167] op_sel:[0,0,0] op_sel_hi:[1,0,1]
    v_max_f32 v92, 0, v92
    v_max_f32 v93, 0, v93
    v_max_f32 v94, 0, v94
    v_max_f32 v95, 0, v95
    v_pk_mul_f32 v[92:93], v[92:93], v[92:93]
    v_pk_mul_f32 v[94:95], v[94:95], v[94:95]
    v_cvt_pk_bf16_f32 v224, v92, v93
    v_cvt_pk_bf16_f32 v225, v94, v95
    v_pk_fma_f32 v[168:169], v[156:157], v[134:135], v[248:249] op_sel:[0,1,0] op_sel_hi:[1,1,1]
    v_pk_fma_f32 v[170:171], v[158:159], v[134:135], v[250:251] op_sel:[0,1,0] op_sel_hi:[1,1,1]
    v_pk_fma_f32 v[108:109], v[108:109], v[134:135], v[168:169] op_sel:[0,0,0] op_sel_hi:[1,0,1]
    v_pk_fma_f32 v[110:111], v[110:111], v[134:135], v[170:171] op_sel:[0,0,0] op_sel_hi:[1,0,1]
    v_max_f32 v108, 0, v108
    v_max_f32 v109, 0, v109
    v_max_f32 v110, 0, v110
    v_max_f32 v111, 0, v111
    v_pk_mul_f32 v[108:109], v[108:109], v[108:109]
    v_pk_mul_f32 v[110:111], v[110:111], v[110:111]
    v_cvt_pk_bf16_f32 v226, v108, v109
    v_cvt_pk_bf16_f32 v227, v110, v111
    ds_write_b128 v7, v[224:227] offset:23552
    v_pk_fma_f32 v[164:165], v[160:161], v[134:135], v[252:253] op_sel:[0,1,0] op_sel_hi:[1,1,1]
    v_pk_fma_f32 v[166:167], v[162:163], v[134:135], v[254:255] op_sel:[0,1,0] op_sel_hi:[1,1,1]
    v_pk_fma_f32 v[124:125], v[124:125], v[134:135], v[164:165] op_sel:[0,0,0] op_sel_hi:[1,0,1]
    v_pk_fma_f32 v[126:127], v[126:127], v[134:135], v[166:167] op_sel:[0,0,0] op_sel_hi:[1,0,1]
    v_max_f32 v124, 0, v124
    v_max_f32 v125, 0, v125
    v_max_f32 v126, 0, v126
    v_max_f32 v127, 0, v127
    v_pk_mul_f32 v[124:125], v[124:125], v[124:125]
    v_pk_mul_f32 v[126:127], v[126:127], v[126:127]
    v_cvt_pk_bf16_f32 v216, v124, v125
    v_cvt_pk_bf16_f32 v217, v126, v127
    ds_write_b64 v6, v[216:217] offset:21504
    s_waitcnt lgkmcnt(0)
    s_barrier
    ds_read_b128 v[80:83], v12 offset:0
    ds_read_b128 v[84:87], v12 offset:7168
    ds_read_b128 v[88:91], v12 offset:1024
    ds_read_b128 v[92:95], v12 offset:8192
    ds_read_b128 v[96:99], v12 offset:2048
    ds_read_b128 v[100:103], v12 offset:9216
    ds_read_b128 v[104:107], v12 offset:3072
    ds_read_b128 v[108:111], v12 offset:10240
    ds_read_b128 v[112:115], v12 offset:4096
    ds_read_b128 v[116:119], v12 offset:11264
    ds_read_b128 v[120:123], v12 offset:5120
    ds_read_b128 v[124:127], v12 offset:12288
    ds_read_b128 v[128:131], v12 offset:6144
    ds_read_b128 v[132:135], v12 offset:13312
    s_bfe_u32 s34, s2, 0x10002
    s_lshr_b32 s3, s2, 5
    s_xor_b32 s16, s3, 0
    s_mov_b32 s33, 0
sequential_preLN__ssm_conv_h3__dense_activation_squared_relu__prompt_kernel_g_idc:
    s_waitcnt vmcnt(0)
    v_cmp_eq_u32_e64 vcc, -1, v15
    s_cmp_gt_u32 s33, 0x20000
    s_cbranch_scc1 sequential_preLN__ssm_conv_h3__dense_activation_squared_relu__prompt_kernel_g_idok
    s_cbranch_vccz sequential_preLN__ssm_conv_h3__dense_activation_squared_relu__prompt_kernel_g_idok
    buffer_load_dword v15, v14, s[48:51], 0 offen sc1
    s_add_u32 s33, s33, 1
    s_branch sequential_preLN__ssm_conv_h3__dense_activation_squared_relu__prompt_kernel_g_idc
sequential_preLN__ssm_conv_h3__dense_activation_squared_relu__prompt_kernel_g_idok:
    v_cmp_eq_u32_e64 vcc, s60, v15
    s_and_b32 s63, vcc_lo, 0xff
    s_cmp_eq_u32 s63, 0xff
    s_cselect_b32 s63, 1, 0
    s_nop 0
    s_bfe_u32 s59, vcc_lo, 0x10008
    s_load_dwordx4 s[4:7], s[0:1], 80
    s_add_u32 s62, s61, 41943072
    s_load_dword s30, s[12:13], s62
    s_and_b32 s62, s2, 31
    v_and_b32 v14, 7, v1
    v_lshlrev_b32 v14, 5, v14
    v_add_u32 v14, s62, v14
    v_lshlrev_b32 v14, 2, v14
    v_add_u32 v14, s14, v14
    v_lshlrev_b32_e64 v14, 7, v14
    v_add_u32 v14, 8388704, v14
    s_lshl_b32 s17, s15, 3
    s_lshl_b32 s18, s14, 1
    s_add_u32 s17, s17, s18
    s_nop 0
    s_mul_i32 s17, s17, 114688
    s_mul_i32 s18, s34, 57344
    s_add_u32 s17, s17, s18
    s_add_u32 s17, s17, 0
    v_add_u32 v6, 114688, v5
    s_mov_b32 s28, 0
    s_add_u32 s20, s12, s17
    s_addc_u32 s21, s13, 0
    s_nop 0
    s_mov_b32 s22, 172032
    s_mov_b32 s23, 0x20000
    v_lshrrev_b32 v8, 2, v1
    v_lshlrev_b32 v9, 7, v8
    v_and_b32_e64 v8, 6, v8
    v_lshl_add_u32 v9, v8, 4, v9
    v_and_b32_e64 v8, 3, v1
    v_lshl_add_u32 v208, v8, 3, v9
    s_mov_b32 s31, 0x10000
    v_xor_b32 v209, 32, v208
    v_xor_b32 v210, 64, v208
    v_xor_b32 v211, 96, v208
    s_mul_i32 s17, s14, 14336
    s_add_u32 s17, s17, 65536
    v_add_u32_e64 v8, s17, v5
    s_add_u32 s28, s3, 1
    s_and_b32 s28, s28, 7
    s_mul_i32 s28, s28, 7168
    s_waitcnt lgkmcnt(0)
    s_waitcnt lgkmcnt(0)
    s_barrier
    s_nop 0
    ds_read_b64_tr_b16 v[144:145], v208 offset:0
    ds_read_b64_tr_b16 v[146:147], v208 offset:2048
    ds_read_b64_tr_b16 v[148:149], v209 offset:0
    ds_read_b64_tr_b16 v[150:151], v209 offset:2048
    ds_read_b64_tr_b16 v[152:153], v210 offset:0
    ds_read_b64_tr_b16 v[154:155], v210 offset:2048
    ds_read_b64_tr_b16 v[156:157], v211 offset:0
    ds_read_b64_tr_b16 v[158:159], v211 offset:2048
    ds_read_b64_tr_b16 v[160:161], v208 offset:4096
    ds_read_b64_tr_b16 v[162:163], v208 offset:6144
    ds_read_b64_tr_b16 v[164:165], v209 offset:4096
    ds_read_b64_tr_b16 v[166:167], v209 offset:6144
    ds_read_b64_tr_b16 v[168:169], v210 offset:4096
    ds_read_b64_tr_b16 v[170:171], v210 offset:6144
    ds_read_b64_tr_b16 v[172:173], v211 offset:4096
    ds_read_b64_tr_b16 v[174:175], v211 offset:6144
    s_mul_i32 s36, s3, 7168
    s_add_u32 s37, s36, 4096
    s_cmp_eq_u32 s63, 0
    s_cbranch_scc1 sequential_preLN__ssm_conv_h3__dense_activation_squared_relu__prompt_kernel_g_rfar
    s_waitcnt lgkmcnt(0)
    s_nop 0
    v_mfma_f32_16x16x32_bf16 v[16:19], v[144:147], v[80:83], 0
    ds_read_b64_tr_b16 v[176:177], v208 offset:8192
    ds_read_b64_tr_b16 v[178:179], v208 offset:10240
    v_mfma_f32_16x16x32_bf16 v[20:23], v[144:147], v[84:87], 0
    ds_read_b64_tr_b16 v[180:181], v209 offset:8192
    buffer_store_dwordx4 v[80:83], v5, s[20:23], s36 offen offset:0
    v_mfma_f32_16x16x32_bf16 v[24:27], v[148:151], v[80:83], 0
    ds_read_b64_tr_b16 v[182:183], v209 offset:10240
    v_mfma_f32_16x16x32_bf16 v[28:31], v[148:151], v[84:87], 0
    ds_read_b64_tr_b16 v[184:185], v210 offset:8192
    buffer_store_dwordx4 v[84:87], v6, s[20:23], s36 offen offset:0
    v_mfma_f32_16x16x32_bf16 v[32:35], v[152:155], v[80:83], 0
    ds_read_b64_tr_b16 v[186:187], v210 offset:10240
    v_mfma_f32_16x16x32_bf16 v[36:39], v[152:155], v[84:87], 0
    ds_read_b64_tr_b16 v[188:189], v211 offset:8192
    buffer_store_dwordx4 v[88:91], v5, s[20:23], s36 offen offset:1024
    v_mfma_f32_16x16x32_bf16 v[40:43], v[156:159], v[80:83], 0
    ds_read_b64_tr_b16 v[190:191], v211 offset:10240
    v_mfma_f32_16x16x32_bf16 v[44:47], v[156:159], v[84:87], 0
    ds_read_b64_tr_b16 v[192:193], v208 offset:12288
    ds_read_b64_tr_b16 v[194:195], v208 offset:14336
    buffer_store_dwordx4 v[92:95], v6, s[20:23], s36 offen offset:1024
    v_mfma_f32_16x16x32_bf16 v[48:51], v[160:163], v[80:83], 0
    ds_read_b64_tr_b16 v[196:197], v209 offset:12288
    v_mfma_f32_16x16x32_bf16 v[52:55], v[160:163], v[84:87], 0
    ds_read_b64_tr_b16 v[198:199], v209 offset:14336
    buffer_store_dwordx4 v[96:99], v5, s[20:23], s36 offen offset:2048
    v_mfma_f32_16x16x32_bf16 v[56:59], v[164:167], v[80:83], 0
    ds_read_b64_tr_b16 v[200:201], v210 offset:12288
    v_mfma_f32_16x16x32_bf16 v[60:63], v[164:167], v[84:87], 0
    ds_read_b64_tr_b16 v[202:203], v210 offset:14336
    buffer_store_dwordx4 v[100:103], v6, s[20:23], s36 offen offset:2048
    v_mfma_f32_16x16x32_bf16 v[64:67], v[168:171], v[80:83], 0
    ds_read_b64_tr_b16 v[204:205], v211 offset:12288
    v_mfma_f32_16x16x32_bf16 v[68:71], v[168:171], v[84:87], 0
    ds_read_b64_tr_b16 v[206:207], v211 offset:14336
    buffer_store_dwordx4 v[104:107], v5, s[20:23], s36 offen offset:3072
    v_mfma_f32_16x16x32_bf16 v[72:75], v[172:175], v[80:83], 0
    v_mfma_f32_16x16x32_bf16 v[76:79], v[172:175], v[84:87], 0
    s_waitcnt lgkmcnt(0)
    s_nop 0
    v_mfma_f32_16x16x32_bf16 v[16:19], v[176:179], v[88:91], v[16:19]
    ds_read_b64_tr_b16 v[144:145], v208 offset:16384
    ds_read_b64_tr_b16 v[146:147], v208 offset:18432
    v_mfma_f32_16x16x32_bf16 v[20:23], v[176:179], v[92:95], v[20:23]
    ds_read_b64_tr_b16 v[148:149], v209 offset:16384
    buffer_store_dwordx4 v[108:111], v6, s[20:23], s36 offen offset:3072
    v_mfma_f32_16x16x32_bf16 v[24:27], v[180:183], v[88:91], v[24:27]
    ds_read_b64_tr_b16 v[150:151], v209 offset:18432
    v_mfma_f32_16x16x32_bf16 v[28:31], v[180:183], v[92:95], v[28:31]
    ds_read_b64_tr_b16 v[152:153], v210 offset:16384
    buffer_store_dwordx4 v[112:115], v5, s[20:23], s37 offen offset:0
    v_mfma_f32_16x16x32_bf16 v[32:35], v[184:187], v[88:91], v[32:35]
    ds_read_b64_tr_b16 v[154:155], v210 offset:18432
    v_mfma_f32_16x16x32_bf16 v[36:39], v[184:187], v[92:95], v[36:39]
    ds_read_b64_tr_b16 v[156:157], v211 offset:16384
    buffer_store_dwordx4 v[116:119], v6, s[20:23], s37 offen offset:0
    v_mfma_f32_16x16x32_bf16 v[40:43], v[188:191], v[88:91], v[40:43]
    ds_read_b64_tr_b16 v[158:159], v211 offset:18432
    v_mfma_f32_16x16x32_bf16 v[44:47], v[188:191], v[92:95], v[44:47]
    ds_read_b64_tr_b16 v[160:161], v208 offset:20480
    ds_read_b64_tr_b16 v[162:163], v208 offset:22528
    buffer_store_dwordx4 v[120:123], v5, s[20:23], s37 offen offset:1024
    v_mfma_f32_16x16x32_bf16 v[48:51], v[192:195], v[88:91], v[48:51]
    ds_read_b64_tr_b16 v[164:165], v209 offset:20480
    v_mfma_f32_16x16x32_bf16 v[52:55], v[192:195], v[92:95], v[52:55]
    ds_read_b64_tr_b16 v[166:167], v209 offset:22528
    buffer_store_dwordx4 v[124:127], v6, s[20:23], s37 offen offset:1024
    v_mfma_f32_16x16x32_bf16 v[56:59], v[196:199], v[88:91], v[56:59]
    ds_read_b64_tr_b16 v[168:169], v210 offset:20480
    v_mfma_f32_16x16x32_bf16 v[60:63], v[196:199], v[92:95], v[60:63]
    ds_read_b64_tr_b16 v[170:171], v210 offset:22528
    buffer_store_dwordx4 v[128:131], v5, s[20:23], s37 offen offset:2048
    v_mfma_f32_16x16x32_bf16 v[64:67], v[200:203], v[88:91], v[64:67]
    ds_read_b64_tr_b16 v[172:173], v211 offset:20480
    v_mfma_f32_16x16x32_bf16 v[68:71], v[200:203], v[92:95], v[68:71]
    ds_read_b64_tr_b16 v[174:175], v211 offset:22528
    buffer_store_dwordx4 v[132:135], v6, s[20:23], s37 offen offset:2048
    v_mfma_f32_16x16x32_bf16 v[72:75], v[204:207], v[88:91], v[72:75]
    v_mfma_f32_16x16x32_bf16 v[76:79], v[204:207], v[92:95], v[76:79]
    s_branch sequential_preLN__ssm_conv_h3__dense_activation_squared_relu__prompt_kernel_g_rx
sequential_preLN__ssm_conv_h3__dense_activation_squared_relu__prompt_kernel_g_rfar:
    s_waitcnt lgkmcnt(0)
    v_mfma_f32_16x16x32_bf16 v[16:19], v[144:147], v[80:83], 0
    ds_read_b64_tr_b16 v[176:177], v208 offset:8192
    ds_read_b64_tr_b16 v[178:179], v208 offset:10240
    v_mfma_f32_16x16x32_bf16 v[20:23], v[144:147], v[84:87], 0
    ds_read_b64_tr_b16 v[180:181], v209 offset:8192
    buffer_store_dwordx4 v[80:83], v5, s[20:23], s36 offen offset:0 sc1
    v_mfma_f32_16x16x32_bf16 v[24:27], v[148:151], v[80:83], 0
    ds_read_b64_tr_b16 v[182:183], v209 offset:10240
    v_mfma_f32_16x16x32_bf16 v[28:31], v[148:151], v[84:87], 0
    ds_read_b64_tr_b16 v[184:185], v210 offset:8192
    buffer_store_dwordx4 v[84:87], v6, s[20:23], s36 offen offset:0 sc1
    v_mfma_f32_16x16x32_bf16 v[32:35], v[152:155], v[80:83], 0
    ds_read_b64_tr_b16 v[186:187], v210 offset:10240
    v_mfma_f32_16x16x32_bf16 v[36:39], v[152:155], v[84:87], 0
    ds_read_b64_tr_b16 v[188:189], v211 offset:8192
    buffer_store_dwordx4 v[88:91], v5, s[20:23], s36 offen offset:1024 sc1
    v_mfma_f32_16x16x32_bf16 v[40:43], v[156:159], v[80:83], 0
    ds_read_b64_tr_b16 v[190:191], v211 offset:10240
    v_mfma_f32_16x16x32_bf16 v[44:47], v[156:159], v[84:87], 0
    ds_read_b64_tr_b16 v[192:193], v208 offset:12288
    ds_read_b64_tr_b16 v[194:195], v208 offset:14336
    buffer_store_dwordx4 v[92:95], v6, s[20:23], s36 offen offset:1024 sc1
    v_mfma_f32_16x16x32_bf16 v[48:51], v[160:163], v[80:83], 0
    ds_read_b64_tr_b16 v[196:197], v209 offset:12288
    v_mfma_f32_16x16x32_bf16 v[52:55], v[160:163], v[84:87], 0
    ds_read_b64_tr_b16 v[198:199], v209 offset:14336
    buffer_store_dwordx4 v[96:99], v5, s[20:23], s36 offen offset:2048 sc1
    v_mfma_f32_16x16x32_bf16 v[56:59], v[164:167], v[80:83], 0
    ds_read_b64_tr_b16 v[200:201], v210 offset:12288
    v_mfma_f32_16x16x32_bf16 v[60:63], v[164:167], v[84:87], 0
    ds_read_b64_tr_b16 v[202:203], v210 offset:14336
    buffer_store_dwordx4 v[100:103], v6, s[20:23], s36 offen offset:2048 sc1
    v_mfma_f32_16x16x32_bf16 v[64:67], v[168:171], v[80:83], 0
    ds_read_b64_tr_b16 v[204:205], v211 offset:12288
    v_mfma_f32_16x16x32_bf16 v[68:71], v[168:171], v[84:87], 0
    ds_read_b64_tr_b16 v[206:207], v211 offset:14336
    buffer_store_dwordx4 v[104:107], v5, s[20:23], s36 offen offset:3072 sc1
    v_mfma_f32_16x16x32_bf16 v[72:75], v[172:175], v[80:83], 0
    v_mfma_f32_16x16x32_bf16 v[76:79], v[172:175], v[84:87], 0
    s_waitcnt lgkmcnt(0)
    s_nop 0
    v_mfma_f32_16x16x32_bf16 v[16:19], v[176:179], v[88:91], v[16:19]
    ds_read_b64_tr_b16 v[144:145], v208 offset:16384
    ds_read_b64_tr_b16 v[146:147], v208 offset:18432
    v_mfma_f32_16x16x32_bf16 v[20:23], v[176:179], v[92:95], v[20:23]
    ds_read_b64_tr_b16 v[148:149], v209 offset:16384
    buffer_store_dwordx4 v[108:111], v6, s[20:23], s36 offen offset:3072 sc1
    v_mfma_f32_16x16x32_bf16 v[24:27], v[180:183], v[88:91], v[24:27]
    ds_read_b64_tr_b16 v[150:151], v209 offset:18432
    v_mfma_f32_16x16x32_bf16 v[28:31], v[180:183], v[92:95], v[28:31]
    ds_read_b64_tr_b16 v[152:153], v210 offset:16384
    buffer_store_dwordx4 v[112:115], v5, s[20:23], s37 offen offset:0 sc1
    v_mfma_f32_16x16x32_bf16 v[32:35], v[184:187], v[88:91], v[32:35]
    ds_read_b64_tr_b16 v[154:155], v210 offset:18432
    v_mfma_f32_16x16x32_bf16 v[36:39], v[184:187], v[92:95], v[36:39]
    ds_read_b64_tr_b16 v[156:157], v211 offset:16384
    buffer_store_dwordx4 v[116:119], v6, s[20:23], s37 offen offset:0 sc1
    v_mfma_f32_16x16x32_bf16 v[40:43], v[188:191], v[88:91], v[40:43]
    ds_read_b64_tr_b16 v[158:159], v211 offset:18432
    v_mfma_f32_16x16x32_bf16 v[44:47], v[188:191], v[92:95], v[44:47]
    ds_read_b64_tr_b16 v[160:161], v208 offset:20480
    ds_read_b64_tr_b16 v[162:163], v208 offset:22528
    buffer_store_dwordx4 v[120:123], v5, s[20:23], s37 offen offset:1024 sc1
    v_mfma_f32_16x16x32_bf16 v[48:51], v[192:195], v[88:91], v[48:51]
    ds_read_b64_tr_b16 v[164:165], v209 offset:20480
    v_mfma_f32_16x16x32_bf16 v[52:55], v[192:195], v[92:95], v[52:55]
    ds_read_b64_tr_b16 v[166:167], v209 offset:22528
    buffer_store_dwordx4 v[124:127], v6, s[20:23], s37 offen offset:1024 sc1
    v_mfma_f32_16x16x32_bf16 v[56:59], v[196:199], v[88:91], v[56:59]
    ds_read_b64_tr_b16 v[168:169], v210 offset:20480
    v_mfma_f32_16x16x32_bf16 v[60:63], v[196:199], v[92:95], v[60:63]
    ds_read_b64_tr_b16 v[170:171], v210 offset:22528
    buffer_store_dwordx4 v[128:131], v5, s[20:23], s37 offen offset:2048 sc1
    v_mfma_f32_16x16x32_bf16 v[64:67], v[200:203], v[88:91], v[64:67]
    ds_read_b64_tr_b16 v[172:173], v211 offset:20480
    v_mfma_f32_16x16x32_bf16 v[68:71], v[200:203], v[92:95], v[68:71]
    ds_read_b64_tr_b16 v[174:175], v211 offset:22528
    buffer_store_dwordx4 v[132:135], v6, s[20:23], s37 offen offset:2048 sc1
    v_mfma_f32_16x16x32_bf16 v[72:75], v[204:207], v[88:91], v[72:75]
    v_mfma_f32_16x16x32_bf16 v[76:79], v[204:207], v[92:95], v[76:79]
sequential_preLN__ssm_conv_h3__dense_activation_squared_relu__prompt_kernel_g_rx:
    s_waitcnt lgkmcnt(0)
    s_nop 0
    v_mfma_f32_16x16x32_bf16 v[16:19], v[144:147], v[96:99], v[16:19]
    ds_read_b64_tr_b16 v[176:177], v208 offset:24576
    ds_read_b64_tr_b16 v[178:179], v208 offset:26624
    v_mfma_f32_16x16x32_bf16 v[20:23], v[144:147], v[100:103], v[20:23]
    ds_read_b64_tr_b16 v[180:181], v209 offset:24576
    v_mfma_f32_16x16x32_bf16 v[24:27], v[148:151], v[96:99], v[24:27]
    ds_read_b64_tr_b16 v[182:183], v209 offset:26624
    v_mfma_f32_16x16x32_bf16 v[28:31], v[148:151], v[100:103], v[28:31]
    ds_read_b64_tr_b16 v[184:185], v210 offset:24576
    v_mfma_f32_16x16x32_bf16 v[32:35], v[152:155], v[96:99], v[32:35]
    ds_read_b64_tr_b16 v[186:187], v210 offset:26624
    v_mfma_f32_16x16x32_bf16 v[36:39], v[152:155], v[100:103], v[36:39]
    ds_read_b64_tr_b16 v[188:189], v211 offset:24576
    v_mfma_f32_16x16x32_bf16 v[40:43], v[156:159], v[96:99], v[40:43]
    ds_read_b64_tr_b16 v[190:191], v211 offset:26624
    v_mfma_f32_16x16x32_bf16 v[44:47], v[156:159], v[100:103], v[44:47]
    ds_read_b64_tr_b16 v[192:193], v208 offset:28672
    ds_read_b64_tr_b16 v[194:195], v208 offset:30720
    v_mfma_f32_16x16x32_bf16 v[48:51], v[160:163], v[96:99], v[48:51]
    ds_read_b64_tr_b16 v[196:197], v209 offset:28672
    v_mfma_f32_16x16x32_bf16 v[52:55], v[160:163], v[100:103], v[52:55]
    ds_read_b64_tr_b16 v[198:199], v209 offset:30720
    v_mfma_f32_16x16x32_bf16 v[56:59], v[164:167], v[96:99], v[56:59]
    ds_read_b64_tr_b16 v[200:201], v210 offset:28672
    v_mfma_f32_16x16x32_bf16 v[60:63], v[164:167], v[100:103], v[60:63]
    ds_read_b64_tr_b16 v[202:203], v210 offset:30720
    v_mfma_f32_16x16x32_bf16 v[64:67], v[168:171], v[96:99], v[64:67]
    ds_read_b64_tr_b16 v[204:205], v211 offset:28672
    v_mfma_f32_16x16x32_bf16 v[68:71], v[168:171], v[100:103], v[68:71]
    ds_read_b64_tr_b16 v[206:207], v211 offset:30720
    v_mfma_f32_16x16x32_bf16 v[72:75], v[172:175], v[96:99], v[72:75]
    v_mfma_f32_16x16x32_bf16 v[76:79], v[172:175], v[100:103], v[76:79]
    v_mov_b32_e64 v9, 1
    s_mov_b64 exec, 1
    s_cmp_eq_u32 s63, 0
    s_waitcnt vmcnt(0)
    s_cbranch_scc1 sequential_preLN__ssm_conv_h3__dense_activation_squared_relu__prompt_kernel_g_ffar
    buffer_store_dword v9, v13, s[48:51], s61 offen offset:96
    s_branch sequential_preLN__ssm_conv_h3__dense_activation_squared_relu__prompt_kernel_g_fx
sequential_preLN__ssm_conv_h3__dense_activation_squared_relu__prompt_kernel_g_ffar:
    s_nop 0
    buffer_store_dword v9, v13, s[48:51], s61 offen offset:96 sc1
sequential_preLN__ssm_conv_h3__dense_activation_squared_relu__prompt_kernel_g_fx:
    s_mov_b64 exec, -1
    s_waitcnt lgkmcnt(0)
    s_barrier
    s_nop 0
    v_mfma_f32_16x16x32_bf16 v[16:19], v[176:179], v[104:107], v[16:19]
    ds_read_b64_tr_b16 v[144:145], v208 offset:32768
    ds_read_b64_tr_b16 v[146:147], v208 offset:34816
    v_mfma_f32_16x16x32_bf16 v[20:23], v[176:179], v[108:111], v[20:23]
    ds_read_b64_tr_b16 v[148:149], v209 offset:32768
    v_mfma_f32_16x16x32_bf16 v[24:27], v[180:183], v[104:107], v[24:27]
    ds_read_b64_tr_b16 v[150:151], v209 offset:34816
    v_mfma_f32_16x16x32_bf16 v[28:31], v[180:183], v[108:111], v[28:31]
    ds_read_b64_tr_b16 v[152:153], v210 offset:32768
    v_mfma_f32_16x16x32_bf16 v[32:35], v[184:187], v[104:107], v[32:35]
    ds_read_b64_tr_b16 v[154:155], v210 offset:34816
    v_mfma_f32_16x16x32_bf16 v[36:39], v[184:187], v[108:111], v[36:39]
    ds_read_b64_tr_b16 v[156:157], v211 offset:32768
    v_mfma_f32_16x16x32_bf16 v[40:43], v[188:191], v[104:107], v[40:43]
    ds_read_b64_tr_b16 v[158:159], v211 offset:34816
    v_mfma_f32_16x16x32_bf16 v[44:47], v[188:191], v[108:111], v[44:47]
    ds_read_b64_tr_b16 v[160:161], v208 offset:36864
    ds_read_b64_tr_b16 v[162:163], v208 offset:38912
    v_mfma_f32_16x16x32_bf16 v[48:51], v[192:195], v[104:107], v[48:51]
    ds_read_b64_tr_b16 v[164:165], v209 offset:36864
    v_mfma_f32_16x16x32_bf16 v[52:55], v[192:195], v[108:111], v[52:55]
    ds_read_b64_tr_b16 v[166:167], v209 offset:38912
    v_mfma_f32_16x16x32_bf16 v[56:59], v[196:199], v[104:107], v[56:59]
    ds_read_b64_tr_b16 v[168:169], v210 offset:36864
    v_mfma_f32_16x16x32_bf16 v[60:63], v[196:199], v[108:111], v[60:63]
    ds_read_b64_tr_b16 v[170:171], v210 offset:38912
    v_mfma_f32_16x16x32_bf16 v[64:67], v[200:203], v[104:107], v[64:67]
    ds_read_b64_tr_b16 v[172:173], v211 offset:36864
    v_mfma_f32_16x16x32_bf16 v[68:71], v[200:203], v[108:111], v[68:71]
    ds_read_b64_tr_b16 v[174:175], v211 offset:38912
    v_mfma_f32_16x16x32_bf16 v[72:75], v[204:207], v[104:107], v[72:75]
    v_mfma_f32_16x16x32_bf16 v[76:79], v[204:207], v[108:111], v[76:79]
    buffer_load_dword v15, v14, s[48:51], 0 offen sc1
    s_waitcnt lgkmcnt(0)
    s_nop 0
    v_mfma_f32_16x16x32_bf16 v[16:19], v[144:147], v[112:115], v[16:19]
    ds_read_b64_tr_b16 v[176:177], v208 offset:40960
    ds_read_b64_tr_b16 v[178:179], v208 offset:43008
    v_mfma_f32_16x16x32_bf16 v[20:23], v[144:147], v[116:119], v[20:23]
    ds_read_b64_tr_b16 v[180:181], v209 offset:40960
    v_mfma_f32_16x16x32_bf16 v[24:27], v[148:151], v[112:115], v[24:27]
    ds_read_b64_tr_b16 v[182:183], v209 offset:43008
    v_mfma_f32_16x16x32_bf16 v[28:31], v[148:151], v[116:119], v[28:31]
    ds_read_b64_tr_b16 v[184:185], v210 offset:40960
    v_mfma_f32_16x16x32_bf16 v[32:35], v[152:155], v[112:115], v[32:35]
    ds_read_b64_tr_b16 v[186:187], v210 offset:43008
    v_mfma_f32_16x16x32_bf16 v[36:39], v[152:155], v[116:119], v[36:39]
    ds_read_b64_tr_b16 v[188:189], v211 offset:40960
    v_mfma_f32_16x16x32_bf16 v[40:43], v[156:159], v[112:115], v[40:43]
    ds_read_b64_tr_b16 v[190:191], v211 offset:43008
    v_mfma_f32_16x16x32_bf16 v[44:47], v[156:159], v[116:119], v[44:47]
    ds_read_b64_tr_b16 v[192:193], v208 offset:45056
    ds_read_b64_tr_b16 v[194:195], v208 offset:47104
    v_mfma_f32_16x16x32_bf16 v[48:51], v[160:163], v[112:115], v[48:51]
    ds_read_b64_tr_b16 v[196:197], v209 offset:45056
    v_mfma_f32_16x16x32_bf16 v[52:55], v[160:163], v[116:119], v[52:55]
    ds_read_b64_tr_b16 v[198:199], v209 offset:47104
    v_mfma_f32_16x16x32_bf16 v[56:59], v[164:167], v[112:115], v[56:59]
    ds_read_b64_tr_b16 v[200:201], v210 offset:45056
    v_mfma_f32_16x16x32_bf16 v[60:63], v[164:167], v[116:119], v[60:63]
    ds_read_b64_tr_b16 v[202:203], v210 offset:47104
    v_mfma_f32_16x16x32_bf16 v[64:67], v[168:171], v[112:115], v[64:67]
    ds_read_b64_tr_b16 v[204:205], v211 offset:45056
    v_mfma_f32_16x16x32_bf16 v[68:71], v[168:171], v[116:119], v[68:71]
    ds_read_b64_tr_b16 v[206:207], v211 offset:47104
    v_mfma_f32_16x16x32_bf16 v[72:75], v[172:175], v[112:115], v[72:75]
    v_mfma_f32_16x16x32_bf16 v[76:79], v[172:175], v[116:119], v[76:79]
    s_mov_b32 s33, 0
sequential_preLN__ssm_conv_h3__dense_activation_squared_relu__prompt_kernel_g_hc:
    s_waitcnt vmcnt(0)
    v_cmp_eq_u32_e64 vcc, -1, v15
    s_cmp_gt_u32 s33, 0x20000
    s_cbranch_scc1 sequential_preLN__ssm_conv_h3__dense_activation_squared_relu__prompt_kernel_g_hok
    s_cbranch_vccz sequential_preLN__ssm_conv_h3__dense_activation_squared_relu__prompt_kernel_g_hok
    buffer_load_dword v15, v14, s[48:51], 0 offen sc1
    s_add_u32 s33, s33, 1
    s_branch sequential_preLN__ssm_conv_h3__dense_activation_squared_relu__prompt_kernel_g_hc
sequential_preLN__ssm_conv_h3__dense_activation_squared_relu__prompt_kernel_g_hok:
    buffer_load_dwordx4 v[136:139], v5, s[20:23], s28 offen sc1
    buffer_load_dwordx4 v[140:143], v6, s[20:23], s28 offen sc1
    s_add_u32 s28, s28, 1024
    s_cmp_eq_u32 s28, 57344
    s_cselect_b32 s28, 0, s28
    s_nop 0
    buffer_load_dwordx4 v[80:83], v5, s[20:23], s28 offen sc1
    buffer_load_dwordx4 v[84:87], v6, s[20:23], s28 offen sc1
    s_add_u32 s28, s28, 1024
    s_cmp_eq_u32 s28, 57344
    s_cselect_b32 s28, 0, s28
    s_nop 0
    buffer_load_dwordx4 v[88:91], v5, s[20:23], s28 offen sc1
    buffer_load_dwordx4 v[92:95], v6, s[20:23], s28 offen sc1
    s_add_u32 s28, s28, 1024
    s_cmp_eq_u32 s28, 57344
    s_cselect_b32 s28, 0, s28
    s_nop 0
    buffer_load_dwordx4 v[96:99], v5, s[20:23], s28 offen sc1
    buffer_load_dwordx4 v[100:103], v6, s[20:23], s28 offen sc1
    s_add_u32 s28, s28, 1024
    s_cmp_eq_u32 s28, 57344
    s_cselect_b32 s28, 0, s28
    s_nop 0
    buffer_load_dwordx4 v[104:107], v5, s[20:23], s28 offen sc1
    buffer_load_dwordx4 v[108:111], v6, s[20:23], s28 offen sc1
    s_add_u32 s28, s28, 1024
    s_cmp_eq_u32 s28, 57344
    s_cselect_b32 s28, 0, s28
    s_nop 0
    buffer_load_dwordx4 v[112:115], v5, s[20:23], s28 offen sc1
    buffer_load_dwordx4 v[116:119], v6, s[20:23], s28 offen sc1
    s_add_u32 s28, s28, 1024
    s_cmp_eq_u32 s28, 57344
    s_cselect_b32 s28, 0, s28
    s_waitcnt lgkmcnt(0)
    v_mfma_f32_16x16x32_bf16 v[16:19], v[176:179], v[120:123], v[16:19]
    ds_read_b64_tr_b16 v[144:145], v208 offset:49152
    ds_read_b64_tr_b16 v[146:147], v208 offset:51200
    v_mfma_f32_16x16x32_bf16 v[20:23], v[176:179], v[124:127], v[20:23]
    ds_read_b64_tr_b16 v[148:149], v209 offset:49152
    v_mfma_f32_16x16x32_bf16 v[24:27], v[180:183], v[120:123], v[24:27]
    ds_read_b64_tr_b16 v[150:151], v209 offset:51200
    v_mfma_f32_16x16x32_bf16 v[28:31], v[180:183], v[124:127], v[28:31]
    ds_read_b64_tr_b16 v[152:153], v210 offset:49152
    v_mfma_f32_16x16x32_bf16 v[32:35], v[184:187], v[120:123], v[32:35]
    ds_read_b64_tr_b16 v[154:155], v210 offset:51200
    v_mfma_f32_16x16x32_bf16 v[36:39], v[184:187], v[124:127], v[36:39]
    ds_read_b64_tr_b16 v[156:157], v211 offset:49152
    v_mfma_f32_16x16x32_bf16 v[40:43], v[188:191], v[120:123], v[40:43]
    ds_read_b64_tr_b16 v[158:159], v211 offset:51200
    v_mfma_f32_16x16x32_bf16 v[44:47], v[188:191], v[124:127], v[44:47]
    ds_read_b64_tr_b16 v[160:161], v208 offset:53248
    ds_read_b64_tr_b16 v[162:163], v208 offset:55296
    v_mfma_f32_16x16x32_bf16 v[48:51], v[192:195], v[120:123], v[48:51]
    ds_read_b64_tr_b16 v[164:165], v209 offset:53248
    v_mfma_f32_16x16x32_bf16 v[52:55], v[192:195], v[124:127], v[52:55]
    ds_read_b64_tr_b16 v[166:167], v209 offset:55296
    v_mfma_f32_16x16x32_bf16 v[56:59], v[196:199], v[120:123], v[56:59]
    ds_read_b64_tr_b16 v[168:169], v210 offset:53248
    v_mfma_f32_16x16x32_bf16 v[60:63], v[196:199], v[124:127], v[60:63]
    ds_read_b64_tr_b16 v[170:171], v210 offset:55296
    v_mfma_f32_16x16x32_bf16 v[64:67], v[200:203], v[120:123], v[64:67]
    ds_read_b64_tr_b16 v[172:173], v211 offset:53248
    v_mfma_f32_16x16x32_bf16 v[68:71], v[200:203], v[124:127], v[68:71]
    ds_read_b64_tr_b16 v[174:175], v211 offset:55296
    v_mfma_f32_16x16x32_bf16 v[72:75], v[204:207], v[120:123], v[72:75]
    v_mfma_f32_16x16x32_bf16 v[76:79], v[204:207], v[124:127], v[76:79]
    s_waitcnt lgkmcnt(0)
    s_nop 0
    v_mfma_f32_16x16x32_bf16 v[16:19], v[144:147], v[128:131], v[16:19]
    ds_read_b64_tr_b16 v[176:177], v208 offset:57344
    ds_read_b64_tr_b16 v[178:179], v208 offset:59392
    v_mfma_f32_16x16x32_bf16 v[20:23], v[144:147], v[132:135], v[20:23]
    ds_read_b64_tr_b16 v[180:181], v209 offset:57344
    v_mfma_f32_16x16x32_bf16 v[24:27], v[148:151], v[128:131], v[24:27]
    ds_read_b64_tr_b16 v[182:183], v209 offset:59392
    v_mfma_f32_16x16x32_bf16 v[28:31], v[148:151], v[132:135], v[28:31]
    ds_read_b64_tr_b16 v[184:185], v210 offset:57344
    buffer_load_dwordx4 v[120:123], v5, s[20:23], s28 offen sc1
    v_mfma_f32_16x16x32_bf16 v[32:35], v[152:155], v[128:131], v[32:35]
    ds_read_b64_tr_b16 v[186:187], v210 offset:59392
    v_mfma_f32_16x16x32_bf16 v[36:39], v[152:155], v[132:135], v[36:39]
    ds_read_b64_tr_b16 v[188:189], v211 offset:57344
    v_mfma_f32_16x16x32_bf16 v[40:43], v[156:159], v[128:131], v[40:43]
    ds_read_b64_tr_b16 v[190:191], v211 offset:59392
    v_mfma_f32_16x16x32_bf16 v[44:47], v[156:159], v[132:135], v[44:47]
    ds_read_b64_tr_b16 v[192:193], v208 offset:61440
    ds_read_b64_tr_b16 v[194:195], v208 offset:63488
    v_mfma_f32_16x16x32_bf16 v[48:51], v[160:163], v[128:131], v[48:51]
    ds_read_b64_tr_b16 v[196:197], v209 offset:61440
    v_mfma_f32_16x16x32_bf16 v[52:55], v[160:163], v[132:135], v[52:55]
    ds_read_b64_tr_b16 v[198:199], v209 offset:63488
    buffer_load_dwordx4 v[124:127], v6, s[20:23], s28 offen sc1
    s_add_u32 s28, s28, 1024
    s_cmp_eq_u32 s28, 57344
    s_cselect_b32 s28, 0, s28
    s_nop 0
    v_mfma_f32_16x16x32_bf16 v[56:59], v[164:167], v[128:131], v[56:59]
    ds_read_b64_tr_b16 v[200:201], v210 offset:61440
    v_mfma_f32_16x16x32_bf16 v[60:63], v[164:167], v[132:135], v[60:63]
    ds_read_b64_tr_b16 v[202:203], v210 offset:63488
    v_mfma_f32_16x16x32_bf16 v[64:67], v[168:171], v[128:131], v[64:67]
    ds_read_b64_tr_b16 v[204:205], v211 offset:61440
    v_mfma_f32_16x16x32_bf16 v[68:71], v[168:171], v[132:135], v[68:71]
    ds_read_b64_tr_b16 v[206:207], v211 offset:63488
    v_mfma_f32_16x16x32_bf16 v[72:75], v[172:175], v[128:131], v[72:75]
    v_mfma_f32_16x16x32_bf16 v[76:79], v[172:175], v[132:135], v[76:79]
    s_waitcnt vmcnt(12) lgkmcnt(0)
    s_barrier
    v_xor_b32 v208, s31, v208
    v_xor_b32 v209, s31, v209
    v_xor_b32 v210, s31, v210
    v_xor_b32 v211, s31, v211
    v_mfma_f32_16x16x32_bf16 v[16:19], v[176:179], v[136:139], v[16:19]
    ds_read_b64_tr_b16 v[144:145], v208 offset:0
    ds_read_b64_tr_b16 v[146:147], v208 offset:2048
    v_mfma_f32_16x16x32_bf16 v[20:23], v[176:179], v[140:143], v[20:23]
    ds_read_b64_tr_b16 v[148:149], v209 offset:0
    v_mfma_f32_16x16x32_bf16 v[24:27], v[180:183], v[136:139], v[24:27]
    ds_read_b64_tr_b16 v[150:151], v209 offset:2048
    v_mfma_f32_16x16x32_bf16 v[28:31], v[180:183], v[140:143], v[28:31]
    ds_read_b64_tr_b16 v[152:153], v210 offset:0
    buffer_load_dwordx4 v[128:131], v5, s[20:23], s28 offen sc1
    v_mfma_f32_16x16x32_bf16 v[32:35], v[184:187], v[136:139], v[32:35]
    ds_read_b64_tr_b16 v[154:155], v210 offset:2048
    v_mfma_f32_16x16x32_bf16 v[36:39], v[184:187], v[140:143], v[36:39]
    ds_read_b64_tr_b16 v[156:157], v211 offset:0
    v_mfma_f32_16x16x32_bf16 v[40:43], v[188:191], v[136:139], v[40:43]
    ds_read_b64_tr_b16 v[158:159], v211 offset:2048
    v_mfma_f32_16x16x32_bf16 v[44:47], v[188:191], v[140:143], v[44:47]
    ds_read_b64_tr_b16 v[160:161], v208 offset:4096
    ds_read_b64_tr_b16 v[162:163], v208 offset:6144
    v_mfma_f32_16x16x32_bf16 v[48:51], v[192:195], v[136:139], v[48:51]
    ds_read_b64_tr_b16 v[164:165], v209 offset:4096
    v_mfma_f32_16x16x32_bf16 v[52:55], v[192:195], v[140:143], v[52:55]
    ds_read_b64_tr_b16 v[166:167], v209 offset:6144
    buffer_load_dwordx4 v[132:135], v6, s[20:23], s28 offen sc1
    s_add_u32 s28, s28, 1024
    s_cmp_eq_u32 s28, 57344
    s_cselect_b32 s28, 0, s28
    s_nop 0
    v_mfma_f32_16x16x32_bf16 v[56:59], v[196:199], v[136:139], v[56:59]
    ds_read_b64_tr_b16 v[168:169], v210 offset:4096
    v_mfma_f32_16x16x32_bf16 v[60:63], v[196:199], v[140:143], v[60:63]
    ds_read_b64_tr_b16 v[170:171], v210 offset:6144
    v_mfma_f32_16x16x32_bf16 v[64:67], v[200:203], v[136:139], v[64:67]
    ds_read_b64_tr_b16 v[172:173], v211 offset:4096
    v_mfma_f32_16x16x32_bf16 v[68:71], v[200:203], v[140:143], v[68:71]
    ds_read_b64_tr_b16 v[174:175], v211 offset:6144
    v_mfma_f32_16x16x32_bf16 v[72:75], v[204:207], v[136:139], v[72:75]
    v_mfma_f32_16x16x32_bf16 v[76:79], v[204:207], v[140:143], v[76:79]
    s_mov_b32 s33, 1
sequential_preLN__ssm_conv_h3__dense_activation_squared_relu__prompt_kernel_g_g2c:
    s_waitcnt vmcnt(12) lgkmcnt(0)
    v_mfma_f32_16x16x32_bf16 v[16:19], v[144:147], v[80:83], v[16:19]
    ds_read_b64_tr_b16 v[176:177], v208 offset:8192
    ds_read_b64_tr_b16 v[178:179], v208 offset:10240
    v_mfma_f32_16x16x32_bf16 v[20:23], v[144:147], v[84:87], v[20:23]
    ds_read_b64_tr_b16 v[180:181], v209 offset:8192
    v_mfma_f32_16x16x32_bf16 v[24:27], v[148:151], v[80:83], v[24:27]
    ds_read_b64_tr_b16 v[182:183], v209 offset:10240
    v_mfma_f32_16x16x32_bf16 v[28:31], v[148:151], v[84:87], v[28:31]
    ds_read_b64_tr_b16 v[184:185], v210 offset:8192
    buffer_load_dwordx4 v[136:139], v5, s[20:23], s28 offen sc1
    v_mfma_f32_16x16x32_bf16 v[32:35], v[152:155], v[80:83], v[32:35]
    ds_read_b64_tr_b16 v[186:187], v210 offset:10240
    v_mfma_f32_16x16x32_bf16 v[36:39], v[152:155], v[84:87], v[36:39]
    ds_read_b64_tr_b16 v[188:189], v211 offset:8192
    v_mfma_f32_16x16x32_bf16 v[40:43], v[156:159], v[80:83], v[40:43]
    ds_read_b64_tr_b16 v[190:191], v211 offset:10240
    v_mfma_f32_16x16x32_bf16 v[44:47], v[156:159], v[84:87], v[44:47]
    ds_read_b64_tr_b16 v[192:193], v208 offset:12288
    ds_read_b64_tr_b16 v[194:195], v208 offset:14336
    v_mfma_f32_16x16x32_bf16 v[48:51], v[160:163], v[80:83], v[48:51]
    ds_read_b64_tr_b16 v[196:197], v209 offset:12288
    v_mfma_f32_16x16x32_bf16 v[52:55], v[160:163], v[84:87], v[52:55]
    ds_read_b64_tr_b16 v[198:199], v209 offset:14336
    buffer_load_dwordx4 v[140:143], v6, s[20:23], s28 offen sc1
    s_add_u32 s28, s28, 1024
    s_cmp_eq_u32 s28, 57344
    s_cselect_b32 s28, 0, s28
    s_nop 0
    v_mfma_f32_16x16x32_bf16 v[56:59], v[164:167], v[80:83], v[56:59]
    ds_read_b64_tr_b16 v[200:201], v210 offset:12288
    v_mfma_f32_16x16x32_bf16 v[60:63], v[164:167], v[84:87], v[60:63]
    ds_read_b64_tr_b16 v[202:203], v210 offset:14336
    v_mfma_f32_16x16x32_bf16 v[64:67], v[168:171], v[80:83], v[64:67]
    ds_read_b64_tr_b16 v[204:205], v211 offset:12288
    v_mfma_f32_16x16x32_bf16 v[68:71], v[168:171], v[84:87], v[68:71]
    ds_read_b64_tr_b16 v[206:207], v211 offset:14336
    v_mfma_f32_16x16x32_bf16 v[72:75], v[172:175], v[80:83], v[72:75]
    v_mfma_f32_16x16x32_bf16 v[76:79], v[172:175], v[84:87], v[76:79]
    s_waitcnt vmcnt(12) lgkmcnt(0)
    s_nop 0
    v_mfma_f32_16x16x32_bf16 v[16:19], v[176:179], v[88:91], v[16:19]
    ds_read_b64_tr_b16 v[144:145], v208 offset:16384
    ds_read_b64_tr_b16 v[146:147], v208 offset:18432
    v_mfma_f32_16x16x32_bf16 v[20:23], v[176:179], v[92:95], v[20:23]
    ds_read_b64_tr_b16 v[148:149], v209 offset:16384
    v_mfma_f32_16x16x32_bf16 v[24:27], v[180:183], v[88:91], v[24:27]
    ds_read_b64_tr_b16 v[150:151], v209 offset:18432
    v_mfma_f32_16x16x32_bf16 v[28:31], v[180:183], v[92:95], v[28:31]
    ds_read_b64_tr_b16 v[152:153], v210 offset:16384
    buffer_load_dwordx4 v[80:83], v5, s[20:23], s28 offen sc1
    v_mfma_f32_16x16x32_bf16 v[32:35], v[184:187], v[88:91], v[32:35]
    ds_read_b64_tr_b16 v[154:155], v210 offset:18432
    v_mfma_f32_16x16x32_bf16 v[36:39], v[184:187], v[92:95], v[36:39]
    ds_read_b64_tr_b16 v[156:157], v211 offset:16384
    v_mfma_f32_16x16x32_bf16 v[40:43], v[188:191], v[88:91], v[40:43]
    ds_read_b64_tr_b16 v[158:159], v211 offset:18432
    v_mfma_f32_16x16x32_bf16 v[44:47], v[188:191], v[92:95], v[44:47]
    ds_read_b64_tr_b16 v[160:161], v208 offset:20480
    ds_read_b64_tr_b16 v[162:163], v208 offset:22528
    v_mfma_f32_16x16x32_bf16 v[48:51], v[192:195], v[88:91], v[48:51]
    ds_read_b64_tr_b16 v[164:165], v209 offset:20480
    v_mfma_f32_16x16x32_bf16 v[52:55], v[192:195], v[92:95], v[52:55]
    ds_read_b64_tr_b16 v[166:167], v209 offset:22528
    buffer_load_dwordx4 v[84:87], v6, s[20:23], s28 offen sc1
    s_add_u32 s28, s28, 1024
    s_cmp_eq_u32 s28, 57344
    s_cselect_b32 s28, 0, s28
    s_nop 0
    v_mfma_f32_16x16x32_bf16 v[56:59], v[196:199], v[88:91], v[56:59]
    ds_read_b64_tr_b16 v[168:169], v210 offset:20480
    v_mfma_f32_16x16x32_bf16 v[60:63], v[196:199], v[92:95], v[60:63]
    ds_read_b64_tr_b16 v[170:171], v210 offset:22528
    v_mfma_f32_16x16x32_bf16 v[64:67], v[200:203], v[88:91], v[64:67]
    ds_read_b64_tr_b16 v[172:173], v211 offset:20480
    v_mfma_f32_16x16x32_bf16 v[68:71], v[200:203], v[92:95], v[68:71]
    ds_read_b64_tr_b16 v[174:175], v211 offset:22528
    v_mfma_f32_16x16x32_bf16 v[72:75], v[204:207], v[88:91], v[72:75]
    v_mfma_f32_16x16x32_bf16 v[76:79], v[204:207], v[92:95], v[76:79]
    s_waitcnt vmcnt(12) lgkmcnt(0)
    s_nop 0
    v_mfma_f32_16x16x32_bf16 v[16:19], v[144:147], v[96:99], v[16:19]
    ds_read_b64_tr_b16 v[176:177], v208 offset:24576
    ds_read_b64_tr_b16 v[178:179], v208 offset:26624
    v_mfma_f32_16x16x32_bf16 v[20:23], v[144:147], v[100:103], v[20:23]
    ds_read_b64_tr_b16 v[180:181], v209 offset:24576
    v_mfma_f32_16x16x32_bf16 v[24:27], v[148:151], v[96:99], v[24:27]
    ds_read_b64_tr_b16 v[182:183], v209 offset:26624
    v_mfma_f32_16x16x32_bf16 v[28:31], v[148:151], v[100:103], v[28:31]
    ds_read_b64_tr_b16 v[184:185], v210 offset:24576
    buffer_load_dwordx4 v[88:91], v5, s[20:23], s28 offen sc1
    v_mfma_f32_16x16x32_bf16 v[32:35], v[152:155], v[96:99], v[32:35]
    ds_read_b64_tr_b16 v[186:187], v210 offset:26624
    v_mfma_f32_16x16x32_bf16 v[36:39], v[152:155], v[100:103], v[36:39]
    ds_read_b64_tr_b16 v[188:189], v211 offset:24576
    v_mfma_f32_16x16x32_bf16 v[40:43], v[156:159], v[96:99], v[40:43]
    ds_read_b64_tr_b16 v[190:191], v211 offset:26624
    v_mfma_f32_16x16x32_bf16 v[44:47], v[156:159], v[100:103], v[44:47]
    ds_read_b64_tr_b16 v[192:193], v208 offset:28672
    ds_read_b64_tr_b16 v[194:195], v208 offset:30720
    v_mfma_f32_16x16x32_bf16 v[48:51], v[160:163], v[96:99], v[48:51]
    ds_read_b64_tr_b16 v[196:197], v209 offset:28672
    v_mfma_f32_16x16x32_bf16 v[52:55], v[160:163], v[100:103], v[52:55]
    ds_read_b64_tr_b16 v[198:199], v209 offset:30720
    buffer_load_dwordx4 v[92:95], v6, s[20:23], s28 offen sc1
    s_add_u32 s28, s28, 1024
    s_cmp_eq_u32 s28, 57344
    s_cselect_b32 s28, 0, s28
    s_nop 0
    v_mfma_f32_16x16x32_bf16 v[56:59], v[164:167], v[96:99], v[56:59]
    ds_read_b64_tr_b16 v[200:201], v210 offset:28672
    v_mfma_f32_16x16x32_bf16 v[60:63], v[164:167], v[100:103], v[60:63]
    ds_read_b64_tr_b16 v[202:203], v210 offset:30720
    v_mfma_f32_16x16x32_bf16 v[64:67], v[168:171], v[96:99], v[64:67]
    ds_read_b64_tr_b16 v[204:205], v211 offset:28672
    v_mfma_f32_16x16x32_bf16 v[68:71], v[168:171], v[100:103], v[68:71]
    ds_read_b64_tr_b16 v[206:207], v211 offset:30720
    v_mfma_f32_16x16x32_bf16 v[72:75], v[172:175], v[96:99], v[72:75]
    v_mfma_f32_16x16x32_bf16 v[76:79], v[172:175], v[100:103], v[76:79]
    s_waitcnt vmcnt(12) lgkmcnt(0)
    s_barrier
    v_mfma_f32_16x16x32_bf16 v[16:19], v[176:179], v[104:107], v[16:19]
    ds_read_b64_tr_b16 v[144:145], v208 offset:32768
    ds_read_b64_tr_b16 v[146:147], v208 offset:34816
    v_mfma_f32_16x16x32_bf16 v[20:23], v[176:179], v[108:111], v[20:23]
    ds_read_b64_tr_b16 v[148:149], v209 offset:32768
    v_mfma_f32_16x16x32_bf16 v[24:27], v[180:183], v[104:107], v[24:27]
    ds_read_b64_tr_b16 v[150:151], v209 offset:34816
    v_mfma_f32_16x16x32_bf16 v[28:31], v[180:183], v[108:111], v[28:31]
    ds_read_b64_tr_b16 v[152:153], v210 offset:32768
    buffer_load_dwordx4 v[96:99], v5, s[20:23], s28 offen sc1
    v_mfma_f32_16x16x32_bf16 v[32:35], v[184:187], v[104:107], v[32:35]
    ds_read_b64_tr_b16 v[154:155], v210 offset:34816
    v_mfma_f32_16x16x32_bf16 v[36:39], v[184:187], v[108:111], v[36:39]
    ds_read_b64_tr_b16 v[156:157], v211 offset:32768
    v_mfma_f32_16x16x32_bf16 v[40:43], v[188:191], v[104:107], v[40:43]
    ds_read_b64_tr_b16 v[158:159], v211 offset:34816
    v_mfma_f32_16x16x32_bf16 v[44:47], v[188:191], v[108:111], v[44:47]
    ds_read_b64_tr_b16 v[160:161], v208 offset:36864
    ds_read_b64_tr_b16 v[162:163], v208 offset:38912
    v_mfma_f32_16x16x32_bf16 v[48:51], v[192:195], v[104:107], v[48:51]
    ds_read_b64_tr_b16 v[164:165], v209 offset:36864
    v_mfma_f32_16x16x32_bf16 v[52:55], v[192:195], v[108:111], v[52:55]
    ds_read_b64_tr_b16 v[166:167], v209 offset:38912
    buffer_load_dwordx4 v[100:103], v6, s[20:23], s28 offen sc1
    s_add_u32 s28, s28, 1024
    s_cmp_eq_u32 s28, 57344
    s_cselect_b32 s28, 0, s28
    s_nop 0
    v_mfma_f32_16x16x32_bf16 v[56:59], v[196:199], v[104:107], v[56:59]
    ds_read_b64_tr_b16 v[168:169], v210 offset:36864
    v_mfma_f32_16x16x32_bf16 v[60:63], v[196:199], v[108:111], v[60:63]
    ds_read_b64_tr_b16 v[170:171], v210 offset:38912
    v_mfma_f32_16x16x32_bf16 v[64:67], v[200:203], v[104:107], v[64:67]
    ds_read_b64_tr_b16 v[172:173], v211 offset:36864
    v_mfma_f32_16x16x32_bf16 v[68:71], v[200:203], v[108:111], v[68:71]
    ds_read_b64_tr_b16 v[174:175], v211 offset:38912
    v_mfma_f32_16x16x32_bf16 v[72:75], v[204:207], v[104:107], v[72:75]
    v_mfma_f32_16x16x32_bf16 v[76:79], v[204:207], v[108:111], v[76:79]
    s_waitcnt vmcnt(12) lgkmcnt(0)
    s_nop 0
    v_mfma_f32_16x16x32_bf16 v[16:19], v[144:147], v[112:115], v[16:19]
    ds_read_b64_tr_b16 v[176:177], v208 offset:40960
    ds_read_b64_tr_b16 v[178:179], v208 offset:43008
    v_mfma_f32_16x16x32_bf16 v[20:23], v[144:147], v[116:119], v[20:23]
    ds_read_b64_tr_b16 v[180:181], v209 offset:40960
    v_mfma_f32_16x16x32_bf16 v[24:27], v[148:151], v[112:115], v[24:27]
    ds_read_b64_tr_b16 v[182:183], v209 offset:43008
    v_mfma_f32_16x16x32_bf16 v[28:31], v[148:151], v[116:119], v[28:31]
    ds_read_b64_tr_b16 v[184:185], v210 offset:40960
    buffer_load_dwordx4 v[104:107], v5, s[20:23], s28 offen sc1
    v_mfma_f32_16x16x32_bf16 v[32:35], v[152:155], v[112:115], v[32:35]
    ds_read_b64_tr_b16 v[186:187], v210 offset:43008
    v_mfma_f32_16x16x32_bf16 v[36:39], v[152:155], v[116:119], v[36:39]
    ds_read_b64_tr_b16 v[188:189], v211 offset:40960
    v_mfma_f32_16x16x32_bf16 v[40:43], v[156:159], v[112:115], v[40:43]
    ds_read_b64_tr_b16 v[190:191], v211 offset:43008
    v_mfma_f32_16x16x32_bf16 v[44:47], v[156:159], v[116:119], v[44:47]
    ds_read_b64_tr_b16 v[192:193], v208 offset:45056
    ds_read_b64_tr_b16 v[194:195], v208 offset:47104
    v_mfma_f32_16x16x32_bf16 v[48:51], v[160:163], v[112:115], v[48:51]
    ds_read_b64_tr_b16 v[196:197], v209 offset:45056
    v_mfma_f32_16x16x32_bf16 v[52:55], v[160:163], v[116:119], v[52:55]
    ds_read_b64_tr_b16 v[198:199], v209 offset:47104
    buffer_load_dwordx4 v[108:111], v6, s[20:23], s28 offen sc1
    s_add_u32 s28, s28, 1024
    s_cmp_eq_u32 s28, 57344
    s_cselect_b32 s28, 0, s28
    s_nop 0
    v_mfma_f32_16x16x32_bf16 v[56:59], v[164:167], v[112:115], v[56:59]
    ds_read_b64_tr_b16 v[200:201], v210 offset:45056
    v_mfma_f32_16x16x32_bf16 v[60:63], v[164:167], v[116:119], v[60:63]
    ds_read_b64_tr_b16 v[202:203], v210 offset:47104
    v_mfma_f32_16x16x32_bf16 v[64:67], v[168:171], v[112:115], v[64:67]
    ds_read_b64_tr_b16 v[204:205], v211 offset:45056
    v_mfma_f32_16x16x32_bf16 v[68:71], v[168:171], v[116:119], v[68:71]
    ds_read_b64_tr_b16 v[206:207], v211 offset:47104
    v_mfma_f32_16x16x32_bf16 v[72:75], v[172:175], v[112:115], v[72:75]
    v_mfma_f32_16x16x32_bf16 v[76:79], v[172:175], v[116:119], v[76:79]
    s_waitcnt vmcnt(12) lgkmcnt(0)
    s_nop 0
    v_mfma_f32_16x16x32_bf16 v[16:19], v[176:179], v[120:123], v[16:19]
    ds_read_b64_tr_b16 v[144:145], v208 offset:49152
    ds_read_b64_tr_b16 v[146:147], v208 offset:51200
    v_mfma_f32_16x16x32_bf16 v[20:23], v[176:179], v[124:127], v[20:23]
    ds_read_b64_tr_b16 v[148:149], v209 offset:49152
    v_mfma_f32_16x16x32_bf16 v[24:27], v[180:183], v[120:123], v[24:27]
    ds_read_b64_tr_b16 v[150:151], v209 offset:51200
    v_mfma_f32_16x16x32_bf16 v[28:31], v[180:183], v[124:127], v[28:31]
    ds_read_b64_tr_b16 v[152:153], v210 offset:49152
    buffer_load_dwordx4 v[112:115], v5, s[20:23], s28 offen sc1
    v_mfma_f32_16x16x32_bf16 v[32:35], v[184:187], v[120:123], v[32:35]
    ds_read_b64_tr_b16 v[154:155], v210 offset:51200
    v_mfma_f32_16x16x32_bf16 v[36:39], v[184:187], v[124:127], v[36:39]
    ds_read_b64_tr_b16 v[156:157], v211 offset:49152
    v_mfma_f32_16x16x32_bf16 v[40:43], v[188:191], v[120:123], v[40:43]
    ds_read_b64_tr_b16 v[158:159], v211 offset:51200
    v_mfma_f32_16x16x32_bf16 v[44:47], v[188:191], v[124:127], v[44:47]
    ds_read_b64_tr_b16 v[160:161], v208 offset:53248
    ds_read_b64_tr_b16 v[162:163], v208 offset:55296
    v_mfma_f32_16x16x32_bf16 v[48:51], v[192:195], v[120:123], v[48:51]
    ds_read_b64_tr_b16 v[164:165], v209 offset:53248
    v_mfma_f32_16x16x32_bf16 v[52:55], v[192:195], v[124:127], v[52:55]
    ds_read_b64_tr_b16 v[166:167], v209 offset:55296
    buffer_load_dwordx4 v[116:119], v6, s[20:23], s28 offen sc1
    s_add_u32 s28, s28, 1024
    s_cmp_eq_u32 s28, 57344
    s_cselect_b32 s28, 0, s28
    s_nop 0
    v_mfma_f32_16x16x32_bf16 v[56:59], v[196:199], v[120:123], v[56:59]
    ds_read_b64_tr_b16 v[168:169], v210 offset:53248
    v_mfma_f32_16x16x32_bf16 v[60:63], v[196:199], v[124:127], v[60:63]
    ds_read_b64_tr_b16 v[170:171], v210 offset:55296
    v_mfma_f32_16x16x32_bf16 v[64:67], v[200:203], v[120:123], v[64:67]
    ds_read_b64_tr_b16 v[172:173], v211 offset:53248
    v_mfma_f32_16x16x32_bf16 v[68:71], v[200:203], v[124:127], v[68:71]
    ds_read_b64_tr_b16 v[174:175], v211 offset:55296
    v_mfma_f32_16x16x32_bf16 v[72:75], v[204:207], v[120:123], v[72:75]
    v_mfma_f32_16x16x32_bf16 v[76:79], v[204:207], v[124:127], v[76:79]
    s_waitcnt vmcnt(12) lgkmcnt(0)
    s_nop 0
    v_mfma_f32_16x16x32_bf16 v[16:19], v[144:147], v[128:131], v[16:19]
    ds_read_b64_tr_b16 v[176:177], v208 offset:57344
    ds_read_b64_tr_b16 v[178:179], v208 offset:59392
    v_mfma_f32_16x16x32_bf16 v[20:23], v[144:147], v[132:135], v[20:23]
    ds_read_b64_tr_b16 v[180:181], v209 offset:57344
    v_mfma_f32_16x16x32_bf16 v[24:27], v[148:151], v[128:131], v[24:27]
    ds_read_b64_tr_b16 v[182:183], v209 offset:59392
    v_mfma_f32_16x16x32_bf16 v[28:31], v[148:151], v[132:135], v[28:31]
    ds_read_b64_tr_b16 v[184:185], v210 offset:57344
    buffer_load_dwordx4 v[120:123], v5, s[20:23], s28 offen sc1
    v_mfma_f32_16x16x32_bf16 v[32:35], v[152:155], v[128:131], v[32:35]
    ds_read_b64_tr_b16 v[186:187], v210 offset:59392
    v_mfma_f32_16x16x32_bf16 v[36:39], v[152:155], v[132:135], v[36:39]
    ds_read_b64_tr_b16 v[188:189], v211 offset:57344
    v_mfma_f32_16x16x32_bf16 v[40:43], v[156:159], v[128:131], v[40:43]
    ds_read_b64_tr_b16 v[190:191], v211 offset:59392
    v_mfma_f32_16x16x32_bf16 v[44:47], v[156:159], v[132:135], v[44:47]
    ds_read_b64_tr_b16 v[192:193], v208 offset:61440
    ds_read_b64_tr_b16 v[194:195], v208 offset:63488
    v_mfma_f32_16x16x32_bf16 v[48:51], v[160:163], v[128:131], v[48:51]
    ds_read_b64_tr_b16 v[196:197], v209 offset:61440
    v_mfma_f32_16x16x32_bf16 v[52:55], v[160:163], v[132:135], v[52:55]
    ds_read_b64_tr_b16 v[198:199], v209 offset:63488
    buffer_load_dwordx4 v[124:127], v6, s[20:23], s28 offen sc1
    s_add_u32 s28, s28, 1024
    s_cmp_eq_u32 s28, 57344
    s_cselect_b32 s28, 0, s28
    s_nop 0
    v_mfma_f32_16x16x32_bf16 v[56:59], v[164:167], v[128:131], v[56:59]
    ds_read_b64_tr_b16 v[200:201], v210 offset:61440
    v_mfma_f32_16x16x32_bf16 v[60:63], v[164:167], v[132:135], v[60:63]
    ds_read_b64_tr_b16 v[202:203], v210 offset:63488
    v_mfma_f32_16x16x32_bf16 v[64:67], v[168:171], v[128:131], v[64:67]
    ds_read_b64_tr_b16 v[204:205], v211 offset:61440
    v_mfma_f32_16x16x32_bf16 v[68:71], v[168:171], v[132:135], v[68:71]
    ds_read_b64_tr_b16 v[206:207], v211 offset:63488
    v_mfma_f32_16x16x32_bf16 v[72:75], v[172:175], v[128:131], v[72:75]
    v_mfma_f32_16x16x32_bf16 v[76:79], v[172:175], v[132:135], v[76:79]
    s_waitcnt vmcnt(12) lgkmcnt(0)
    s_barrier
    v_xor_b32 v208, s31, v208
    v_xor_b32 v209, s31, v209
    v_xor_b32 v210, s31, v210
    v_xor_b32 v211, s31, v211
    v_mfma_f32_16x16x32_bf16 v[16:19], v[176:179], v[136:139], v[16:19]
    ds_read_b64_tr_b16 v[144:145], v208 offset:0
    ds_read_b64_tr_b16 v[146:147], v208 offset:2048
    v_mfma_f32_16x16x32_bf16 v[20:23], v[176:179], v[140:143], v[20:23]
    ds_read_b64_tr_b16 v[148:149], v209 offset:0
    v_mfma_f32_16x16x32_bf16 v[24:27], v[180:183], v[136:139], v[24:27]
    ds_read_b64_tr_b16 v[150:151], v209 offset:2048
    v_mfma_f32_16x16x32_bf16 v[28:31], v[180:183], v[140:143], v[28:31]
    ds_read_b64_tr_b16 v[152:153], v210 offset:0
    buffer_load_dwordx4 v[128:131], v5, s[20:23], s28 offen sc1
    v_mfma_f32_16x16x32_bf16 v[32:35], v[184:187], v[136:139], v[32:35]
    ds_read_b64_tr_b16 v[154:155], v210 offset:2048
    v_mfma_f32_16x16x32_bf16 v[36:39], v[184:187], v[140:143], v[36:39]
    ds_read_b64_tr_b16 v[156:157], v211 offset:0
    v_mfma_f32_16x16x32_bf16 v[40:43], v[188:191], v[136:139], v[40:43]
    ds_read_b64_tr_b16 v[158:159], v211 offset:2048
    v_mfma_f32_16x16x32_bf16 v[44:47], v[188:191], v[140:143], v[44:47]
    ds_read_b64_tr_b16 v[160:161], v208 offset:4096
    ds_read_b64_tr_b16 v[162:163], v208 offset:6144
    v_mfma_f32_16x16x32_bf16 v[48:51], v[192:195], v[136:139], v[48:51]
    ds_read_b64_tr_b16 v[164:165], v209 offset:4096
    v_mfma_f32_16x16x32_bf16 v[52:55], v[192:195], v[140:143], v[52:55]
    ds_read_b64_tr_b16 v[166:167], v209 offset:6144
    buffer_load_dwordx4 v[132:135], v6, s[20:23], s28 offen sc1
    s_add_u32 s28, s28, 1024
    s_cmp_eq_u32 s28, 57344
    s_cselect_b32 s28, 0, s28
    s_nop 0
    v_mfma_f32_16x16x32_bf16 v[56:59], v[196:199], v[136:139], v[56:59]
    ds_read_b64_tr_b16 v[168:169], v210 offset:4096
    v_mfma_f32_16x16x32_bf16 v[60:63], v[196:199], v[140:143], v[60:63]
    ds_read_b64_tr_b16 v[170:171], v210 offset:6144
    v_mfma_f32_16x16x32_bf16 v[64:67], v[200:203], v[136:139], v[64:67]
    ds_read_b64_tr_b16 v[172:173], v211 offset:4096
    v_mfma_f32_16x16x32_bf16 v[68:71], v[200:203], v[140:143], v[68:71]
    ds_read_b64_tr_b16 v[174:175], v211 offset:6144
    v_mfma_f32_16x16x32_bf16 v[72:75], v[204:207], v[136:139], v[72:75]
    v_mfma_f32_16x16x32_bf16 v[76:79], v[204:207], v[140:143], v[76:79]
    s_add_u32 s33, s33, 1
    s_cmp_lt_u32 s33, 6
    s_cbranch_scc1 sequential_preLN__ssm_conv_h3__dense_activation_squared_relu__prompt_kernel_g_g2c
    s_waitcnt vmcnt(12) lgkmcnt(0)
    v_mfma_f32_16x16x32_bf16 v[16:19], v[144:147], v[80:83], v[16:19]
    ds_read_b64_tr_b16 v[176:177], v208 offset:8192
    ds_read_b64_tr_b16 v[178:179], v208 offset:10240
    v_mfma_f32_16x16x32_bf16 v[20:23], v[144:147], v[84:87], v[20:23]
    ds_read_b64_tr_b16 v[180:181], v209 offset:8192
    v_mfma_f32_16x16x32_bf16 v[24:27], v[148:151], v[80:83], v[24:27]
    ds_read_b64_tr_b16 v[182:183], v209 offset:10240
    v_mfma_f32_16x16x32_bf16 v[28:31], v[148:151], v[84:87], v[28:31]
    ds_read_b64_tr_b16 v[184:185], v210 offset:8192
    buffer_load_dwordx4 v[136:139], v5, s[20:23], s28 offen sc1
    v_mfma_f32_16x16x32_bf16 v[32:35], v[152:155], v[80:83], v[32:35]
    ds_read_b64_tr_b16 v[186:187], v210 offset:10240
    v_mfma_f32_16x16x32_bf16 v[36:39], v[152:155], v[84:87], v[36:39]
    ds_read_b64_tr_b16 v[188:189], v211 offset:8192
    v_mfma_f32_16x16x32_bf16 v[40:43], v[156:159], v[80:83], v[40:43]
    ds_read_b64_tr_b16 v[190:191], v211 offset:10240
    v_mfma_f32_16x16x32_bf16 v[44:47], v[156:159], v[84:87], v[44:47]
    ds_read_b64_tr_b16 v[192:193], v208 offset:12288
    ds_read_b64_tr_b16 v[194:195], v208 offset:14336
    v_mfma_f32_16x16x32_bf16 v[48:51], v[160:163], v[80:83], v[48:51]
    ds_read_b64_tr_b16 v[196:197], v209 offset:12288
    v_mfma_f32_16x16x32_bf16 v[52:55], v[160:163], v[84:87], v[52:55]
    ds_read_b64_tr_b16 v[198:199], v209 offset:14336
    buffer_load_dwordx4 v[140:143], v6, s[20:23], s28 offen sc1
    s_add_u32 s28, s28, 1024
    s_cmp_eq_u32 s28, 57344
    s_cselect_b32 s28, 0, s28
    s_nop 0
    v_mfma_f32_16x16x32_bf16 v[56:59], v[164:167], v[80:83], v[56:59]
    ds_read_b64_tr_b16 v[200:201], v210 offset:12288
    v_mfma_f32_16x16x32_bf16 v[60:63], v[164:167], v[84:87], v[60:63]
    ds_read_b64_tr_b16 v[202:203], v210 offset:14336
    v_mfma_f32_16x16x32_bf16 v[64:67], v[168:171], v[80:83], v[64:67]
    ds_read_b64_tr_b16 v[204:205], v211 offset:12288
    v_mfma_f32_16x16x32_bf16 v[68:71], v[168:171], v[84:87], v[68:71]
    ds_read_b64_tr_b16 v[206:207], v211 offset:14336
    v_mfma_f32_16x16x32_bf16 v[72:75], v[172:175], v[80:83], v[72:75]
    v_mfma_f32_16x16x32_bf16 v[76:79], v[172:175], v[84:87], v[76:79]
    s_mov_b32 s40, s4
    s_mov_b32 s41, s5
    s_mov_b32 s42, 2048
    s_mov_b32 s43, 0x20000
    s_lshl_b32 s35, s16, 1
    s_add_u32 s35, s35, s34
    v_lshlrev_b32 v10, 3, v4
    s_lshl_b32 s18, s35, 7
    buffer_load_dwordx2 v[216:217], v10, s[40:43], s18 offen offset:0
    buffer_load_dwordx2 v[218:219], v10, s[40:43], s18 offen offset:32
    buffer_load_dwordx2 v[220:221], v10, s[40:43], s18 offen offset:64
    buffer_load_dwordx2 v[222:223], v10, s[40:43], s18 offen offset:96
    s_lshl_b32 s52, s2, 15
    s_lshl_b32 s18, s14, 13
    s_add_u32 s52, s52, s18
    s_nop 0
    s_add_u32 s53, s52, 4096
    s_xor_b32 s54, s52, 131072
    s_add_u32 s55, s54, 4096
    s_xor_b32 s57, s61, 2048
    s_waitcnt vmcnt(16) lgkmcnt(0)
    s_nop 0
    v_mfma_f32_16x16x32_bf16 v[16:19], v[176:179], v[88:91], v[16:19]
    ds_read_b64_tr_b16 v[144:145], v208 offset:16384
    ds_read_b64_tr_b16 v[146:147], v208 offset:18432
    v_mfma_f32_16x16x32_bf16 v[20:23], v[176:179], v[92:95], v[20:23]
    ds_read_b64_tr_b16 v[148:149], v209 offset:16384
    v_mfma_f32_16x16x32_bf16 v[24:27], v[180:183], v[88:91], v[24:27]
    ds_read_b64_tr_b16 v[150:151], v209 offset:18432
    v_mfma_f32_16x16x32_bf16 v[28:31], v[180:183], v[92:95], v[28:31]
    ds_read_b64_tr_b16 v[152:153], v210 offset:16384
    v_mfma_f32_16x16x32_bf16 v[32:35], v[184:187], v[88:91], v[32:35]
    ds_read_b64_tr_b16 v[154:155], v210 offset:18432
    v_mfma_f32_16x16x32_bf16 v[36:39], v[184:187], v[92:95], v[36:39]
    ds_read_b64_tr_b16 v[156:157], v211 offset:16384
    v_mfma_f32_16x16x32_bf16 v[40:43], v[188:191], v[88:91], v[40:43]
    ds_read_b64_tr_b16 v[158:159], v211 offset:18432
    v_mfma_f32_16x16x32_bf16 v[44:47], v[188:191], v[92:95], v[44:47]
    ds_read_b64_tr_b16 v[160:161], v208 offset:20480
    ds_read_b64_tr_b16 v[162:163], v208 offset:22528
    v_mfma_f32_16x16x32_bf16 v[48:51], v[192:195], v[88:91], v[48:51]
    ds_read_b64_tr_b16 v[164:165], v209 offset:20480
    v_mfma_f32_16x16x32_bf16 v[52:55], v[192:195], v[92:95], v[52:55]
    ds_read_b64_tr_b16 v[166:167], v209 offset:22528
    v_mfma_f32_16x16x32_bf16 v[56:59], v[196:199], v[88:91], v[56:59]
    ds_read_b64_tr_b16 v[168:169], v210 offset:20480
    v_mfma_f32_16x16x32_bf16 v[60:63], v[196:199], v[92:95], v[60:63]
    ds_read_b64_tr_b16 v[170:171], v210 offset:22528
    v_mfma_f32_16x16x32_bf16 v[64:67], v[200:203], v[88:91], v[64:67]
    ds_read_b64_tr_b16 v[172:173], v211 offset:20480
    v_mfma_f32_16x16x32_bf16 v[68:71], v[200:203], v[92:95], v[68:71]
    ds_read_b64_tr_b16 v[174:175], v211 offset:22528
    v_mfma_f32_16x16x32_bf16 v[72:75], v[204:207], v[88:91], v[72:75]
    v_mfma_f32_16x16x32_bf16 v[76:79], v[204:207], v[92:95], v[76:79]
    s_waitcnt vmcnt(14) lgkmcnt(0)
    s_nop 0
    v_mfma_f32_16x16x32_bf16 v[16:19], v[144:147], v[96:99], v[16:19]
    ds_read_b64_tr_b16 v[176:177], v208 offset:24576
    ds_read_b64_tr_b16 v[178:179], v208 offset:26624
    v_mfma_f32_16x16x32_bf16 v[20:23], v[144:147], v[100:103], v[20:23]
    ds_read_b64_tr_b16 v[180:181], v209 offset:24576
    v_mfma_f32_16x16x32_bf16 v[24:27], v[148:151], v[96:99], v[24:27]
    ds_read_b64_tr_b16 v[182:183], v209 offset:26624
    v_mfma_f32_16x16x32_bf16 v[28:31], v[148:151], v[100:103], v[28:31]
    ds_read_b64_tr_b16 v[184:185], v210 offset:24576
    v_mfma_f32_16x16x32_bf16 v[32:35], v[152:155], v[96:99], v[32:35]
    ds_read_b64_tr_b16 v[186:187], v210 offset:26624
    v_mfma_f32_16x16x32_bf16 v[36:39], v[152:155], v[100:103], v[36:39]
    ds_read_b64_tr_b16 v[188:189], v211 offset:24576
    v_mfma_f32_16x16x32_bf16 v[40:43], v[156:159], v[96:99], v[40:43]
    ds_read_b64_tr_b16 v[190:191], v211 offset:26624
    v_mfma_f32_16x16x32_bf16 v[44:47], v[156:159], v[100:103], v[44:47]
    ds_read_b64_tr_b16 v[192:193], v208 offset:28672
    ds_read_b64_tr_b16 v[194:195], v208 offset:30720
    v_mfma_f32_16x16x32_bf16 v[48:51], v[160:163], v[96:99], v[48:51]
    ds_read_b64_tr_b16 v[196:197], v209 offset:28672
    v_mfma_f32_16x16x32_bf16 v[52:55], v[160:163], v[100:103], v[52:55]
    ds_read_b64_tr_b16 v[198:199], v209 offset:30720
    v_mfma_f32_16x16x32_bf16 v[56:59], v[164:167], v[96:99], v[56:59]
    ds_read_b64_tr_b16 v[200:201], v210 offset:28672
    v_mfma_f32_16x16x32_bf16 v[60:63], v[164:167], v[100:103], v[60:63]
    ds_read_b64_tr_b16 v[202:203], v210 offset:30720
    v_mfma_f32_16x16x32_bf16 v[64:67], v[168:171], v[96:99], v[64:67]
    ds_read_b64_tr_b16 v[204:205], v211 offset:28672
    v_mfma_f32_16x16x32_bf16 v[68:71], v[168:171], v[100:103], v[68:71]
    ds_read_b64_tr_b16 v[206:207], v211 offset:30720
    v_mfma_f32_16x16x32_bf16 v[72:75], v[172:175], v[96:99], v[72:75]
    v_mfma_f32_16x16x32_bf16 v[76:79], v[172:175], v[100:103], v[76:79]
    s_waitcnt vmcnt(12) lgkmcnt(0)
    s_barrier
    v_mfma_f32_16x16x32_bf16 v[16:19], v[176:179], v[104:107], v[16:19]
    ds_read_b64_tr_b16 v[160:161], v208 offset:36864
    ds_read_b64_tr_b16 v[162:163], v208 offset:38912
    v_mfma_f32_16x16x32_bf16 v[20:23], v[176:179], v[108:111], v[20:23]
    ds_read_b64_tr_b16 v[164:165], v209 offset:36864
    v_mfma_f32_16x16x32_bf16 v[24:27], v[180:183], v[104:107], v[24:27]
    ds_read_b64_tr_b16 v[166:167], v209 offset:38912
    v_mfma_f32_16x16x32_bf16 v[28:31], v[180:183], v[108:111], v[28:31]
    ds_read_b64_tr_b16 v[168:169], v210 offset:36864
    v_mfma_f32_16x16x32_bf16 v[32:35], v[184:187], v[104:107], v[32:35]
    ds_read_b64_tr_b16 v[170:171], v210 offset:38912
    v_mfma_f32_16x16x32_bf16 v[36:39], v[184:187], v[108:111], v[36:39]
    ds_read_b64_tr_b16 v[172:173], v211 offset:36864
    v_mfma_f32_16x16x32_bf16 v[40:43], v[188:191], v[104:107], v[40:43]
    ds_read_b64_tr_b16 v[174:175], v211 offset:38912
    v_mfma_f32_16x16x32_bf16 v[44:47], v[188:191], v[108:111], v[44:47]
    v_mfma_f32_16x16x32_bf16 v[48:51], v[192:195], v[104:107], v[48:51]
    v_mfma_f32_16x16x32_bf16 v[52:55], v[192:195], v[108:111], v[52:55]
    v_mfma_f32_16x16x32_bf16 v[56:59], v[196:199], v[104:107], v[56:59]
    v_mfma_f32_16x16x32_bf16 v[60:63], v[196:199], v[108:111], v[60:63]
    v_mfma_f32_16x16x32_bf16 v[64:67], v[200:203], v[104:107], v[64:67]
    v_mfma_f32_16x16x32_bf16 v[68:71], v[200:203], v[108:111], v[68:71]
    v_mfma_f32_16x16x32_bf16 v[72:75], v[204:207], v[104:107], v[72:75]
    v_mfma_f32_16x16x32_bf16 v[76:79], v[204:207], v[108:111], v[76:79]
    s_waitcnt vmcnt(10) lgkmcnt(0)
    s_nop 0
    v_mfma_f32_16x16x32_bf16 v[48:51], v[160:163], v[112:115], v[48:51]
    ds_read_b64_tr_b16 v[192:193], v208 offset:45056
    ds_read_b64_tr_b16 v[194:195], v208 offset:47104
    v_mfma_f32_16x16x32_bf16 v[52:55], v[160:163], v[116:119], v[52:55]
    ds_read_b64_tr_b16 v[196:197], v209 offset:45056
    v_mfma_f32_16x16x32_bf16 v[56:59], v[164:167], v[112:115], v[56:59]
    ds_read_b64_tr_b16 v[198:199], v209 offset:47104
    v_mfma_f32_16x16x32_bf16 v[60:63], v[164:167], v[116:119], v[60:63]
    ds_read_b64_tr_b16 v[200:201], v210 offset:45056
    ds_read_b64_tr_b16 v[202:203], v210 offset:47104
    v_mfma_f32_16x16x32_bf16 v[64:67], v[168:171], v[112:115], v[64:67]
    ds_read_b64_tr_b16 v[204:205], v211 offset:45056
    v_mfma_f32_16x16x32_bf16 v[68:71], v[168:171], v[116:119], v[68:71]
    ds_read_b64_tr_b16 v[206:207], v211 offset:47104
    v_mfma_f32_16x16x32_bf16 v[72:75], v[172:175], v[112:115], v[72:75]
    v_mfma_f32_16x16x32_bf16 v[76:79], v[172:175], v[116:119], v[76:79]
    s_waitcnt vmcnt(8) lgkmcnt(0)
    s_nop 0
    v_mfma_f32_16x16x32_bf16 v[48:51], v[192:195], v[120:123], v[48:51]
    ds_read_b64_tr_b16 v[160:161], v208 offset:53248
    ds_read_b64_tr_b16 v[162:163], v208 offset:55296
    v_mfma_f32_16x16x32_bf16 v[52:55], v[192:195], v[124:127], v[52:55]
    ds_read_b64_tr_b16 v[164:165], v209 offset:53248
    v_mfma_f32_16x16x32_bf16 v[56:59], v[196:199], v[120:123], v[56:59]
    ds_read_b64_tr_b16 v[166:167], v209 offset:55296
    v_mfma_f32_16x16x32_bf16 v[60:63], v[196:199], v[124:127], v[60:63]
    ds_read_b64_tr_b16 v[168:169], v210 offset:53248
    ds_read_b64_tr_b16 v[170:171], v210 offset:55296
    v_mfma_f32_16x16x32_bf16 v[64:67], v[200:203], v[120:123], v[64:67]
    ds_read_b64_tr_b16 v[172:173], v211 offset:53248
    v_mfma_f32_16x16x32_bf16 v[68:71], v[200:203], v[124:127], v[68:71]
    ds_read_b64_tr_b16 v[174:175], v211 offset:55296
    v_mfma_f32_16x16x32_bf16 v[72:75], v[204:207], v[120:123], v[72:75]
    v_mfma_f32_16x16x32_bf16 v[76:79], v[204:207], v[124:127], v[76:79]
    s_waitcnt vmcnt(6) lgkmcnt(0)
    s_nop 0
    v_mfma_f32_16x16x32_bf16 v[48:51], v[160:163], v[128:131], v[48:51]
    ds_read_b64_tr_b16 v[192:193], v208 offset:61440
    ds_read_b64_tr_b16 v[194:195], v208 offset:63488
    v_mfma_f32_16x16x32_bf16 v[52:55], v[160:163], v[132:135], v[52:55]
    ds_read_b64_tr_b16 v[196:197], v209 offset:61440
    v_mfma_f32_16x16x32_bf16 v[56:59], v[164:167], v[128:131], v[56:59]
    ds_read_b64_tr_b16 v[198:199], v209 offset:63488
    v_mfma_f32_16x16x32_bf16 v[60:63], v[164:167], v[132:135], v[60:63]
    ds_read_b64_tr_b16 v[200:201], v210 offset:61440
    ds_read_b64_tr_b16 v[202:203], v210 offset:63488
    v_mfma_f32_16x16x32_bf16 v[64:67], v[168:171], v[128:131], v[64:67]
    ds_read_b64_tr_b16 v[204:205], v211 offset:61440
    v_mfma_f32_16x16x32_bf16 v[68:71], v[168:171], v[132:135], v[68:71]
    ds_read_b64_tr_b16 v[206:207], v211 offset:63488
    v_mfma_f32_16x16x32_bf16 v[72:75], v[172:175], v[128:131], v[72:75]
    v_mfma_f32_16x16x32_bf16 v[76:79], v[172:175], v[132:135], v[76:79]
    s_waitcnt vmcnt(4) lgkmcnt(0)
    s_nop 0
    v_mfma_f32_16x16x32_bf16 v[48:51], v[192:195], v[136:139], v[48:51]
    ds_read_b64_tr_b16 v[144:145], v208 offset:32768
    ds_read_b64_tr_b16 v[146:147], v208 offset:34816
    v_mfma_f32_16x16x32_bf16 v[52:55], v[192:195], v[140:143], v[52:55]
    ds_read_b64_tr_b16 v[148:149], v209 offset:32768
    v_mfma_f32_16x16x32_bf16 v[56:59], v[196:199], v[136:139], v[56:59]
    ds_read_b64_tr_b16 v[150:151], v209 offset:34816
    v_mfma_f32_16x16x32_bf16 v[60:63], v[196:199], v[140:143], v[60:63]
    ds_read_b64_tr_b16 v[152:153], v210 offset:32768
    ds_read_b64_tr_b16 v[154:155], v210 offset:34816
    v_mfma_f32_16x16x32_bf16 v[64:67], v[200:203], v[136:139], v[64:67]
    ds_read_b64_tr_b16 v[156:157], v211 offset:32768
    v_mfma_f32_16x16x32_bf16 v[68:71], v[200:203], v[140:143], v[68:71]
    ds_read_b64_tr_b16 v[158:159], v211 offset:34816
    v_mfma_f32_16x16x32_bf16 v[72:75], v[204:207], v[136:139], v[72:75]
    v_mfma_f32_16x16x32_bf16 v[76:79], v[204:207], v[140:143], v[76:79]
    s_nop 4
    s_cmp_eq_u32 s59, 1
    s_cbranch_scc1 sequential_preLN__ssm_conv_h3__dense_activation_squared_relu__prompt_kernel_g_near
    s_nop 0
    buffer_store_dwordx4 v[48:51], v5, s[48:51], s52 offen offset:0 sc1
    buffer_store_dwordx4 v[52:55], v5, s[48:51], s52 offen offset:1024 sc1
    buffer_store_dwordx4 v[56:59], v5, s[48:51], s52 offen offset:2048 sc1
    buffer_store_dwordx4 v[60:63], v5, s[48:51], s52 offen offset:3072 sc1
    buffer_store_dwordx4 v[64:67], v5, s[48:51], s53 offen offset:0 sc1
    buffer_store_dwordx4 v[68:71], v5, s[48:51], s53 offen offset:1024 sc1
    buffer_store_dwordx4 v[72:75], v5, s[48:51], s53 offen offset:2048 sc1
    buffer_store_dwordx4 v[76:79], v5, s[48:51], s53 offen offset:3072 sc1
    s_branch sequential_preLN__ssm_conv_h3__dense_activation_squared_relu__prompt_kernel_g_sent
sequential_preLN__ssm_conv_h3__dense_activation_squared_relu__prompt_kernel_g_near:
    s_nop 0
    buffer_store_dwordx4 v[48:51], v5, s[48:51], s52 offen offset:0
    buffer_store_dwordx4 v[52:55], v5, s[48:51], s52 offen offset:1024
    buffer_store_dwordx4 v[56:59], v5, s[48:51], s52 offen offset:2048
    buffer_store_dwordx4 v[60:63], v5, s[48:51], s52 offen offset:3072
    buffer_store_dwordx4 v[64:67], v5, s[48:51], s53 offen offset:0
    buffer_store_dwordx4 v[68:71], v5, s[48:51], s53 offen offset:1024
    buffer_store_dwordx4 v[72:75], v5, s[48:51], s53 offen offset:2048
    buffer_store_dwordx4 v[76:79], v5, s[48:51], s53 offen offset:3072
sequential_preLN__ssm_conv_h3__dense_activation_squared_relu__prompt_kernel_g_sent:
    s_waitcnt lgkmcnt(0)
    s_nop 0
    v_mfma_f32_16x16x32_bf16 v[16:19], v[144:147], v[112:115], v[16:19]
    ds_read_b64_tr_b16 v[176:177], v208 offset:40960
    ds_read_b64_tr_b16 v[178:179], v208 offset:43008
    v_mfma_f32_16x16x32_bf16 v[20:23], v[144:147], v[116:119], v[20:23]
    ds_read_b64_tr_b16 v[180:181], v209 offset:40960
    v_mfma_f32_16x16x32_bf16 v[24:27], v[148:151], v[112:115], v[24:27]
    ds_read_b64_tr_b16 v[182:183], v209 offset:43008
    v_mfma_f32_16x16x32_bf16 v[28:31], v[148:151], v[116:119], v[28:31]
    ds_read_b64_tr_b16 v[184:185], v210 offset:40960
    ds_read_b64_tr_b16 v[186:187], v210 offset:43008
    v_mfma_f32_16x16x32_bf16 v[32:35], v[152:155], v[112:115], v[32:35]
    ds_read_b64_tr_b16 v[188:189], v211 offset:40960
    v_mfma_f32_16x16x32_bf16 v[36:39], v[152:155], v[116:119], v[36:39]
    ds_read_b64_tr_b16 v[190:191], v211 offset:43008
    v_mfma_f32_16x16x32_bf16 v[40:43], v[156:159], v[112:115], v[40:43]
    v_mfma_f32_16x16x32_bf16 v[44:47], v[156:159], v[116:119], v[44:47]
    s_waitcnt lgkmcnt(0)
    s_nop 0
    v_mfma_f32_16x16x32_bf16 v[16:19], v[176:179], v[120:123], v[16:19]
    ds_read_b64_tr_b16 v[144:145], v208 offset:49152
    ds_read_b64_tr_b16 v[146:147], v208 offset:51200
    v_mfma_f32_16x16x32_bf16 v[20:23], v[176:179], v[124:127], v[20:23]
    ds_read_b64_tr_b16 v[148:149], v209 offset:49152
    v_mfma_f32_16x16x32_bf16 v[24:27], v[180:183], v[120:123], v[24:27]
    ds_read_b64_tr_b16 v[150:151], v209 offset:51200
    v_mfma_f32_16x16x32_bf16 v[28:31], v[180:183], v[124:127], v[28:31]
    ds_read_b64_tr_b16 v[152:153], v210 offset:49152
    ds_read_b64_tr_b16 v[154:155], v210 offset:51200
    v_mfma_f32_16x16x32_bf16 v[32:35], v[184:187], v[120:123], v[32:35]
    ds_read_b64_tr_b16 v[156:157], v211 offset:49152
    v_mfma_f32_16x16x32_bf16 v[36:39], v[184:187], v[124:127], v[36:39]
    ds_read_b64_tr_b16 v[158:159], v211 offset:51200
    v_mfma_f32_16x16x32_bf16 v[40:43], v[188:191], v[120:123], v[40:43]
    v_mfma_f32_16x16x32_bf16 v[44:47], v[188:191], v[124:127], v[44:47]
    s_waitcnt lgkmcnt(0)
    s_nop 0
    v_mfma_f32_16x16x32_bf16 v[16:19], v[144:147], v[128:131], v[16:19]
    ds_read_b64_tr_b16 v[176:177], v208 offset:57344
    ds_read_b64_tr_b16 v[178:179], v208 offset:59392
    v_mfma_f32_16x16x32_bf16 v[20:23], v[144:147], v[132:135], v[20:23]
    ds_read_b64_tr_b16 v[180:181], v209 offset:57344
    v_mfma_f32_16x16x32_bf16 v[24:27], v[148:151], v[128:131], v[24:27]
    ds_read_b64_tr_b16 v[182:183], v209 offset:59392
    v_mfma_f32_16x16x32_bf16 v[28:31], v[148:151], v[132:135], v[28:31]
    ds_read_b64_tr_b16 v[184:185], v210 offset:57344
    ds_read_b64_tr_b16 v[186:187], v210 offset:59392
    v_mfma_f32_16x16x32_bf16 v[32:35], v[152:155], v[128:131], v[32:35]
    ds_read_b64_tr_b16 v[188:189], v211 offset:57344
    v_mfma_f32_16x16x32_bf16 v[36:39], v[152:155], v[132:135], v[36:39]
    ds_read_b64_tr_b16 v[190:191], v211 offset:59392
    v_mfma_f32_16x16x32_bf16 v[40:43], v[156:159], v[128:131], v[40:43]
    v_mfma_f32_16x16x32_bf16 v[44:47], v[156:159], v[132:135], v[44:47]
    s_waitcnt lgkmcnt(0)
    s_nop 0
    v_mfma_f32_16x16x32_bf16 v[16:19], v[176:179], v[136:139], v[16:19]
    v_mfma_f32_16x16x32_bf16 v[20:23], v[176:179], v[140:143], v[20:23]
    v_mfma_f32_16x16x32_bf16 v[24:27], v[180:183], v[136:139], v[24:27]
    v_mfma_f32_16x16x32_bf16 v[28:31], v[180:183], v[140:143], v[28:31]
    v_mfma_f32_16x16x32_bf16 v[32:35], v[184:187], v[136:139], v[32:35]
    v_mfma_f32_16x16x32_bf16 v[36:39], v[184:187], v[140:143], v[36:39]
    v_mfma_f32_16x16x32_bf16 v[40:43], v[188:191], v[136:139], v[40:43]
    v_mfma_f32_16x16x32_bf16 v[44:47], v[188:191], v[140:143], v[44:47]
    v_mov_b32_e64 v8, 1
    s_waitcnt vmcnt(0)
    s_mov_b64 exec, 1
    buffer_store_dword v8, v13, s[48:51], s61 offen offset:64 sc1
    s_mov_b64 exec, -1
    s_nop 0
    buffer_load_dword v14, v13, s[48:51], s57 offen offset:64 sc1
    s_mov_b32 s44, s6
    s_mov_b32 s45, s7
    s_mov_b32 s46, 4194304
    s_mov_b32 s47, 0x20000
    v_lshrrev_b32 v8, 2, v1
    v_lshlrev_b32 v9, 8, v8
    v_and_b32_e64 v8, 7, v8
    v_lshl_add_u32 v9, v8, 5, v9
    v_and_b32_e64 v8, 3, v1
    v_lshl_add_u32 v9, v8, 3, v9
    s_lshl_b32 s18, s14, 6
    v_xor_b32 v9, s18, v9
    v_add_u32 v9, 131072, v9
    v_xor_b32_e64 v10, 32, v9
    ds_read_b64_tr_b16 v[144:145], v9 offset:0
    ds_read_b64_tr_b16 v[146:147], v9 offset:4096
    ds_read_b64_tr_b16 v[148:149], v9 offset:8192
    ds_read_b64_tr_b16 v[150:151], v9 offset:12288
    ds_read_b64_tr_b16 v[152:153], v10 offset:0
    ds_read_b64_tr_b16 v[154:155], v10 offset:4096
    ds_read_b64_tr_b16 v[156:157], v10 offset:8192
    ds_read_b64_tr_b16 v[158:159], v10 offset:12288
    s_lshl_b32 s17, s15, 7
    s_lshl_b32 s18, s14, 5
    s_add_u32 s17, s17, s18
    s_lshl_b32 s17, s17, 11
    s_lshl_b32 s18, s35, 7
    s_add_u32 s17, s17, s18
    s_add_u32 s18, s17, 32768
    v_lshlrev_b32 v11, 11, v3
    v_and_b32 v12, 1, v4
    v_lshl_add_u32 v11, v12, 5, v11
    v_lshrrev_b32_e64 v12, 1, v4
    v_lshl_add_u32 v11, v12, 4, v11
    v_lshlrev_b32_e64 v176, 16, v216
    v_and_b32 v177, 0xffff0000, v216
    v_lshlrev_b32_e64 v178, 16, v217
    v_and_b32 v179, 0xffff0000, v217
    v_lshlrev_b32_e64 v180, 16, v218
    v_and_b32 v181, 0xffff0000, v218
    v_lshlrev_b32_e64 v182, 16, v219
    v_and_b32 v183, 0xffff0000, v219
    v_lshlrev_b32_e64 v184, 16, v220
    v_and_b32 v185, 0xffff0000, v220
    v_lshlrev_b32_e64 v186, 16, v221
    v_and_b32 v187, 0xffff0000, v221
    v_lshlrev_b32_e64 v188, 16, v222
    v_and_b32 v189, 0xffff0000, v222
    v_lshlrev_b32_e64 v190, 16, v223
    v_and_b32 v191, 0xffff0000, v223
    s_waitcnt lgkmcnt(0)
    v_lshlrev_b32 v192, 16, v144
    v_and_b32 v193, 0xffff0000, v144
    v_lshlrev_b32_e64 v194, 16, v145
    v_and_b32 v195, 0xffff0000, v145
    v_pk_add_f32 v[16:17], v[16:17], v[176:177]
    v_pk_add_f32 v[16:17], v[16:17], v[192:193]
    v_pk_add_f32 v[18:19], v[18:19], v[178:179]
    v_pk_add_f32 v[18:19], v[18:19], v[194:195]
    v_lshlrev_b32_e64 v192, 16, v146
    v_and_b32 v193, 0xffff0000, v146
    v_lshlrev_b32_e64 v194, 16, v147
    v_and_b32 v195, 0xffff0000, v147
    v_pk_add_f32 v[24:25], v[24:25], v[180:181]
    v_pk_add_f32 v[24:25], v[24:25], v[192:193]
    v_pk_add_f32 v[26:27], v[26:27], v[182:183]
    v_pk_add_f32 v[26:27], v[26:27], v[194:195]
    v_lshlrev_b32_e64 v192, 16, v148
    v_and_b32 v193, 0xffff0000, v148
    v_lshlrev_b32_e64 v194, 16, v149
    v_and_b32 v195, 0xffff0000, v149
    v_pk_add_f32 v[32:33], v[32:33], v[184:185]
    v_pk_add_f32 v[32:33], v[32:33], v[192:193]
    v_pk_add_f32 v[34:35], v[34:35], v[186:187]
    v_pk_add_f32 v[34:35], v[34:35], v[194:195]
    v_lshlrev_b32_e64 v192, 16, v150
    v_and_b32 v193, 0xffff0000, v150
    v_lshlrev_b32_e64 v194, 16, v151
    v_and_b32 v195, 0xffff0000, v151
    v_pk_add_f32 v[40:41], v[40:41], v[188:189]
    v_pk_add_f32 v[40:41], v[40:41], v[192:193]
    v_pk_add_f32 v[42:43], v[42:43], v[190:191]
    v_pk_add_f32 v[42:43], v[42:43], v[194:195]
    v_lshlrev_b32_e64 v192, 16, v152
    v_and_b32 v193, 0xffff0000, v152
    v_lshlrev_b32_e64 v194, 16, v153
    v_and_b32 v195, 0xffff0000, v153
    v_pk_add_f32 v[20:21], v[20:21], v[176:177]
    v_pk_add_f32 v[20:21], v[20:21], v[192:193]
    v_pk_add_f32 v[22:23], v[22:23], v[178:179]
    v_pk_add_f32 v[22:23], v[22:23], v[194:195]
    v_lshlrev_b32_e64 v192, 16, v154
    v_and_b32 v193, 0xffff0000, v154
    v_lshlrev_b32_e64 v194, 16, v155
    v_and_b32 v195, 0xffff0000, v155
    v_pk_add_f32 v[28:29], v[28:29], v[180:181]
    v_pk_add_f32 v[28:29], v[28:29], v[192:193]
    v_pk_add_f32 v[30:31], v[30:31], v[182:183]
    v_pk_add_f32 v[30:31], v[30:31], v[194:195]
    v_lshlrev_b32_e64 v192, 16, v156
    v_and_b32 v193, 0xffff0000, v156
    v_lshlrev_b32_e64 v194, 16, v157
    v_and_b32 v195, 0xffff0000, v157
    v_pk_add_f32 v[36:37], v[36:37], v[184:185]
    v_pk_add_f32 v[36:37], v[36:37], v[192:193]
    v_pk_add_f32 v[38:39], v[38:39], v[186:187]
    v_pk_add_f32 v[38:39], v[38:39], v[194:195]
    v_lshlrev_b32_e64 v192, 16, v158
    v_and_b32 v193, 0xffff0000, v158
    v_lshlrev_b32_e64 v194, 16, v159
    v_and_b32 v195, 0xffff0000, v159
    v_pk_add_f32 v[44:45], v[44:45], v[188:189]
    v_pk_add_f32 v[44:45], v[44:45], v[192:193]
    v_pk_add_f32 v[46:47], v[46:47], v[190:191]
    v_pk_add_f32 v[46:47], v[46:47], v[194:195]
    s_mov_b32 s33, 0
sequential_preLN__ssm_conv_h3__dense_activation_squared_relu__prompt_kernel_g_chk:
    s_waitcnt vmcnt(0)
    v_readfirstlane_b32 s58, v14
    s_nop 0
    s_cmp_lg_u32 s58, -1
    s_cbranch_scc1 sequential_preLN__ssm_conv_h3__dense_activation_squared_relu__prompt_kernel_g_got
    buffer_load_dword v14, v13, s[48:51], s57 offen offset:64 sc1
    s_add_u32 s33, s33, 1
    s_nop 0
    s_cmp_lt_u32 s33, 0x20000
    s_cbranch_scc1 sequential_preLN__ssm_conv_h3__dense_activation_squared_relu__prompt_kernel_g_chk
sequential_preLN__ssm_conv_h3__dense_activation_squared_relu__prompt_kernel_g_got:
    s_nop 0
    buffer_load_dwordx4 v[80:83], v5, s[48:51], s54 offen offset:0 sc1
    buffer_load_dwordx4 v[84:87], v5, s[48:51], s54 offen offset:1024 sc1
    buffer_load_dwordx4 v[88:91], v5, s[48:51], s54 offen offset:2048 sc1
    buffer_load_dwordx4 v[92:95], v5, s[48:51], s54 offen offset:3072 sc1
    buffer_load_dwordx4 v[96:99], v5, s[48:51], s55 offen offset:0 sc1
    buffer_load_dwordx4 v[100:103], v5, s[48:51], s55 offen offset:1024 sc1
    buffer_load_dwordx4 v[104:107], v5, s[48:51], s55 offen offset:2048 sc1
    buffer_load_dwordx4 v[108:111], v5, s[48:51], s55 offen offset:3072 sc1
    s_waitcnt vmcnt(6)
    s_nop 0
    v_pk_add_f32 v[16:17], v[16:17], v[80:81]
    v_pk_add_f32 v[18:19], v[18:19], v[82:83]
    v_cvt_pk_bf16_f32 v112, v16, v17
    v_cvt_pk_bf16_f32 v113, v18, v19
    v_pk_add_f32 v[20:21], v[20:21], v[84:85]
    v_pk_add_f32 v[22:23], v[22:23], v[86:87]
    v_cvt_pk_bf16_f32 v120, v20, v21
    v_cvt_pk_bf16_f32 v121, v22, v23
    s_waitcnt vmcnt(4)
    s_nop 0
    v_pk_add_f32 v[24:25], v[24:25], v[88:89]
    v_pk_add_f32 v[26:27], v[26:27], v[90:91]
    v_cvt_pk_bf16_f32 v114, v24, v25
    v_cvt_pk_bf16_f32 v115, v26, v27
    v_pk_add_f32 v[28:29], v[28:29], v[92:93]
    v_pk_add_f32 v[30:31], v[30:31], v[94:95]
    v_cvt_pk_bf16_f32 v122, v28, v29
    v_cvt_pk_bf16_f32 v123, v30, v31
    s_nop 1
    s_nop 0
    v_permlane16_swap_b32 v112, v114
    v_permlane16_swap_b32 v113, v115
    buffer_store_dwordx4 v[112:115], v11, s[44:47], s17 offen offset:0
    s_nop 1
    s_nop 0
    v_permlane16_swap_b32 v120, v122
    v_permlane16_swap_b32 v121, v123
    buffer_store_dwordx4 v[120:123], v11, s[44:47], s18 offen offset:0
    s_waitcnt vmcnt(4)
    s_nop 0
    v_pk_add_f32 v[32:33], v[32:33], v[96:97]
    v_pk_add_f32 v[34:35], v[34:35], v[98:99]
    v_cvt_pk_bf16_f32 v116, v32, v33
    v_cvt_pk_bf16_f32 v117, v34, v35
    v_pk_add_f32 v[36:37], v[36:37], v[100:101]
    v_pk_add_f32 v[38:39], v[38:39], v[102:103]
    v_cvt_pk_bf16_f32 v124, v36, v37
    v_cvt_pk_bf16_f32 v125, v38, v39
    s_waitcnt vmcnt(2)
    s_nop 0
    v_pk_add_f32 v[40:41], v[40:41], v[104:105]
    v_pk_add_f32 v[42:43], v[42:43], v[106:107]
    v_cvt_pk_bf16_f32 v118, v40, v41
    v_cvt_pk_bf16_f32 v119, v42, v43
    v_pk_add_f32 v[44:45], v[44:45], v[108:109]
    v_pk_add_f32 v[46:47], v[46:47], v[110:111]
    v_cvt_pk_bf16_f32 v126, v44, v45
    v_cvt_pk_bf16_f32 v127, v46, v47
    s_nop 1
    s_nop 0
    v_permlane16_swap_b32 v116, v118
    v_permlane16_swap_b32 v117, v119
    buffer_store_dwordx4 v[116:119], v11, s[44:47], s17 offen offset:64
    s_nop 1
    s_nop 0
    v_permlane16_swap_b32 v124, v126
    v_permlane16_swap_b32 v125, v127
    buffer_store_dwordx4 v[124:127], v11, s[44:47], s18 offen offset:64
sequential_preLN__ssm_conv_h3__dense_activation_squared_relu__prompt_kernel_end:
    s_endpgm
code_end_lbl:
    s_endpgm
.section .rodata,"a"
.p2align 6
.amdhsa_kernel sequential_preLN__ssm_conv_h3__dense_activation_squared_relu__prompt_kernel
  .amdhsa_next_free_vgpr 256
  .amdhsa_next_free_sgpr 96
  .amdhsa_accum_offset 256
  .amdhsa_group_segment_fixed_size 0
  .amdhsa_kernarg_size 112
  .amdhsa_user_sgpr_count 2
  .amdhsa_user_sgpr_kernarg_segment_ptr 1
  .amdhsa_system_sgpr_workgroup_id_x 1
.end_amdhsa_kernel
```
